```python
import torch

def _softmax(x, axis=-1):
    return torch.softmax(x, dim=axis)
def _gelu(x):
    return torch.nn.functional.gelu(x, approximate="tanh")
def _silu(x):
    return torch.nn.functional.silu(x)
def _sigmoid(x):
    return torch.sigmoid(x)
def _layernorm(x, axis=-1, eps=1e-5):
    m = x.mean(dim=axis, keepdim=True)
    v = x.var(dim=axis, keepdim=True, unbiased=False)
    return (x - m) / torch.sqrt(v + eps)
def _scatter_add(tgt, idx, src, axis=0):
    return tgt.clone().index_add_(axis, idx, src)
def _segment_sum(src, seg, n):
    out = torch.zeros((n,) + src.shape[1:], dtype=src.dtype)
    return out.index_add_(0, seg, src)
def _pad(x, pw):
    flat = tuple(v for pair in reversed(pw) for v in pair)
    return torch.nn.functional.pad(x, flat)

kernel_name = 'recurrent_scan__mha_block_cached__swiglu_ffn__prompt'

def setup_inputs():

    _w = (lambda a: (lambda t: t.to(torch.bfloat16) if t.is_floating_point() else t)(torch.as_tensor(a)))
    def _A_setup():
        B, Sq, D = 1, 2048, 512
        H, Sk, Dh = 32, 2048, 128
        return {
            "x": _w((lambda *s: torch.randn(*s, dtype=torch.bfloat16) * 0.05)(B, Sq, D)),
            "k_cache": _w((lambda *s: torch.randn(*s, dtype=torch.bfloat16) * 0.8)(B, H, Sk, Dh)),
            "v_cache": _w((lambda *s: torch.randn(*s, dtype=torch.bfloat16) * 0.2)(B, H, Sk, Dh)),
            "wq": _w((lambda *s: torch.randn(*s, dtype=torch.bfloat16) * 0.8)(D, H * Dh) * (D ** -0.5)),
            "wo": _w((lambda *s: torch.randn(*s, dtype=torch.bfloat16) * 0.2)(H * Dh, D) * ((H * Dh) ** -0.5)),
        }
    _A_in = _A_setup()

    def _B_setup():
        B, S, D, F = 1, 2048, 512, 1792
        return {
            "x": _w((lambda *s: torch.randn(*s, dtype=torch.bfloat16) * 0.05)(B, S, D)),
            "w_gate": _w((lambda *s: torch.randn(*s, dtype=torch.bfloat16) * 0.1)(D, F)),
            "w_up": _w((lambda *s: torch.randn(*s, dtype=torch.bfloat16) * 0.1)(D, F)),
            "w_down": _w((lambda *s: torch.randn(*s, dtype=torch.bfloat16) * 0.1)(F, D)),
        }
    _B_in = _B_setup()

    return {
        "A_x": _A_in["x"],
        "A_k_cache": _A_in["k_cache"],
        "A_v_cache": _A_in["v_cache"],
        "A_wq": _A_in["wq"],
        "A_wo": _A_in["wo"],
        "B_x": _B_in["x"],
        "B_w_gate": _B_in["w_gate"],
        "B_w_up": _B_in["w_up"],
        "B_w_down": _B_in["w_down"],
    }

def reference(A_x, A_k_cache, A_v_cache, A_wq, A_wo, B_x, B_w_gate, B_w_up, B_w_down):
    def _A_ref(x, k_cache, v_cache, wq, wo):
        B, Sq, D = x.shape
        H, Dh = 32, 128
        q = (lambda x, *d: x.permute(*d))((x @ wq).reshape(B, Sq, H, Dh), 0, 2, 1, 3)
        scores = torch.einsum("bhqd,bhkd->bhqk", q, k_cache) * (Dh ** -0.5)
        p = _softmax(scores, axis=-1)
        o = torch.einsum("bhqk,bhkd->bhqd", p, v_cache)
        return (lambda x, *d: x.permute(*d))(o, 0, 2, 1, 3).reshape(B, Sq, H * Dh) @ wo

    def _B_ref(x, w_gate, w_up, w_down):
        g = _silu(x @ w_gate)
        u = x @ w_up
        return (g * u) @ w_down

    x = A_x
    xn = _layernorm(x, axis=-1)
    s = _A_ref(xn, A_k_cache, A_v_cache, A_wq, A_wo)
    g = _silu(_B_ref(xn, B_w_gate, B_w_up, B_w_down))
    return x + s * g
```

```asm
; @launch kernel=attn_kernel grid=(256,1,1) block=(256,1,1) lds=131328
; @launch kernel=oproj_kernel grid=(256,1,1) block=(256,1,1) lds=131072
.amdgcn_target "amdgcn-amd-amdhsa--gfx950"
.text
.globl attn_kernel
.p2align 8
.type attn_kernel,@function
attn_kernel:
    s_cmp_ge_u32 s2, 256
    s_cbranch_scc1 KA_end
    s_load_dwordx2 s[76:77], s[0:1], 0
    s_load_dwordx2 s[34:35], s[0:1], 88
    s_load_dwordx4 s[28:31], s[0:1], 8
    s_load_dwordx2 s[32:33], s[0:1], 24
    s_load_dwordx4 s[40:43], s[0:1], 48
    s_load_dwordx2 s[72:73], s[0:1], 80
    v_and_b32 v1, 63, v0
    v_lshrrev_b32 v2, 6, v0
    s_nop 0
    v_readfirstlane_b32 s3, v2
    s_and_b32 s4, s2, 7
    s_lshl_b32 s4, s4, 2
    s_lshr_b32 s5, s2, 3
    s_and_b32 s6, s5, 3
    s_add_u32 s4, s4, s6
    s_lshr_b32 s5, s2, 5
    s_lshl_b32 s25, s3, 12
    s_lshl_b32 s16, s5, 8
    s_lshl_b32 s17, s4, 3
    s_add_u32 s16, s16, s17
    s_lshl_b32 s17, s3, 1
    s_add_u32 s16, s16, s17
    s_lshl_b32 s17, s16, 10
    v_lshlrev_b32 v2, 4, v1
    s_waitcnt lgkmcnt(0)
    s_mov_b32 s8, s76
    s_and_b32 s9, s77, 0xffff
    s_mov_b32 s10, 2097152
    s_mov_b32 s11, 0x20000
    buffer_load_dwordx4 v[4:7], v2, s[8:11], s17 offen
    buffer_load_dwordx4 v[8:11], v2, s[8:11], s17 offen offset:1024
    s_mov_b32 s20, s34
    s_and_b32 s21, s35, 0xffff
    s_mov_b32 s22, 0x10000000
    s_mov_b32 s23, 0x20000
    s_mov_b32 s36, s32
    s_and_b32 s37, s33, 0xffff
    s_mov_b32 s38, 4194304
    s_mov_b32 s39, 0x20000
    s_mov_b32 s44, s42
    s_and_b32 s45, s43, 0xffff
    s_and_b32 s41, s41, 0xffff
    s_cmp_lt_u32 s4, 28
    s_cselect_b32 s42, 1835008, 0
    s_mov_b32 s46, s42
    s_mov_b32 s43, 0x20000
    s_mov_b32 s47, 0x20000
    s_lshl_b32 s50, s5, 18
    s_add_u32 s50, s50, 0
    s_add_u32 s50, s50, s25
    s_lshl_b32 s51, s4, 8
    s_lshl_b32 s52, s4, 7
    s_lshl_b32 s6, s3, 11
    s_add_u32 s55, s6, 65536
    s_lshl_b32 s6, s3, 10
    s_add_u32 s56, s6, 73728
    s_add_u32 s57, s6, 77824
    v_lshrrev_b32 v12, 4, v1
    v_and_b32 v13, 15, v1
    v_lshlrev_b32 v14, 2, v12
    v_xor_b32 v14, v14, v13
    v_lshlrev_b32 v14, 4, v14
    s_lshl_b32 s6, s3, 3
    v_add_u32 v15, s6, v12
    v_lshlrev_b32 v15, 13, v15
    v_add_u32 v239, v15, v14
    v_add_u32 v240, 31744, v239
    v_lshrrev_b32 v12, 3, v1
    v_and_b32 v13, 7, v1
    v_bfe_u32 v14, v1, 4, 1
    s_and_b32 s7, s3, 1
    s_lshl_b32 s7, s7, 1
    v_or_b32 v14, s7, v14
    v_lshlrev_b32 v14, 1, v14
    v_xor_b32 v14, v14, v13
    v_add_u32 v15, s6, v12
    s_movk_i32 s7, 3584
    v_mul_lo_u32 v15, v15, s7
    v_lshl_add_u32 v241, v14, 4, v15
    s_add_u32 m0, s55, 0
    s_nop 0
    buffer_load_dwordx4 v239, s[36:39], s51 offen lds
    buffer_load_dwordx4 v240, s[36:39], s51 offen offset:1024 lds
    s_add_u32 m0, s56, 0
    s_nop 0
    buffer_load_dwordx4 v241, s[40:43], s52 offen lds
    s_add_u32 m0, s57, 0
    s_nop 0
    buffer_load_dwordx4 v241, s[44:47], s52 offen lds
    s_add_u32 s51, s51, 262144
    s_add_u32 s52, s52, 114688
    s_add_u32 m0, s55, 16384
    s_nop 0
    buffer_load_dwordx4 v239, s[36:39], s51 offen lds
    buffer_load_dwordx4 v240, s[36:39], s51 offen offset:1024 lds
    s_add_u32 m0, s56, 16384
    s_nop 0
    buffer_load_dwordx4 v241, s[40:43], s52 offen lds
    s_add_u32 m0, s57, 16384
    s_nop 0
    buffer_load_dwordx4 v241, s[44:47], s52 offen lds
    s_add_u32 s51, s51, 262144
    s_add_u32 s52, s52, 114688
    s_add_u32 m0, s55, 32768
    s_nop 0
    buffer_load_dwordx4 v239, s[36:39], s51 offen lds
    buffer_load_dwordx4 v240, s[36:39], s51 offen offset:1024 lds
    s_add_u32 m0, s56, 32768
    s_nop 0
    buffer_load_dwordx4 v241, s[40:43], s52 offen lds
    s_add_u32 m0, s57, 32768
    s_nop 0
    buffer_load_dwordx4 v241, s[44:47], s52 offen lds
    s_add_u32 s51, s51, 262144
    s_add_u32 s52, s52, 114688
    v_bfe_u32 v3, v1, 2, 3
    v_lshlrev_b32 v3, 14, v3
    v_lshrrev_b32 v12, 5, v1
    v_lshl_add_u32 v3, v12, 6, v3
    v_and_b32 v12, 3, v1
    s_lshr_b32 s18, s16, 8
    s_lshl_b32 s18, s18, 18
    s_and_b32 s19, s16, 255
    s_lshl_b32 s6, s19, 6
    s_add_u32 s18, s18, s6
    s_add_u32 s18, s18, 0
    s_lshr_b32 s6, s19, 2
    s_and_b32 s6, s6, 3
    s_and_b32 s7, s6, 1
    s_lshl_b32 s7, s7, 1
    s_lshr_b32 s6, s6, 1
    s_mul_i32 s6, s6, 3
    s_xor_b32 s7, s7, s6
    v_xor_b32 v12, s7, v12
    v_lshl_add_u32 v3, v12, 4, v3
    s_waitcnt vmcnt(13)
    v_lshlrev_b32 v16, 16, v4
    v_and_b32 v17, 0xffff0000, v4
    v_lshlrev_b32 v18, 16, v5
    v_and_b32 v19, 0xffff0000, v5
    v_lshlrev_b32 v20, 16, v6
    v_and_b32 v21, 0xffff0000, v6
    v_lshlrev_b32 v22, 16, v7
    v_and_b32 v23, 0xffff0000, v7
    s_waitcnt vmcnt(12)
    v_lshlrev_b32 v32, 16, v8
    v_and_b32 v33, 0xffff0000, v8
    v_lshlrev_b32 v34, 16, v9
    v_and_b32 v35, 0xffff0000, v9
    v_lshlrev_b32 v36, 16, v10
    v_and_b32 v37, 0xffff0000, v10
    v_lshlrev_b32 v38, 16, v11
    v_and_b32 v39, 0xffff0000, v11
    v_add_f32 v24, v16, v17
    v_add_f32 v40, v32, v33
    v_add_f32 v24, v24, v18
    v_add_f32 v40, v40, v34
    v_add_f32 v24, v24, v19
    v_add_f32 v40, v40, v35
    v_add_f32 v24, v24, v20
    v_add_f32 v40, v40, v36
    v_add_f32 v24, v24, v21
    v_add_f32 v40, v40, v37
    v_add_f32 v24, v24, v22
    v_add_f32 v40, v40, v38
    v_add_f32 v24, v24, v23
    v_add_f32 v40, v40, v39
    s_nop 0
    v_add_f32_dpp v24, v24, v24 quad_perm:[1,0,3,2] row_mask:0xf bank_mask:0xf
    v_add_f32_dpp v40, v40, v40 quad_perm:[1,0,3,2] row_mask:0xf bank_mask:0xf
    s_nop 0
    v_add_f32_dpp v24, v24, v24 quad_perm:[2,3,0,1] row_mask:0xf bank_mask:0xf
    v_add_f32_dpp v40, v40, v40 quad_perm:[2,3,0,1] row_mask:0xf bank_mask:0xf
    s_nop 0
    v_add_f32_dpp v24, v24, v24 row_half_mirror row_mask:0xf bank_mask:0xf
    v_add_f32_dpp v40, v40, v40 row_half_mirror row_mask:0xf bank_mask:0xf
    s_nop 0
    v_add_f32_dpp v24, v24, v24 row_mirror row_mask:0xf bank_mask:0xf
    v_add_f32_dpp v40, v40, v40 row_mirror row_mask:0xf bank_mask:0xf
    v_mov_b32 v25, v24
    v_mov_b32 v41, v40
    s_nop 0
    v_permlane16_swap_b32 v25, v24
    v_permlane16_swap_b32 v41, v40
    v_add_f32 v24, v24, v25
    v_add_f32 v40, v40, v41
    v_mov_b32 v25, v24
    v_mov_b32 v41, v40
    s_nop 0
    v_permlane32_swap_b32 v25, v24
    v_permlane32_swap_b32 v41, v40
    v_add_f32 v24, v24, v25
    v_add_f32 v40, v40, v41
    v_mul_f32 v24, 0x3b000000, v24
    v_mul_f32 v40, 0x3b000000, v40
    v_sub_f32 v27, v16, v24
    v_mul_f32 v26, v27, v27
    v_sub_f32 v43, v32, v40
    v_mul_f32 v42, v43, v43
    v_sub_f32 v27, v17, v24
    v_fmac_f32 v26, v27, v27
    v_sub_f32 v43, v33, v40
    v_fmac_f32 v42, v43, v43
    v_sub_f32 v27, v18, v24
    v_fmac_f32 v26, v27, v27
    v_sub_f32 v43, v34, v40
    v_fmac_f32 v42, v43, v43
    v_sub_f32 v27, v19, v24
    v_fmac_f32 v26, v27, v27
    v_sub_f32 v43, v35, v40
    v_fmac_f32 v42, v43, v43
    v_sub_f32 v27, v20, v24
    v_fmac_f32 v26, v27, v27
    v_sub_f32 v43, v36, v40
    v_fmac_f32 v42, v43, v43
    v_sub_f32 v27, v21, v24
    v_fmac_f32 v26, v27, v27
    v_sub_f32 v43, v37, v40
    v_fmac_f32 v42, v43, v43
    v_sub_f32 v27, v22, v24
    v_fmac_f32 v26, v27, v27
    v_sub_f32 v43, v38, v40
    v_fmac_f32 v42, v43, v43
    v_sub_f32 v27, v23, v24
    v_fmac_f32 v26, v27, v27
    v_sub_f32 v43, v39, v40
    v_fmac_f32 v42, v43, v43
    v_add_f32_dpp v26, v26, v26 quad_perm:[1,0,3,2] row_mask:0xf bank_mask:0xf
    s_nop 0
    v_add_f32_dpp v42, v42, v42 quad_perm:[1,0,3,2] row_mask:0xf bank_mask:0xf
    v_add_f32_dpp v26, v26, v26 quad_perm:[2,3,0,1] row_mask:0xf bank_mask:0xf
    s_nop 0
    v_add_f32_dpp v42, v42, v42 quad_perm:[2,3,0,1] row_mask:0xf bank_mask:0xf
    v_add_f32_dpp v26, v26, v26 row_half_mirror row_mask:0xf bank_mask:0xf
    s_nop 0
    v_add_f32_dpp v42, v42, v42 row_half_mirror row_mask:0xf bank_mask:0xf
    v_add_f32_dpp v26, v26, v26 row_mirror row_mask:0xf bank_mask:0xf
    s_nop 0
    v_add_f32_dpp v42, v42, v42 row_mirror row_mask:0xf bank_mask:0xf
    v_mov_b32 v25, v26
    v_mov_b32 v41, v42
    s_nop 0
    v_permlane16_swap_b32 v25, v26
    v_permlane16_swap_b32 v41, v42
    v_add_f32 v26, v26, v25
    v_add_f32 v42, v42, v41
    v_mov_b32 v25, v26
    v_mov_b32 v41, v42
    s_nop 0
    v_permlane32_swap_b32 v25, v26
    v_permlane32_swap_b32 v41, v42
    v_add_f32 v26, v26, v25
    v_add_f32 v42, v42, v41
    v_mul_f32 v26, 0x3b000000, v26
    v_mul_f32 v42, 0x3b000000, v42
    v_cvt_pk_bf16_f32 v26, v26, v26
    v_and_b32 v26, 0xffff0000, v26
    v_cvt_pk_bf16_f32 v42, v42, v42
    v_and_b32 v42, 0xffff0000, v42
    v_add_f32 v26, 0x3727c5ac, v26
    v_add_f32 v42, 0x3727c5ac, v42
    v_cvt_pk_bf16_f32 v26, v26, v26
    v_and_b32 v26, 0xffff0000, v26
    v_cvt_pk_bf16_f32 v42, v42, v42
    v_and_b32 v42, 0xffff0000, v42
    v_sqrt_f32 v26, v26
    v_sqrt_f32 v42, v42
    v_cvt_pk_bf16_f32 v24, v24, v24
    v_and_b32 v24, 0xffff0000, v24
    v_cvt_pk_bf16_f32 v40, v40, v40
    v_and_b32 v40, 0xffff0000, v40
    v_cvt_pk_bf16_f32 v26, v26, v26
    v_and_b32 v26, 0xffff0000, v26
    v_cvt_pk_bf16_f32 v42, v42, v42
    v_and_b32 v42, 0xffff0000, v42
    v_rcp_f32 v26, v26
    v_rcp_f32 v42, v42
    v_sub_f32 v16, v16, v24
    v_sub_f32 v32, v32, v40
    v_sub_f32 v17, v17, v24
    v_sub_f32 v33, v33, v40
    v_sub_f32 v18, v18, v24
    v_sub_f32 v34, v34, v40
    v_sub_f32 v19, v19, v24
    v_sub_f32 v35, v35, v40
    v_sub_f32 v20, v20, v24
    v_sub_f32 v36, v36, v40
    v_sub_f32 v21, v21, v24
    v_sub_f32 v37, v37, v40
    v_sub_f32 v22, v22, v24
    v_sub_f32 v38, v38, v40
    v_sub_f32 v23, v23, v24
    v_sub_f32 v39, v39, v40
    v_cvt_pk_bf16_f32 v4, v16, v17
    v_cvt_pk_bf16_f32 v8, v32, v33
    v_cvt_pk_bf16_f32 v5, v18, v19
    v_cvt_pk_bf16_f32 v9, v34, v35
    v_cvt_pk_bf16_f32 v6, v20, v21
    v_cvt_pk_bf16_f32 v10, v36, v37
    v_cvt_pk_bf16_f32 v7, v22, v23
    v_cvt_pk_bf16_f32 v11, v38, v39
    v_lshlrev_b32 v16, 16, v4
    v_and_b32 v17, 0xffff0000, v4
    v_lshlrev_b32 v32, 16, v8
    v_and_b32 v33, 0xffff0000, v8
    v_lshlrev_b32 v18, 16, v5
    v_and_b32 v19, 0xffff0000, v5
    v_lshlrev_b32 v34, 16, v9
    v_and_b32 v35, 0xffff0000, v9
    v_lshlrev_b32 v20, 16, v6
    v_and_b32 v21, 0xffff0000, v6
    v_lshlrev_b32 v36, 16, v10
    v_and_b32 v37, 0xffff0000, v10
    v_lshlrev_b32 v22, 16, v7
    v_and_b32 v23, 0xffff0000, v7
    v_lshlrev_b32 v38, 16, v11
    v_and_b32 v39, 0xffff0000, v11
    v_mul_f32 v16, v16, v26
    v_mul_f32 v32, v32, v42
    v_mul_f32 v17, v17, v26
    v_mul_f32 v33, v33, v42
    v_mul_f32 v18, v18, v26
    v_mul_f32 v34, v34, v42
    v_mul_f32 v19, v19, v26
    v_mul_f32 v35, v35, v42
    v_mul_f32 v20, v20, v26
    v_mul_f32 v36, v36, v42
    v_mul_f32 v21, v21, v26
    v_mul_f32 v37, v37, v42
    v_mul_f32 v22, v22, v26
    v_mul_f32 v38, v38, v42
    v_mul_f32 v23, v23, v26
    v_mul_f32 v39, v39, v42
    v_cvt_pk_bf16_f32 v4, v16, v17
    v_cvt_pk_bf16_f32 v8, v32, v33
    v_cvt_pk_bf16_f32 v5, v18, v19
    v_cvt_pk_bf16_f32 v9, v34, v35
    v_cvt_pk_bf16_f32 v6, v20, v21
    v_cvt_pk_bf16_f32 v10, v36, v37
    v_cvt_pk_bf16_f32 v7, v22, v23
    v_cvt_pk_bf16_f32 v11, v38, v39
    v_permlane32_swap_b32 v4, v8
    v_permlane32_swap_b32 v5, v9
    v_permlane32_swap_b32 v6, v10
    v_permlane32_swap_b32 v7, v11
    buffer_store_dwordx4 v[4:7], v3, s[20:23], s18 offen sc1
    s_add_u32 s18, s18, 131072
    buffer_store_dwordx4 v[8:11], v3, s[20:23], s18 offen sc1
    s_lshl_b32 s6, s4, 19
    s_add_u32 s16, s28, s6
    s_addc_u32 s17, s29, 0
    s_and_b32 s17, s17, 0xffff
    s_mov_b32 s18, 524288
    s_mov_b32 s19, 0x20000
    s_add_u32 s8, s16, 16384
    s_addc_u32 s9, s17, 0
    s_mov_b32 s10, 507904
    s_mov_b32 s11, 0x20000
    s_add_u32 s12, s30, s6
    s_addc_u32 s13, s31, 0
    s_and_b32 s13, s13, 0xffff
    s_mov_b32 s14, 524288
    s_mov_b32 s15, 0x20000
    s_waitcnt vmcnt(0)
    s_barrier
    s_and_b32 s6, s5, 3
    s_lshl_b32 s6, s6, 6
    s_lshr_b32 s7, s5, 2
    s_lshl_b32 s7, s7, 2
    s_add_u32 s74, s6, s7
    s_cmp_lg_u32 s3, 0
    s_cbranch_scc1 K_xn_skip
    v_mov_b32 v2, s74
    v_mov_b32 v4, 1
    s_mov_b64 exec, 1
    global_atomic_add v2, v4, s[72:73] sc1
    s_mov_b64 exec, -1
K_xn_skip:
    v_bfe_u32 v2, v1, 2, 2
    v_and_b32 v3, 3, v1
    v_lshrrev_b32 v4, 4, v1
    v_lshl_add_u32 v5, v4, 3, v2
    v_lshlrev_b32 v6, 8, v5
    v_add_u32 v6, 65536, v6
    v_lshlrev_b32 v7, 2, v2
    v_add_u32 v8, 0, v3
    v_xor_b32 v8, v8, v7
    v_lshl_add_u32 v230, v8, 4, v6
    v_add_u32 v8, 4, v3
    v_xor_b32 v8, v8, v7
    v_lshl_add_u32 v231, v8, 4, v6
    v_add_u32 v8, 8, v3
    v_xor_b32 v8, v8, v7
    v_lshl_add_u32 v232, v8, 4, v6
    v_add_u32 v8, 12, v3
    v_xor_b32 v8, v8, v7
    v_lshl_add_u32 v233, v8, 4, v6
    v_lshlrev_b32 v6, 7, v5
    v_add_u32 v6, 65536, v6
    v_and_b32 v7, 1, v3
    v_lshl_add_u32 v6, v7, 3, v6
    v_bfe_u32 v7, v1, 3, 1
    v_and_b32 v8, 1, v4
    v_lshl_or_b32 v7, v8, 1, v7
    v_lshlrev_b32 v7, 1, v7
    v_lshrrev_b32 v9, 1, v3
    v_add_u32 v8, 0, v9
    v_xor_b32 v8, v8, v7
    v_lshl_add_u32 v234, v8, 4, v6
    v_add_u32 v8, 2, v9
    v_xor_b32 v8, v8, v7
    v_lshl_add_u32 v235, v8, 4, v6
    v_add_u32 v8, 4, v9
    v_xor_b32 v8, v8, v7
    v_lshl_add_u32 v236, v8, 4, v6
    v_add_u32 v8, 6, v9
    v_xor_b32 v8, v8, v7
    v_lshl_add_u32 v237, v8, 4, v6
    v_and_b32 v2, 15, v1
    v_lshrrev_b32 v3, 4, v1
    v_bfe_u32 v4, v1, 2, 1
    v_lshlrev_b32 v4, 1, v4
    v_bfe_u32 v5, v1, 3, 1
    v_mul_u32_u24 v5, 3, v5
    v_xor_b32 v4, v4, v5
    v_xor_b32 v4, v4, v3
    v_lshlrev_b32 v4, 4, v4
    v_lshl_add_u32 v238, v2, 6, v4
    v_lshrrev_b32 v2, 4, v1
    v_and_b32 v3, 15, v1
    v_lshlrev_b32 v4, 8, v2
    v_add_u32 v4, s25, v4
    v_add_u32 v5, 0, v2
    v_xor_b32 v5, v5, v3
    v_lshl_add_u32 v220, v5, 4, v4
    v_add_u32 v5, 4, v2
    v_xor_b32 v5, v5, v3
    v_lshl_add_u32 v221, v5, 4, v4
    v_add_u32 v5, 8, v2
    v_xor_b32 v5, v5, v3
    v_lshl_add_u32 v222, v5, 4, v4
    v_add_u32 v5, 12, v2
    v_xor_b32 v5, v5, v3
    v_lshl_add_u32 v223, v5, 4, v4
    v_add_u32 v5, 0, v2
    v_lshlrev_b32 v5, 1, v5
    v_xor_b32 v5, v5, v3
    v_lshl_add_u32 v224, v5, 4, v4
    v_add_u32 v5, 4, v2
    v_lshlrev_b32 v5, 1, v5
    v_xor_b32 v5, v5, v3
    v_lshl_add_u32 v225, v5, 4, v4
    v_and_b32 v2, 15, v1
    v_lshrrev_b32 v3, 4, v1
    v_lshlrev_b32 v5, 8, v2
    v_add_u32 v6, 0, v3
    v_xor_b32 v6, v6, v2
    v_lshl_add_u32 v208, v6, 4, v5
    v_add_u32 v6, 4, v3
    v_xor_b32 v6, v6, v2
    v_lshl_add_u32 v209, v6, 4, v5
    v_add_u32 v6, 8, v3
    v_xor_b32 v6, v6, v2
    v_lshl_add_u32 v210, v6, 4, v5
    v_add_u32 v6, 12, v3
    v_xor_b32 v6, v6, v2
    v_lshl_add_u32 v211, v6, 4, v5
    v_bfe_u32 v2, v1, 2, 2
    v_and_b32 v3, 3, v1
    v_lshrrev_b32 v4, 4, v1
    v_lshl_add_u32 v6, v4, 2, v2
    v_and_b32 v8, 7, v6
    v_lshlrev_b32 v8, 1, v8
    v_lshlrev_b32 v6, 8, v6
    v_add_u32 v6, 65536, v6
    v_and_b32 v7, 1, v3
    v_lshl_add_u32 v6, v7, 3, v6
    v_lshrrev_b32 v7, 1, v3
    v_add_u32 v9, 0, v7
    v_xor_b32 v9, v9, v8
    v_lshl_add_u32 v212, v9, 4, v6
    v_add_u32 v9, 2, v7
    v_xor_b32 v9, v9, v8
    v_lshl_add_u32 v213, v9, 4, v6
    v_add_u32 v9, 4, v7
    v_xor_b32 v9, v9, v8
    v_lshl_add_u32 v214, v9, 4, v6
    v_add_u32 v9, 6, v7
    v_xor_b32 v9, v9, v8
    v_lshl_add_u32 v215, v9, 4, v6
    v_add_u32 v9, 8, v7
    v_xor_b32 v9, v9, v8
    v_lshl_add_u32 v216, v9, 4, v6
    v_add_u32 v9, 10, v7
    v_xor_b32 v9, v9, v8
    v_lshl_add_u32 v217, v9, 4, v6
    v_add_u32 v9, 12, v7
    v_xor_b32 v9, v9, v8
    v_lshl_add_u32 v218, v9, 4, v6
    v_add_u32 v9, 14, v7
    v_xor_b32 v9, v9, v8
    v_lshl_add_u32 v219, v9, 4, v6
    v_mov_b32 v16, 0
    v_mov_b32 v17, 0
    v_mov_b32 v18, 0
    v_mov_b32 v19, 0
    v_mov_b32 v20, 0
    v_mov_b32 v21, 0
    v_mov_b32 v22, 0
    v_mov_b32 v23, 0
    v_mov_b32 v24, 0
    v_mov_b32 v25, 0
    v_mov_b32 v26, 0
    v_mov_b32 v27, 0
    v_mov_b32 v28, 0
    v_mov_b32 v29, 0
    v_mov_b32 v30, 0
    v_mov_b32 v31, 0
    v_mov_b32 v32, 0
    v_mov_b32 v33, 0
    v_mov_b32 v34, 0
    v_mov_b32 v35, 0
    v_mov_b32 v36, 0
    v_mov_b32 v37, 0
    v_mov_b32 v38, 0
    v_mov_b32 v39, 0
    v_mov_b32 v40, 0
    v_mov_b32 v41, 0
    v_mov_b32 v42, 0
    v_mov_b32 v43, 0
    v_mov_b32 v44, 0
    v_mov_b32 v45, 0
    v_mov_b32 v46, 0
    v_mov_b32 v47, 0
    v_mov_b32 v48, 0
    v_mov_b32 v49, 0
    v_mov_b32 v50, 0
    v_mov_b32 v51, 0
    v_mov_b32 v52, 0
    v_mov_b32 v53, 0
    v_mov_b32 v54, 0
    v_mov_b32 v55, 0
    v_mov_b32 v56, 0
    v_mov_b32 v57, 0
    v_mov_b32 v58, 0
    v_mov_b32 v59, 0
    v_mov_b32 v60, 0
    v_mov_b32 v61, 0
    v_mov_b32 v62, 0
    v_mov_b32 v63, 0
    v_mov_b32 v64, 0
    v_mov_b32 v65, 0
    v_mov_b32 v66, 0
    v_mov_b32 v67, 0
    v_mov_b32 v68, 0
    v_mov_b32 v69, 0
    v_mov_b32 v70, 0
    v_mov_b32 v71, 0
    v_mov_b32 v72, 0
    v_mov_b32 v73, 0
    v_mov_b32 v74, 0
    v_mov_b32 v75, 0
    v_mov_b32 v76, 0
    v_mov_b32 v77, 0
    v_mov_b32 v78, 0
    v_mov_b32 v79, 0
    v_mov_b32 v80, 0
    v_mov_b32 v81, 0
    v_mov_b32 v82, 0
    v_mov_b32 v83, 0
    v_mov_b32 v84, 0
    v_mov_b32 v85, 0
    v_mov_b32 v86, 0
    v_mov_b32 v87, 0
    v_mov_b32 v88, 0
    v_mov_b32 v89, 0
    v_mov_b32 v90, 0
    v_mov_b32 v91, 0
    v_mov_b32 v92, 0
    v_mov_b32 v93, 0
    v_mov_b32 v94, 0
    v_mov_b32 v95, 0
    v_mov_b32 v96, 0
    v_mov_b32 v97, 0
    v_mov_b32 v98, 0
    v_mov_b32 v99, 0
    v_mov_b32 v100, 0
    v_mov_b32 v101, 0
    v_mov_b32 v102, 0
    v_mov_b32 v103, 0
    v_mov_b32 v104, 0
    v_mov_b32 v105, 0
    v_mov_b32 v106, 0
    v_mov_b32 v107, 0
    v_mov_b32 v108, 0
    v_mov_b32 v109, 0
    v_mov_b32 v110, 0
    v_mov_b32 v111, 0
    v_mov_b32 v112, 0
    v_mov_b32 v113, 0
    v_mov_b32 v114, 0
    v_mov_b32 v115, 0
    v_mov_b32 v116, 0
    v_mov_b32 v117, 0
    v_mov_b32 v118, 0
    v_mov_b32 v119, 0
    v_mov_b32 v120, 0
    v_mov_b32 v121, 0
    v_mov_b32 v122, 0
    v_mov_b32 v123, 0
    v_mov_b32 v124, 0
    v_mov_b32 v125, 0
    v_mov_b32 v126, 0
    v_mov_b32 v127, 0
    v_mov_b32 v128, 0
    v_mov_b32 v129, 0
    v_mov_b32 v130, 0
    v_mov_b32 v131, 0
    v_mov_b32 v132, 0
    v_mov_b32 v133, 0
    v_mov_b32 v134, 0
    v_mov_b32 v135, 0
    v_mov_b32 v136, 0
    v_mov_b32 v137, 0
    v_mov_b32 v138, 0
    v_mov_b32 v139, 0
    v_mov_b32 v140, 0
    v_mov_b32 v141, 0
    v_mov_b32 v142, 0
    v_mov_b32 v143, 0
    v_accvgpr_write_b32 a0, 0
    v_accvgpr_write_b32 a1, 0
    v_accvgpr_write_b32 a2, 0
    v_accvgpr_write_b32 a3, 0
    v_accvgpr_write_b32 a4, 0
    v_accvgpr_write_b32 a5, 0
    v_accvgpr_write_b32 a6, 0
    v_accvgpr_write_b32 a7, 0
    v_accvgpr_write_b32 a8, 0
    v_accvgpr_write_b32 a9, 0
    v_accvgpr_write_b32 a10, 0
    v_accvgpr_write_b32 a11, 0
    v_accvgpr_write_b32 a12, 0
    v_accvgpr_write_b32 a13, 0
    v_accvgpr_write_b32 a14, 0
    v_accvgpr_write_b32 a15, 0
    v_accvgpr_write_b32 a16, 0
    v_accvgpr_write_b32 a17, 0
    v_accvgpr_write_b32 a18, 0
    v_accvgpr_write_b32 a19, 0
    v_accvgpr_write_b32 a20, 0
    v_accvgpr_write_b32 a21, 0
    v_accvgpr_write_b32 a22, 0
    v_accvgpr_write_b32 a23, 0
    v_accvgpr_write_b32 a24, 0
    v_accvgpr_write_b32 a25, 0
    v_accvgpr_write_b32 a26, 0
    v_accvgpr_write_b32 a27, 0
    v_accvgpr_write_b32 a28, 0
    v_accvgpr_write_b32 a29, 0
    v_accvgpr_write_b32 a30, 0
    v_accvgpr_write_b32 a31, 0
    v_accvgpr_write_b32 a32, 0
    v_accvgpr_write_b32 a33, 0
    v_accvgpr_write_b32 a34, 0
    v_accvgpr_write_b32 a35, 0
    v_accvgpr_write_b32 a36, 0
    v_accvgpr_write_b32 a37, 0
    v_accvgpr_write_b32 a38, 0
    v_accvgpr_write_b32 a39, 0
    v_accvgpr_write_b32 a40, 0
    v_accvgpr_write_b32 a41, 0
    v_accvgpr_write_b32 a42, 0
    v_accvgpr_write_b32 a43, 0
    v_accvgpr_write_b32 a44, 0
    v_accvgpr_write_b32 a45, 0
    v_accvgpr_write_b32 a46, 0
    v_accvgpr_write_b32 a47, 0
    v_accvgpr_write_b32 a48, 0
    v_accvgpr_write_b32 a49, 0
    v_accvgpr_write_b32 a50, 0
    v_accvgpr_write_b32 a51, 0
    v_accvgpr_write_b32 a52, 0
    v_accvgpr_write_b32 a53, 0
    v_accvgpr_write_b32 a54, 0
    v_accvgpr_write_b32 a55, 0
    v_accvgpr_write_b32 a56, 0
    v_accvgpr_write_b32 a57, 0
    v_accvgpr_write_b32 a58, 0
    v_accvgpr_write_b32 a59, 0
    v_accvgpr_write_b32 a60, 0
    v_accvgpr_write_b32 a61, 0
    v_accvgpr_write_b32 a62, 0
    v_accvgpr_write_b32 a63, 0
    v_accvgpr_write_b32 a64, 0
    v_accvgpr_write_b32 a65, 0
    v_accvgpr_write_b32 a66, 0
    v_accvgpr_write_b32 a67, 0
    v_accvgpr_write_b32 a68, 0
    v_accvgpr_write_b32 a69, 0
    v_accvgpr_write_b32 a70, 0
    v_accvgpr_write_b32 a71, 0
    v_accvgpr_write_b32 a72, 0
    v_accvgpr_write_b32 a73, 0
    v_accvgpr_write_b32 a74, 0
    v_accvgpr_write_b32 a75, 0
    v_accvgpr_write_b32 a76, 0
    v_accvgpr_write_b32 a77, 0
    v_accvgpr_write_b32 a78, 0
    v_accvgpr_write_b32 a79, 0
    v_accvgpr_write_b32 a80, 0
    v_accvgpr_write_b32 a81, 0
    v_accvgpr_write_b32 a82, 0
    v_accvgpr_write_b32 a83, 0
    v_accvgpr_write_b32 a84, 0
    v_accvgpr_write_b32 a85, 0
    v_accvgpr_write_b32 a86, 0
    v_accvgpr_write_b32 a87, 0
    v_accvgpr_write_b32 a88, 0
    v_accvgpr_write_b32 a89, 0
    v_accvgpr_write_b32 a90, 0
    v_accvgpr_write_b32 a91, 0
    v_accvgpr_write_b32 a92, 0
    v_accvgpr_write_b32 a93, 0
    v_accvgpr_write_b32 a94, 0
    v_accvgpr_write_b32 a95, 0
    v_accvgpr_write_b32 a96, 0
    v_accvgpr_write_b32 a97, 0
    v_accvgpr_write_b32 a98, 0
    v_accvgpr_write_b32 a99, 0
    v_accvgpr_write_b32 a100, 0
    v_accvgpr_write_b32 a101, 0
    v_accvgpr_write_b32 a102, 0
    v_accvgpr_write_b32 a103, 0
    v_accvgpr_write_b32 a104, 0
    v_accvgpr_write_b32 a105, 0
    v_accvgpr_write_b32 a106, 0
    v_accvgpr_write_b32 a107, 0
    v_accvgpr_write_b32 a108, 0
    v_accvgpr_write_b32 a109, 0
    v_accvgpr_write_b32 a110, 0
    v_accvgpr_write_b32 a111, 0
    v_accvgpr_write_b32 a112, 0
    v_accvgpr_write_b32 a113, 0
    v_accvgpr_write_b32 a114, 0
    v_accvgpr_write_b32 a115, 0
    v_accvgpr_write_b32 a116, 0
    v_accvgpr_write_b32 a117, 0
    v_accvgpr_write_b32 a118, 0
    v_accvgpr_write_b32 a119, 0
    v_accvgpr_write_b32 a120, 0
    v_accvgpr_write_b32 a121, 0
    v_accvgpr_write_b32 a122, 0
    v_accvgpr_write_b32 a123, 0
    v_accvgpr_write_b32 a124, 0
    v_accvgpr_write_b32 a125, 0
    v_accvgpr_write_b32 a126, 0
    v_accvgpr_write_b32 a127, 0
    ds_read_b64_tr_b16 a[128:129], v230 offset:0
    ds_read_b64_tr_b16 a[130:131], v230 offset:1024
    ds_read_b64_tr_b16 a[132:133], v230 offset:8
    ds_read_b64_tr_b16 a[134:135], v230 offset:1032
    ds_read_b64_tr_b16 a[136:137], v231 offset:0
    ds_read_b64_tr_b16 a[138:139], v231 offset:1024
    ds_read_b64_tr_b16 a[140:141], v231 offset:8
    ds_read_b64_tr_b16 a[142:143], v231 offset:1032
    ds_read_b64_tr_b16 a[144:145], v232 offset:0
    ds_read_b64_tr_b16 a[146:147], v232 offset:1024
    ds_read_b64_tr_b16 a[148:149], v232 offset:8
    ds_read_b64_tr_b16 a[150:151], v232 offset:1032
    ds_read_b64_tr_b16 a[152:153], v233 offset:0
    ds_read_b64_tr_b16 a[154:155], v233 offset:1024
    ds_read_b64_tr_b16 a[156:157], v233 offset:8
    ds_read_b64_tr_b16 a[158:159], v233 offset:1032
    ds_read_b64_tr_b16 a[160:161], v234 offset:8192
    ds_read_b64_tr_b16 a[162:163], v234 offset:8704
    ds_read_b64_tr_b16 a[164:165], v235 offset:8192
    ds_read_b64_tr_b16 a[166:167], v235 offset:8704
    ds_read_b64_tr_b16 a[168:169], v236 offset:8192
    ds_read_b64_tr_b16 a[170:171], v236 offset:8704
    ds_read_b64_tr_b16 a[172:173], v237 offset:8192
    ds_read_b64_tr_b16 a[174:175], v237 offset:8704
    ds_read_b64_tr_b16 a[176:177], v234 offset:12288
    ds_read_b64_tr_b16 a[178:179], v234 offset:12800
    ds_read_b64_tr_b16 a[180:181], v235 offset:12288
    ds_read_b64_tr_b16 a[182:183], v235 offset:12800
    ds_read_b64_tr_b16 a[184:185], v236 offset:12288
    ds_read_b64_tr_b16 a[186:187], v236 offset:12800
    ds_read_b64_tr_b16 a[188:189], v237 offset:12288
    ds_read_b64_tr_b16 a[190:191], v237 offset:12800
    s_cmp_lg_u32 s3, 0
    s_cbranch_scc1 K_xn_wait
    v_mov_b32 v2, s74
    s_mov_b64 exec, 1
    s_mov_b32 s79, 0x40000
K_xn_poll:
    global_load_dword v5, v2, s[72:73] sc1
    s_waitcnt vmcnt(0)
    v_readfirstlane_b32 s75, v5
    s_nop 0
    s_cmp_ge_u32 s75, 32
    s_cbranch_scc1 K_xn_poll_ok
    s_sleep 2
    s_sub_u32 s79, s79, 1
    s_cbranch_scc0 K_xn_poll
K_xn_poll_ok:
    s_mov_b64 exec, -1
K_xn_wait:
    s_barrier
    buffer_load_dwordx4 v[144:147], v238, s[20:23], s50 offen offset:0 sc1
    buffer_load_dwordx4 v[148:151], v238, s[20:23], s50 offen offset:1024 sc1
    buffer_load_dwordx4 v[152:155], v238, s[20:23], s50 offen offset:2048 sc1
    buffer_load_dwordx4 v[156:159], v238, s[20:23], s50 offen offset:3072 sc1
    s_add_u32 s50, s50, 16384
    buffer_load_dwordx4 v[160:163], v238, s[20:23], s50 offen offset:0 sc1
    buffer_load_dwordx4 v[164:167], v238, s[20:23], s50 offen offset:1024 sc1
    buffer_load_dwordx4 v[168:171], v238, s[20:23], s50 offen offset:2048 sc1
    buffer_load_dwordx4 v[172:175], v238, s[20:23], s50 offen offset:3072 sc1
    s_add_u32 s50, s50, 16384
    buffer_load_dwordx4 v[176:179], v238, s[20:23], s50 offen offset:0 sc1
    buffer_load_dwordx4 v[180:183], v238, s[20:23], s50 offen offset:1024 sc1
    buffer_load_dwordx4 v[184:187], v238, s[20:23], s50 offen offset:2048 sc1
    buffer_load_dwordx4 v[188:191], v238, s[20:23], s50 offen offset:3072 sc1
    s_add_u32 s50, s50, 16384
    s_mov_b32 s26, 3
K_gloop:
    s_waitcnt vmcnt(8) lgkmcnt(15)
    s_barrier
    v_mfma_f32_16x16x32_bf16 v[16:19], a[128:131], v[144:147], v[16:19]
    v_mfma_f32_16x16x32_bf16 v[20:23], a[128:131], v[148:151], v[20:23]
    v_mfma_f32_16x16x32_bf16 v[24:27], a[128:131], v[152:155], v[24:27]
    buffer_load_dwordx4 v[192:195], v238, s[20:23], s50 offen offset:0 sc1
    v_mfma_f32_16x16x32_bf16 v[28:31], a[128:131], v[156:159], v[28:31]
    v_mfma_f32_16x16x32_bf16 v[32:35], a[132:135], v[144:147], v[32:35]
    ds_read_b64_tr_b16 a[128:129], v230 offset:16384
    v_mfma_f32_16x16x32_bf16 v[36:39], a[132:135], v[148:151], v[36:39]
    ds_read_b64_tr_b16 a[130:131], v230 offset:17408
    v_mfma_f32_16x16x32_bf16 v[40:43], a[132:135], v[152:155], v[40:43]
    buffer_load_dwordx4 v[196:199], v238, s[20:23], s50 offen offset:1024 sc1
    v_mfma_f32_16x16x32_bf16 v[44:47], a[132:135], v[156:159], v[44:47]
    v_mfma_f32_16x16x32_bf16 v[48:51], a[136:139], v[144:147], v[48:51]
    ds_read_b64_tr_b16 a[132:133], v230 offset:16392
    v_mfma_f32_16x16x32_bf16 v[52:55], a[136:139], v[148:151], v[52:55]
    ds_read_b64_tr_b16 a[134:135], v230 offset:17416
    v_mfma_f32_16x16x32_bf16 v[56:59], a[136:139], v[152:155], v[56:59]
    buffer_load_dwordx4 v[200:203], v238, s[20:23], s50 offen offset:2048 sc1
    v_mfma_f32_16x16x32_bf16 v[60:63], a[136:139], v[156:159], v[60:63]
    v_mfma_f32_16x16x32_bf16 v[64:67], a[140:143], v[144:147], v[64:67]
    ds_read_b64_tr_b16 a[136:137], v231 offset:16384
    v_mfma_f32_16x16x32_bf16 v[68:71], a[140:143], v[148:151], v[68:71]
    ds_read_b64_tr_b16 a[138:139], v231 offset:17408
    v_mfma_f32_16x16x32_bf16 v[72:75], a[140:143], v[152:155], v[72:75]
    buffer_load_dwordx4 v[204:207], v238, s[20:23], s50 offen offset:3072 sc1
    v_mfma_f32_16x16x32_bf16 v[76:79], a[140:143], v[156:159], v[76:79]
    v_mfma_f32_16x16x32_bf16 v[80:83], a[144:147], v[144:147], v[80:83]
    ds_read_b64_tr_b16 a[140:141], v231 offset:16392
    v_mfma_f32_16x16x32_bf16 v[84:87], a[144:147], v[148:151], v[84:87]
    ds_read_b64_tr_b16 a[142:143], v231 offset:17416
    s_add_u32 m0, s55, 49152
    v_mfma_f32_16x16x32_bf16 v[88:91], a[144:147], v[152:155], v[88:91]
    buffer_load_dwordx4 v239, s[36:39], s51 offen lds
    v_mfma_f32_16x16x32_bf16 v[92:95], a[144:147], v[156:159], v[92:95]
    v_mfma_f32_16x16x32_bf16 v[96:99], a[148:151], v[144:147], v[96:99]
    ds_read_b64_tr_b16 a[144:145], v232 offset:16384
    v_mfma_f32_16x16x32_bf16 v[100:103], a[148:151], v[148:151], v[100:103]
    ds_read_b64_tr_b16 a[146:147], v232 offset:17408
    v_mfma_f32_16x16x32_bf16 v[104:107], a[148:151], v[152:155], v[104:107]
    buffer_load_dwordx4 v240, s[36:39], s51 offen offset:1024 lds
    v_mfma_f32_16x16x32_bf16 v[108:111], a[148:151], v[156:159], v[108:111]
    v_mfma_f32_16x16x32_bf16 v[112:115], a[152:155], v[144:147], v[112:115]
    ds_read_b64_tr_b16 a[148:149], v232 offset:16392
    v_mfma_f32_16x16x32_bf16 v[116:119], a[152:155], v[148:151], v[116:119]
    ds_read_b64_tr_b16 a[150:151], v232 offset:17416
    s_add_u32 m0, s56, 49152
    v_mfma_f32_16x16x32_bf16 v[120:123], a[152:155], v[152:155], v[120:123]
    buffer_load_dwordx4 v241, s[40:43], s52 offen lds
    v_mfma_f32_16x16x32_bf16 v[124:127], a[152:155], v[156:159], v[124:127]
    v_mfma_f32_16x16x32_bf16 v[128:131], a[156:159], v[144:147], v[128:131]
    ds_read_b64_tr_b16 a[152:153], v233 offset:16384
    v_mfma_f32_16x16x32_bf16 v[132:135], a[156:159], v[148:151], v[132:135]
    ds_read_b64_tr_b16 a[154:155], v233 offset:17408
    s_add_u32 m0, s57, 49152
    v_mfma_f32_16x16x32_bf16 v[136:139], a[156:159], v[152:155], v[136:139]
    buffer_load_dwordx4 v241, s[44:47], s52 offen lds
    v_mfma_f32_16x16x32_bf16 v[140:143], a[156:159], v[156:159], v[140:143]
    s_waitcnt lgkmcnt(15)
    v_mfma_f32_16x16x32_bf16 a[0:3], a[160:163], v[144:147], a[0:3]
    ds_read_b64_tr_b16 a[156:157], v233 offset:16392
    v_mfma_f32_16x16x32_bf16 a[4:7], a[160:163], v[148:151], a[4:7]
    ds_read_b64_tr_b16 a[158:159], v233 offset:17416
    v_mfma_f32_16x16x32_bf16 a[8:11], a[160:163], v[152:155], a[8:11]
    v_mfma_f32_16x16x32_bf16 a[12:15], a[160:163], v[156:159], a[12:15]
    v_mfma_f32_16x16x32_bf16 a[16:19], a[164:167], v[144:147], a[16:19]
    ds_read_b64_tr_b16 a[160:161], v234 offset:24576
    v_mfma_f32_16x16x32_bf16 a[20:23], a[164:167], v[148:151], a[20:23]
    ds_read_b64_tr_b16 a[162:163], v234 offset:25088
    v_mfma_f32_16x16x32_bf16 a[24:27], a[164:167], v[152:155], a[24:27]
    v_mfma_f32_16x16x32_bf16 a[28:31], a[164:167], v[156:159], a[28:31]
    v_mfma_f32_16x16x32_bf16 a[32:35], a[168:171], v[144:147], a[32:35]
    ds_read_b64_tr_b16 a[164:165], v235 offset:24576
    v_mfma_f32_16x16x32_bf16 a[36:39], a[168:171], v[148:151], a[36:39]
    ds_read_b64_tr_b16 a[166:167], v235 offset:25088
    v_mfma_f32_16x16x32_bf16 a[40:43], a[168:171], v[152:155], a[40:43]
    v_mfma_f32_16x16x32_bf16 a[44:47], a[168:171], v[156:159], a[44:47]
    v_mfma_f32_16x16x32_bf16 a[48:51], a[172:175], v[144:147], a[48:51]
    ds_read_b64_tr_b16 a[168:169], v236 offset:24576
    v_mfma_f32_16x16x32_bf16 a[52:55], a[172:175], v[148:151], a[52:55]
    ds_read_b64_tr_b16 a[170:171], v236 offset:25088
    v_mfma_f32_16x16x32_bf16 a[56:59], a[172:175], v[152:155], a[56:59]
    v_mfma_f32_16x16x32_bf16 a[60:63], a[172:175], v[156:159], a[60:63]
    s_waitcnt lgkmcnt(15)
    v_mfma_f32_16x16x32_bf16 a[64:67], a[176:179], v[144:147], a[64:67]
    ds_read_b64_tr_b16 a[172:173], v237 offset:24576
    s_add_u32 s50, s50, 16384
    v_mfma_f32_16x16x32_bf16 a[68:71], a[176:179], v[148:151], a[68:71]
    ds_read_b64_tr_b16 a[174:175], v237 offset:25088
    s_add_u32 s51, s51, 262144
    v_mfma_f32_16x16x32_bf16 a[72:75], a[176:179], v[152:155], a[72:75]
    s_add_u32 s52, s52, 114688
    v_mfma_f32_16x16x32_bf16 a[76:79], a[176:179], v[156:159], a[76:79]
    v_mfma_f32_16x16x32_bf16 a[80:83], a[180:183], v[144:147], a[80:83]
    ds_read_b64_tr_b16 a[176:177], v234 offset:28672
    v_mfma_f32_16x16x32_bf16 a[84:87], a[180:183], v[148:151], a[84:87]
    ds_read_b64_tr_b16 a[178:179], v234 offset:29184
    v_mfma_f32_16x16x32_bf16 a[88:91], a[180:183], v[152:155], a[88:91]
    v_mfma_f32_16x16x32_bf16 a[92:95], a[180:183], v[156:159], a[92:95]
    v_mfma_f32_16x16x32_bf16 a[96:99], a[184:187], v[144:147], a[96:99]
    ds_read_b64_tr_b16 a[180:181], v235 offset:28672
    v_mfma_f32_16x16x32_bf16 a[100:103], a[184:187], v[148:151], a[100:103]
    ds_read_b64_tr_b16 a[182:183], v235 offset:29184
    v_mfma_f32_16x16x32_bf16 a[104:107], a[184:187], v[152:155], a[104:107]
    v_mfma_f32_16x16x32_bf16 a[108:111], a[184:187], v[156:159], a[108:111]
    v_mfma_f32_16x16x32_bf16 a[112:115], a[188:191], v[144:147], a[112:115]
    ds_read_b64_tr_b16 a[184:185], v236 offset:28672
    v_mfma_f32_16x16x32_bf16 a[116:119], a[188:191], v[148:151], a[116:119]
    ds_read_b64_tr_b16 a[186:187], v236 offset:29184
    v_mfma_f32_16x16x32_bf16 a[120:123], a[188:191], v[152:155], a[120:123]
    v_mfma_f32_16x16x32_bf16 a[124:127], a[188:191], v[156:159], a[124:127]
    ds_read_b64_tr_b16 a[188:189], v237 offset:28672
    ds_read_b64_tr_b16 a[190:191], v237 offset:29184
    s_waitcnt vmcnt(8) lgkmcnt(15)
    s_barrier
    v_mfma_f32_16x16x32_bf16 v[16:19], a[128:131], v[160:163], v[16:19]
    v_mfma_f32_16x16x32_bf16 v[20:23], a[128:131], v[164:167], v[20:23]
    v_mfma_f32_16x16x32_bf16 v[24:27], a[128:131], v[168:171], v[24:27]
    buffer_load_dwordx4 v[144:147], v238, s[20:23], s50 offen offset:0 sc1
    v_mfma_f32_16x16x32_bf16 v[28:31], a[128:131], v[172:175], v[28:31]
    v_mfma_f32_16x16x32_bf16 v[32:35], a[132:135], v[160:163], v[32:35]
    ds_read_b64_tr_b16 a[128:129], v230 offset:32768
    v_mfma_f32_16x16x32_bf16 v[36:39], a[132:135], v[164:167], v[36:39]
    ds_read_b64_tr_b16 a[130:131], v230 offset:33792
    v_mfma_f32_16x16x32_bf16 v[40:43], a[132:135], v[168:171], v[40:43]
    buffer_load_dwordx4 v[148:151], v238, s[20:23], s50 offen offset:1024 sc1
    v_mfma_f32_16x16x32_bf16 v[44:47], a[132:135], v[172:175], v[44:47]
    v_mfma_f32_16x16x32_bf16 v[48:51], a[136:139], v[160:163], v[48:51]
    ds_read_b64_tr_b16 a[132:133], v230 offset:32776
    v_mfma_f32_16x16x32_bf16 v[52:55], a[136:139], v[164:167], v[52:55]
    ds_read_b64_tr_b16 a[134:135], v230 offset:33800
    v_mfma_f32_16x16x32_bf16 v[56:59], a[136:139], v[168:171], v[56:59]
    buffer_load_dwordx4 v[152:155], v238, s[20:23], s50 offen offset:2048 sc1
    v_mfma_f32_16x16x32_bf16 v[60:63], a[136:139], v[172:175], v[60:63]
    v_mfma_f32_16x16x32_bf16 v[64:67], a[140:143], v[160:163], v[64:67]
    ds_read_b64_tr_b16 a[136:137], v231 offset:32768
    v_mfma_f32_16x16x32_bf16 v[68:71], a[140:143], v[164:167], v[68:71]
    ds_read_b64_tr_b16 a[138:139], v231 offset:33792
    v_mfma_f32_16x16x32_bf16 v[72:75], a[140:143], v[168:171], v[72:75]
    buffer_load_dwordx4 v[156:159], v238, s[20:23], s50 offen offset:3072 sc1
    v_mfma_f32_16x16x32_bf16 v[76:79], a[140:143], v[172:175], v[76:79]
    v_mfma_f32_16x16x32_bf16 v[80:83], a[144:147], v[160:163], v[80:83]
    ds_read_b64_tr_b16 a[140:141], v231 offset:32776
    v_mfma_f32_16x16x32_bf16 v[84:87], a[144:147], v[164:167], v[84:87]
    ds_read_b64_tr_b16 a[142:143], v231 offset:33800
    s_add_u32 m0, s55, 0
    v_mfma_f32_16x16x32_bf16 v[88:91], a[144:147], v[168:171], v[88:91]
    buffer_load_dwordx4 v239, s[36:39], s51 offen lds
    v_mfma_f32_16x16x32_bf16 v[92:95], a[144:147], v[172:175], v[92:95]
    v_mfma_f32_16x16x32_bf16 v[96:99], a[148:151], v[160:163], v[96:99]
    ds_read_b64_tr_b16 a[144:145], v232 offset:32768
    v_mfma_f32_16x16x32_bf16 v[100:103], a[148:151], v[164:167], v[100:103]
    ds_read_b64_tr_b16 a[146:147], v232 offset:33792
    v_mfma_f32_16x16x32_bf16 v[104:107], a[148:151], v[168:171], v[104:107]
    buffer_load_dwordx4 v240, s[36:39], s51 offen offset:1024 lds
    v_mfma_f32_16x16x32_bf16 v[108:111], a[148:151], v[172:175], v[108:111]
    v_mfma_f32_16x16x32_bf16 v[112:115], a[152:155], v[160:163], v[112:115]
    ds_read_b64_tr_b16 a[148:149], v232 offset:32776
    v_mfma_f32_16x16x32_bf16 v[116:119], a[152:155], v[164:167], v[116:119]
    ds_read_b64_tr_b16 a[150:151], v232 offset:33800
    s_add_u32 m0, s56, 0
    v_mfma_f32_16x16x32_bf16 v[120:123], a[152:155], v[168:171], v[120:123]
    buffer_load_dwordx4 v241, s[40:43], s52 offen lds
    v_mfma_f32_16x16x32_bf16 v[124:127], a[152:155], v[172:175], v[124:127]
    v_mfma_f32_16x16x32_bf16 v[128:131], a[156:159], v[160:163], v[128:131]
    ds_read_b64_tr_b16 a[152:153], v233 offset:32768
    v_mfma_f32_16x16x32_bf16 v[132:135], a[156:159], v[164:167], v[132:135]
    ds_read_b64_tr_b16 a[154:155], v233 offset:33792
    s_add_u32 m0, s57, 0
    v_mfma_f32_16x16x32_bf16 v[136:139], a[156:159], v[168:171], v[136:139]
    buffer_load_dwordx4 v241, s[44:47], s52 offen lds
    v_mfma_f32_16x16x32_bf16 v[140:143], a[156:159], v[172:175], v[140:143]
    s_waitcnt lgkmcnt(15)
    v_mfma_f32_16x16x32_bf16 a[0:3], a[160:163], v[160:163], a[0:3]
    ds_read_b64_tr_b16 a[156:157], v233 offset:32776
    v_mfma_f32_16x16x32_bf16 a[4:7], a[160:163], v[164:167], a[4:7]
    ds_read_b64_tr_b16 a[158:159], v233 offset:33800
    v_mfma_f32_16x16x32_bf16 a[8:11], a[160:163], v[168:171], a[8:11]
    v_mfma_f32_16x16x32_bf16 a[12:15], a[160:163], v[172:175], a[12:15]
    v_mfma_f32_16x16x32_bf16 a[16:19], a[164:167], v[160:163], a[16:19]
    ds_read_b64_tr_b16 a[160:161], v234 offset:40960
    v_mfma_f32_16x16x32_bf16 a[20:23], a[164:167], v[164:167], a[20:23]
    ds_read_b64_tr_b16 a[162:163], v234 offset:41472
    v_mfma_f32_16x16x32_bf16 a[24:27], a[164:167], v[168:171], a[24:27]
    v_mfma_f32_16x16x32_bf16 a[28:31], a[164:167], v[172:175], a[28:31]
    v_mfma_f32_16x16x32_bf16 a[32:35], a[168:171], v[160:163], a[32:35]
    ds_read_b64_tr_b16 a[164:165], v235 offset:40960
    v_mfma_f32_16x16x32_bf16 a[36:39], a[168:171], v[164:167], a[36:39]
    ds_read_b64_tr_b16 a[166:167], v235 offset:41472
    v_mfma_f32_16x16x32_bf16 a[40:43], a[168:171], v[168:171], a[40:43]
    v_mfma_f32_16x16x32_bf16 a[44:47], a[168:171], v[172:175], a[44:47]
    v_mfma_f32_16x16x32_bf16 a[48:51], a[172:175], v[160:163], a[48:51]
    ds_read_b64_tr_b16 a[168:169], v236 offset:40960
    v_mfma_f32_16x16x32_bf16 a[52:55], a[172:175], v[164:167], a[52:55]
    ds_read_b64_tr_b16 a[170:171], v236 offset:41472
    v_mfma_f32_16x16x32_bf16 a[56:59], a[172:175], v[168:171], a[56:59]
    v_mfma_f32_16x16x32_bf16 a[60:63], a[172:175], v[172:175], a[60:63]
    s_waitcnt lgkmcnt(15)
    v_mfma_f32_16x16x32_bf16 a[64:67], a[176:179], v[160:163], a[64:67]
    ds_read_b64_tr_b16 a[172:173], v237 offset:40960
    s_add_u32 s50, s50, 16384
    v_mfma_f32_16x16x32_bf16 a[68:71], a[176:179], v[164:167], a[68:71]
    ds_read_b64_tr_b16 a[174:175], v237 offset:41472
    s_add_u32 s51, s51, 262144
    v_mfma_f32_16x16x32_bf16 a[72:75], a[176:179], v[168:171], a[72:75]
    s_add_u32 s52, s52, 114688
    v_mfma_f32_16x16x32_bf16 a[76:79], a[176:179], v[172:175], a[76:79]
    v_mfma_f32_16x16x32_bf16 a[80:83], a[180:183], v[160:163], a[80:83]
    ds_read_b64_tr_b16 a[176:177], v234 offset:45056
    v_mfma_f32_16x16x32_bf16 a[84:87], a[180:183], v[164:167], a[84:87]
    ds_read_b64_tr_b16 a[178:179], v234 offset:45568
    v_mfma_f32_16x16x32_bf16 a[88:91], a[180:183], v[168:171], a[88:91]
    v_mfma_f32_16x16x32_bf16 a[92:95], a[180:183], v[172:175], a[92:95]
    v_mfma_f32_16x16x32_bf16 a[96:99], a[184:187], v[160:163], a[96:99]
    ds_read_b64_tr_b16 a[180:181], v235 offset:45056
    v_mfma_f32_16x16x32_bf16 a[100:103], a[184:187], v[164:167], a[100:103]
    ds_read_b64_tr_b16 a[182:183], v235 offset:45568
    v_mfma_f32_16x16x32_bf16 a[104:107], a[184:187], v[168:171], a[104:107]
    v_mfma_f32_16x16x32_bf16 a[108:111], a[184:187], v[172:175], a[108:111]
    v_mfma_f32_16x16x32_bf16 a[112:115], a[188:191], v[160:163], a[112:115]
    ds_read_b64_tr_b16 a[184:185], v236 offset:45056
    v_mfma_f32_16x16x32_bf16 a[116:119], a[188:191], v[164:167], a[116:119]
    ds_read_b64_tr_b16 a[186:187], v236 offset:45568
    v_mfma_f32_16x16x32_bf16 a[120:123], a[188:191], v[168:171], a[120:123]
    v_mfma_f32_16x16x32_bf16 a[124:127], a[188:191], v[172:175], a[124:127]
    ds_read_b64_tr_b16 a[188:189], v237 offset:45056
    ds_read_b64_tr_b16 a[190:191], v237 offset:45568
    s_waitcnt vmcnt(8) lgkmcnt(15)
    s_barrier
    v_mfma_f32_16x16x32_bf16 v[16:19], a[128:131], v[176:179], v[16:19]
    v_mfma_f32_16x16x32_bf16 v[20:23], a[128:131], v[180:183], v[20:23]
    v_mfma_f32_16x16x32_bf16 v[24:27], a[128:131], v[184:187], v[24:27]
    buffer_load_dwordx4 v[160:163], v238, s[20:23], s50 offen offset:0 sc1
    v_mfma_f32_16x16x32_bf16 v[28:31], a[128:131], v[188:191], v[28:31]
    v_mfma_f32_16x16x32_bf16 v[32:35], a[132:135], v[176:179], v[32:35]
    ds_read_b64_tr_b16 a[128:129], v230 offset:49152
    v_mfma_f32_16x16x32_bf16 v[36:39], a[132:135], v[180:183], v[36:39]
    ds_read_b64_tr_b16 a[130:131], v230 offset:50176
    v_mfma_f32_16x16x32_bf16 v[40:43], a[132:135], v[184:187], v[40:43]
    buffer_load_dwordx4 v[164:167], v238, s[20:23], s50 offen offset:1024 sc1
    v_mfma_f32_16x16x32_bf16 v[44:47], a[132:135], v[188:191], v[44:47]
    v_mfma_f32_16x16x32_bf16 v[48:51], a[136:139], v[176:179], v[48:51]
    ds_read_b64_tr_b16 a[132:133], v230 offset:49160
    v_mfma_f32_16x16x32_bf16 v[52:55], a[136:139], v[180:183], v[52:55]
    ds_read_b64_tr_b16 a[134:135], v230 offset:50184
    v_mfma_f32_16x16x32_bf16 v[56:59], a[136:139], v[184:187], v[56:59]
    buffer_load_dwordx4 v[168:171], v238, s[20:23], s50 offen offset:2048 sc1
    v_mfma_f32_16x16x32_bf16 v[60:63], a[136:139], v[188:191], v[60:63]
    v_mfma_f32_16x16x32_bf16 v[64:67], a[140:143], v[176:179], v[64:67]
    ds_read_b64_tr_b16 a[136:137], v231 offset:49152
    v_mfma_f32_16x16x32_bf16 v[68:71], a[140:143], v[180:183], v[68:71]
    ds_read_b64_tr_b16 a[138:139], v231 offset:50176
    v_mfma_f32_16x16x32_bf16 v[72:75], a[140:143], v[184:187], v[72:75]
    buffer_load_dwordx4 v[172:175], v238, s[20:23], s50 offen offset:3072 sc1
    v_mfma_f32_16x16x32_bf16 v[76:79], a[140:143], v[188:191], v[76:79]
    v_mfma_f32_16x16x32_bf16 v[80:83], a[144:147], v[176:179], v[80:83]
    ds_read_b64_tr_b16 a[140:141], v231 offset:49160
    v_mfma_f32_16x16x32_bf16 v[84:87], a[144:147], v[180:183], v[84:87]
    ds_read_b64_tr_b16 a[142:143], v231 offset:50184
    s_add_u32 m0, s55, 16384
    v_mfma_f32_16x16x32_bf16 v[88:91], a[144:147], v[184:187], v[88:91]
    buffer_load_dwordx4 v239, s[36:39], s51 offen lds
    v_mfma_f32_16x16x32_bf16 v[92:95], a[144:147], v[188:191], v[92:95]
    v_mfma_f32_16x16x32_bf16 v[96:99], a[148:151], v[176:179], v[96:99]
    ds_read_b64_tr_b16 a[144:145], v232 offset:49152
    v_mfma_f32_16x16x32_bf16 v[100:103], a[148:151], v[180:183], v[100:103]
    ds_read_b64_tr_b16 a[146:147], v232 offset:50176
    v_mfma_f32_16x16x32_bf16 v[104:107], a[148:151], v[184:187], v[104:107]
    buffer_load_dwordx4 v240, s[36:39], s51 offen offset:1024 lds
    v_mfma_f32_16x16x32_bf16 v[108:111], a[148:151], v[188:191], v[108:111]
    v_mfma_f32_16x16x32_bf16 v[112:115], a[152:155], v[176:179], v[112:115]
    ds_read_b64_tr_b16 a[148:149], v232 offset:49160
    v_mfma_f32_16x16x32_bf16 v[116:119], a[152:155], v[180:183], v[116:119]
    ds_read_b64_tr_b16 a[150:151], v232 offset:50184
    s_add_u32 m0, s56, 16384
    v_mfma_f32_16x16x32_bf16 v[120:123], a[152:155], v[184:187], v[120:123]
    buffer_load_dwordx4 v241, s[40:43], s52 offen lds
    v_mfma_f32_16x16x32_bf16 v[124:127], a[152:155], v[188:191], v[124:127]
    v_mfma_f32_16x16x32_bf16 v[128:131], a[156:159], v[176:179], v[128:131]
    ds_read_b64_tr_b16 a[152:153], v233 offset:49152
    v_mfma_f32_16x16x32_bf16 v[132:135], a[156:159], v[180:183], v[132:135]
    ds_read_b64_tr_b16 a[154:155], v233 offset:50176
    s_add_u32 m0, s57, 16384
    v_mfma_f32_16x16x32_bf16 v[136:139], a[156:159], v[184:187], v[136:139]
    buffer_load_dwordx4 v241, s[44:47], s52 offen lds
    v_mfma_f32_16x16x32_bf16 v[140:143], a[156:159], v[188:191], v[140:143]
    s_waitcnt lgkmcnt(15)
    v_mfma_f32_16x16x32_bf16 a[0:3], a[160:163], v[176:179], a[0:3]
    ds_read_b64_tr_b16 a[156:157], v233 offset:49160
    v_mfma_f32_16x16x32_bf16 a[4:7], a[160:163], v[180:183], a[4:7]
    ds_read_b64_tr_b16 a[158:159], v233 offset:50184
    v_mfma_f32_16x16x32_bf16 a[8:11], a[160:163], v[184:187], a[8:11]
    v_mfma_f32_16x16x32_bf16 a[12:15], a[160:163], v[188:191], a[12:15]
    v_mfma_f32_16x16x32_bf16 a[16:19], a[164:167], v[176:179], a[16:19]
    ds_read_b64_tr_b16 a[160:161], v234 offset:57344
    v_mfma_f32_16x16x32_bf16 a[20:23], a[164:167], v[180:183], a[20:23]
    ds_read_b64_tr_b16 a[162:163], v234 offset:57856
    v_mfma_f32_16x16x32_bf16 a[24:27], a[164:167], v[184:187], a[24:27]
    v_mfma_f32_16x16x32_bf16 a[28:31], a[164:167], v[188:191], a[28:31]
    v_mfma_f32_16x16x32_bf16 a[32:35], a[168:171], v[176:179], a[32:35]
    ds_read_b64_tr_b16 a[164:165], v235 offset:57344
    v_mfma_f32_16x16x32_bf16 a[36:39], a[168:171], v[180:183], a[36:39]
    ds_read_b64_tr_b16 a[166:167], v235 offset:57856
    v_mfma_f32_16x16x32_bf16 a[40:43], a[168:171], v[184:187], a[40:43]
    v_mfma_f32_16x16x32_bf16 a[44:47], a[168:171], v[188:191], a[44:47]
    v_mfma_f32_16x16x32_bf16 a[48:51], a[172:175], v[176:179], a[48:51]
    ds_read_b64_tr_b16 a[168:169], v236 offset:57344
    v_mfma_f32_16x16x32_bf16 a[52:55], a[172:175], v[180:183], a[52:55]
    ds_read_b64_tr_b16 a[170:171], v236 offset:57856
    v_mfma_f32_16x16x32_bf16 a[56:59], a[172:175], v[184:187], a[56:59]
    v_mfma_f32_16x16x32_bf16 a[60:63], a[172:175], v[188:191], a[60:63]
    s_waitcnt lgkmcnt(15)
    v_mfma_f32_16x16x32_bf16 a[64:67], a[176:179], v[176:179], a[64:67]
    ds_read_b64_tr_b16 a[172:173], v237 offset:57344
    s_add_u32 s50, s50, 16384
    v_mfma_f32_16x16x32_bf16 a[68:71], a[176:179], v[180:183], a[68:71]
    ds_read_b64_tr_b16 a[174:175], v237 offset:57856
    s_add_u32 s51, s51, 262144
    v_mfma_f32_16x16x32_bf16 a[72:75], a[176:179], v[184:187], a[72:75]
    s_add_u32 s52, s52, 114688
    v_mfma_f32_16x16x32_bf16 a[76:79], a[176:179], v[188:191], a[76:79]
    v_mfma_f32_16x16x32_bf16 a[80:83], a[180:183], v[176:179], a[80:83]
    ds_read_b64_tr_b16 a[176:177], v234 offset:61440
    v_mfma_f32_16x16x32_bf16 a[84:87], a[180:183], v[180:183], a[84:87]
    ds_read_b64_tr_b16 a[178:179], v234 offset:61952
    v_mfma_f32_16x16x32_bf16 a[88:91], a[180:183], v[184:187], a[88:91]
    v_mfma_f32_16x16x32_bf16 a[92:95], a[180:183], v[188:191], a[92:95]
    v_mfma_f32_16x16x32_bf16 a[96:99], a[184:187], v[176:179], a[96:99]
    ds_read_b64_tr_b16 a[180:181], v235 offset:61440
    v_mfma_f32_16x16x32_bf16 a[100:103], a[184:187], v[180:183], a[100:103]
    ds_read_b64_tr_b16 a[182:183], v235 offset:61952
    v_mfma_f32_16x16x32_bf16 a[104:107], a[184:187], v[184:187], a[104:107]
    v_mfma_f32_16x16x32_bf16 a[108:111], a[184:187], v[188:191], a[108:111]
    v_mfma_f32_16x16x32_bf16 a[112:115], a[188:191], v[176:179], a[112:115]
    ds_read_b64_tr_b16 a[184:185], v236 offset:61440
    v_mfma_f32_16x16x32_bf16 a[116:119], a[188:191], v[180:183], a[116:119]
    ds_read_b64_tr_b16 a[186:187], v236 offset:61952
    v_mfma_f32_16x16x32_bf16 a[120:123], a[188:191], v[184:187], a[120:123]
    v_mfma_f32_16x16x32_bf16 a[124:127], a[188:191], v[188:191], a[124:127]
    ds_read_b64_tr_b16 a[188:189], v237 offset:61440
    ds_read_b64_tr_b16 a[190:191], v237 offset:61952
    s_waitcnt vmcnt(8) lgkmcnt(15)
    s_barrier
    v_mfma_f32_16x16x32_bf16 v[16:19], a[128:131], v[192:195], v[16:19]
    v_mfma_f32_16x16x32_bf16 v[20:23], a[128:131], v[196:199], v[20:23]
    v_mfma_f32_16x16x32_bf16 v[24:27], a[128:131], v[200:203], v[24:27]
    buffer_load_dwordx4 v[176:179], v238, s[20:23], s50 offen offset:0 sc1
    v_mfma_f32_16x16x32_bf16 v[28:31], a[128:131], v[204:207], v[28:31]
    v_mfma_f32_16x16x32_bf16 v[32:35], a[132:135], v[192:195], v[32:35]
    ds_read_b64_tr_b16 a[128:129], v230 offset:0
    v_mfma_f32_16x16x32_bf16 v[36:39], a[132:135], v[196:199], v[36:39]
    ds_read_b64_tr_b16 a[130:131], v230 offset:1024
    v_mfma_f32_16x16x32_bf16 v[40:43], a[132:135], v[200:203], v[40:43]
    buffer_load_dwordx4 v[180:183], v238, s[20:23], s50 offen offset:1024 sc1
    v_mfma_f32_16x16x32_bf16 v[44:47], a[132:135], v[204:207], v[44:47]
    v_mfma_f32_16x16x32_bf16 v[48:51], a[136:139], v[192:195], v[48:51]
    ds_read_b64_tr_b16 a[132:133], v230 offset:8
    v_mfma_f32_16x16x32_bf16 v[52:55], a[136:139], v[196:199], v[52:55]
    ds_read_b64_tr_b16 a[134:135], v230 offset:1032
    v_mfma_f32_16x16x32_bf16 v[56:59], a[136:139], v[200:203], v[56:59]
    buffer_load_dwordx4 v[184:187], v238, s[20:23], s50 offen offset:2048 sc1
    v_mfma_f32_16x16x32_bf16 v[60:63], a[136:139], v[204:207], v[60:63]
    v_mfma_f32_16x16x32_bf16 v[64:67], a[140:143], v[192:195], v[64:67]
    ds_read_b64_tr_b16 a[136:137], v231 offset:0
    v_mfma_f32_16x16x32_bf16 v[68:71], a[140:143], v[196:199], v[68:71]
    ds_read_b64_tr_b16 a[138:139], v231 offset:1024
    v_mfma_f32_16x16x32_bf16 v[72:75], a[140:143], v[200:203], v[72:75]
    buffer_load_dwordx4 v[188:191], v238, s[20:23], s50 offen offset:3072 sc1
    v_mfma_f32_16x16x32_bf16 v[76:79], a[140:143], v[204:207], v[76:79]
    v_mfma_f32_16x16x32_bf16 v[80:83], a[144:147], v[192:195], v[80:83]
    ds_read_b64_tr_b16 a[140:141], v231 offset:8
    v_mfma_f32_16x16x32_bf16 v[84:87], a[144:147], v[196:199], v[84:87]
    ds_read_b64_tr_b16 a[142:143], v231 offset:1032
    s_add_u32 m0, s55, 32768
    v_mfma_f32_16x16x32_bf16 v[88:91], a[144:147], v[200:203], v[88:91]
    buffer_load_dwordx4 v239, s[36:39], s51 offen lds
    v_mfma_f32_16x16x32_bf16 v[92:95], a[144:147], v[204:207], v[92:95]
    v_mfma_f32_16x16x32_bf16 v[96:99], a[148:151], v[192:195], v[96:99]
    ds_read_b64_tr_b16 a[144:145], v232 offset:0
    v_mfma_f32_16x16x32_bf16 v[100:103], a[148:151], v[196:199], v[100:103]
    ds_read_b64_tr_b16 a[146:147], v232 offset:1024
    v_mfma_f32_16x16x32_bf16 v[104:107], a[148:151], v[200:203], v[104:107]
    buffer_load_dwordx4 v240, s[36:39], s51 offen offset:1024 lds
    v_mfma_f32_16x16x32_bf16 v[108:111], a[148:151], v[204:207], v[108:111]
    v_mfma_f32_16x16x32_bf16 v[112:115], a[152:155], v[192:195], v[112:115]
    ds_read_b64_tr_b16 a[148:149], v232 offset:8
    v_mfma_f32_16x16x32_bf16 v[116:119], a[152:155], v[196:199], v[116:119]
    ds_read_b64_tr_b16 a[150:151], v232 offset:1032
    s_add_u32 m0, s56, 32768
    v_mfma_f32_16x16x32_bf16 v[120:123], a[152:155], v[200:203], v[120:123]
    buffer_load_dwordx4 v241, s[40:43], s52 offen lds
    v_mfma_f32_16x16x32_bf16 v[124:127], a[152:155], v[204:207], v[124:127]
    v_mfma_f32_16x16x32_bf16 v[128:131], a[156:159], v[192:195], v[128:131]
    ds_read_b64_tr_b16 a[152:153], v233 offset:0
    v_mfma_f32_16x16x32_bf16 v[132:135], a[156:159], v[196:199], v[132:135]
    ds_read_b64_tr_b16 a[154:155], v233 offset:1024
    s_add_u32 m0, s57, 32768
    v_mfma_f32_16x16x32_bf16 v[136:139], a[156:159], v[200:203], v[136:139]
    buffer_load_dwordx4 v241, s[44:47], s52 offen lds
    v_mfma_f32_16x16x32_bf16 v[140:143], a[156:159], v[204:207], v[140:143]
    s_waitcnt lgkmcnt(15)
    v_mfma_f32_16x16x32_bf16 a[0:3], a[160:163], v[192:195], a[0:3]
    ds_read_b64_tr_b16 a[156:157], v233 offset:8
    v_mfma_f32_16x16x32_bf16 a[4:7], a[160:163], v[196:199], a[4:7]
    ds_read_b64_tr_b16 a[158:159], v233 offset:1032
    v_mfma_f32_16x16x32_bf16 a[8:11], a[160:163], v[200:203], a[8:11]
    v_mfma_f32_16x16x32_bf16 a[12:15], a[160:163], v[204:207], a[12:15]
    v_mfma_f32_16x16x32_bf16 a[16:19], a[164:167], v[192:195], a[16:19]
    ds_read_b64_tr_b16 a[160:161], v234 offset:8192
    v_mfma_f32_16x16x32_bf16 a[20:23], a[164:167], v[196:199], a[20:23]
    ds_read_b64_tr_b16 a[162:163], v234 offset:8704
    v_mfma_f32_16x16x32_bf16 a[24:27], a[164:167], v[200:203], a[24:27]
    v_mfma_f32_16x16x32_bf16 a[28:31], a[164:167], v[204:207], a[28:31]
    v_mfma_f32_16x16x32_bf16 a[32:35], a[168:171], v[192:195], a[32:35]
    ds_read_b64_tr_b16 a[164:165], v235 offset:8192
    v_mfma_f32_16x16x32_bf16 a[36:39], a[168:171], v[196:199], a[36:39]
    ds_read_b64_tr_b16 a[166:167], v235 offset:8704
    v_mfma_f32_16x16x32_bf16 a[40:43], a[168:171], v[200:203], a[40:43]
    v_mfma_f32_16x16x32_bf16 a[44:47], a[168:171], v[204:207], a[44:47]
    v_mfma_f32_16x16x32_bf16 a[48:51], a[172:175], v[192:195], a[48:51]
    ds_read_b64_tr_b16 a[168:169], v236 offset:8192
    v_mfma_f32_16x16x32_bf16 a[52:55], a[172:175], v[196:199], a[52:55]
    ds_read_b64_tr_b16 a[170:171], v236 offset:8704
    v_mfma_f32_16x16x32_bf16 a[56:59], a[172:175], v[200:203], a[56:59]
    v_mfma_f32_16x16x32_bf16 a[60:63], a[172:175], v[204:207], a[60:63]
    s_waitcnt lgkmcnt(15)
    v_mfma_f32_16x16x32_bf16 a[64:67], a[176:179], v[192:195], a[64:67]
    ds_read_b64_tr_b16 a[172:173], v237 offset:8192
    s_add_u32 s50, s50, 16384
    v_mfma_f32_16x16x32_bf16 a[68:71], a[176:179], v[196:199], a[68:71]
    ds_read_b64_tr_b16 a[174:175], v237 offset:8704
    s_add_u32 s51, s51, 262144
    v_mfma_f32_16x16x32_bf16 a[72:75], a[176:179], v[200:203], a[72:75]
    s_add_u32 s52, s52, 114688
    v_mfma_f32_16x16x32_bf16 a[76:79], a[176:179], v[204:207], a[76:79]
    v_mfma_f32_16x16x32_bf16 a[80:83], a[180:183], v[192:195], a[80:83]
    ds_read_b64_tr_b16 a[176:177], v234 offset:12288
    v_mfma_f32_16x16x32_bf16 a[84:87], a[180:183], v[196:199], a[84:87]
    ds_read_b64_tr_b16 a[178:179], v234 offset:12800
    v_mfma_f32_16x16x32_bf16 a[88:91], a[180:183], v[200:203], a[88:91]
    v_mfma_f32_16x16x32_bf16 a[92:95], a[180:183], v[204:207], a[92:95]
    v_mfma_f32_16x16x32_bf16 a[96:99], a[184:187], v[192:195], a[96:99]
    ds_read_b64_tr_b16 a[180:181], v235 offset:12288
    v_mfma_f32_16x16x32_bf16 a[100:103], a[184:187], v[196:199], a[100:103]
    ds_read_b64_tr_b16 a[182:183], v235 offset:12800
    v_mfma_f32_16x16x32_bf16 a[104:107], a[184:187], v[200:203], a[104:107]
    v_mfma_f32_16x16x32_bf16 a[108:111], a[184:187], v[204:207], a[108:111]
    v_mfma_f32_16x16x32_bf16 a[112:115], a[188:191], v[192:195], a[112:115]
    ds_read_b64_tr_b16 a[184:185], v236 offset:12288
    v_mfma_f32_16x16x32_bf16 a[116:119], a[188:191], v[196:199], a[116:119]
    ds_read_b64_tr_b16 a[186:187], v236 offset:12800
    v_mfma_f32_16x16x32_bf16 a[120:123], a[188:191], v[200:203], a[120:123]
    v_mfma_f32_16x16x32_bf16 a[124:127], a[188:191], v[204:207], a[124:127]
    ds_read_b64_tr_b16 a[188:189], v237 offset:12288
    ds_read_b64_tr_b16 a[190:191], v237 offset:12800
    s_sub_u32 s26, s26, 1
    s_cmp_lg_u32 s26, 0
    s_cbranch_scc1 K_gloop
    s_waitcnt vmcnt(8) lgkmcnt(15)
    s_barrier
    v_mfma_f32_16x16x32_bf16 v[16:19], a[128:131], v[144:147], v[16:19]
    v_mfma_f32_16x16x32_bf16 v[20:23], a[128:131], v[148:151], v[20:23]
    v_mfma_f32_16x16x32_bf16 v[24:27], a[128:131], v[152:155], v[24:27]
    buffer_load_dwordx4 v[192:195], v238, s[20:23], s50 offen offset:0 sc1
    v_mfma_f32_16x16x32_bf16 v[28:31], a[128:131], v[156:159], v[28:31]
    v_mfma_f32_16x16x32_bf16 v[32:35], a[132:135], v[144:147], v[32:35]
    ds_read_b64_tr_b16 a[128:129], v230 offset:16384
    v_mfma_f32_16x16x32_bf16 v[36:39], a[132:135], v[148:151], v[36:39]
    ds_read_b64_tr_b16 a[130:131], v230 offset:17408
    v_mfma_f32_16x16x32_bf16 v[40:43], a[132:135], v[152:155], v[40:43]
    buffer_load_dwordx4 v[196:199], v238, s[20:23], s50 offen offset:1024 sc1
    v_mfma_f32_16x16x32_bf16 v[44:47], a[132:135], v[156:159], v[44:47]
    v_mfma_f32_16x16x32_bf16 v[48:51], a[136:139], v[144:147], v[48:51]
    ds_read_b64_tr_b16 a[132:133], v230 offset:16392
    v_mfma_f32_16x16x32_bf16 v[52:55], a[136:139], v[148:151], v[52:55]
    ds_read_b64_tr_b16 a[134:135], v230 offset:17416
    v_mfma_f32_16x16x32_bf16 v[56:59], a[136:139], v[152:155], v[56:59]
    buffer_load_dwordx4 v[200:203], v238, s[20:23], s50 offen offset:2048 sc1
    v_mfma_f32_16x16x32_bf16 v[60:63], a[136:139], v[156:159], v[60:63]
    v_mfma_f32_16x16x32_bf16 v[64:67], a[140:143], v[144:147], v[64:67]
    ds_read_b64_tr_b16 a[136:137], v231 offset:16384
    v_mfma_f32_16x16x32_bf16 v[68:71], a[140:143], v[148:151], v[68:71]
    ds_read_b64_tr_b16 a[138:139], v231 offset:17408
    v_mfma_f32_16x16x32_bf16 v[72:75], a[140:143], v[152:155], v[72:75]
    buffer_load_dwordx4 v[204:207], v238, s[20:23], s50 offen offset:3072 sc1
    v_mfma_f32_16x16x32_bf16 v[76:79], a[140:143], v[156:159], v[76:79]
    v_mfma_f32_16x16x32_bf16 v[80:83], a[144:147], v[144:147], v[80:83]
    ds_read_b64_tr_b16 a[140:141], v231 offset:16392
    v_mfma_f32_16x16x32_bf16 v[84:87], a[144:147], v[148:151], v[84:87]
    ds_read_b64_tr_b16 a[142:143], v231 offset:17416
    s_add_u32 m0, s55, 49152
    v_mfma_f32_16x16x32_bf16 v[88:91], a[144:147], v[152:155], v[88:91]
    buffer_load_dwordx4 v239, s[36:39], s51 offen lds
    v_mfma_f32_16x16x32_bf16 v[92:95], a[144:147], v[156:159], v[92:95]
    v_mfma_f32_16x16x32_bf16 v[96:99], a[148:151], v[144:147], v[96:99]
    ds_read_b64_tr_b16 a[144:145], v232 offset:16384
    v_mfma_f32_16x16x32_bf16 v[100:103], a[148:151], v[148:151], v[100:103]
    ds_read_b64_tr_b16 a[146:147], v232 offset:17408
    v_mfma_f32_16x16x32_bf16 v[104:107], a[148:151], v[152:155], v[104:107]
    buffer_load_dwordx4 v240, s[36:39], s51 offen offset:1024 lds
    v_mfma_f32_16x16x32_bf16 v[108:111], a[148:151], v[156:159], v[108:111]
    v_mfma_f32_16x16x32_bf16 v[112:115], a[152:155], v[144:147], v[112:115]
    ds_read_b64_tr_b16 a[148:149], v232 offset:16392
    v_mfma_f32_16x16x32_bf16 v[116:119], a[152:155], v[148:151], v[116:119]
    ds_read_b64_tr_b16 a[150:151], v232 offset:17416
    s_add_u32 m0, s56, 49152
    v_mfma_f32_16x16x32_bf16 v[120:123], a[152:155], v[152:155], v[120:123]
    buffer_load_dwordx4 v241, s[40:43], s52 offen lds
    v_mfma_f32_16x16x32_bf16 v[124:127], a[152:155], v[156:159], v[124:127]
    v_mfma_f32_16x16x32_bf16 v[128:131], a[156:159], v[144:147], v[128:131]
    ds_read_b64_tr_b16 a[152:153], v233 offset:16384
    v_mfma_f32_16x16x32_bf16 v[132:135], a[156:159], v[148:151], v[132:135]
    ds_read_b64_tr_b16 a[154:155], v233 offset:17408
    s_add_u32 m0, s57, 49152
    v_mfma_f32_16x16x32_bf16 v[136:139], a[156:159], v[152:155], v[136:139]
    buffer_load_dwordx4 v241, s[44:47], s52 offen lds
    v_mfma_f32_16x16x32_bf16 v[140:143], a[156:159], v[156:159], v[140:143]
    s_waitcnt lgkmcnt(15)
    v_mfma_f32_16x16x32_bf16 a[0:3], a[160:163], v[144:147], a[0:3]
    ds_read_b64_tr_b16 a[156:157], v233 offset:16392
    v_mfma_f32_16x16x32_bf16 a[4:7], a[160:163], v[148:151], a[4:7]
    ds_read_b64_tr_b16 a[158:159], v233 offset:17416
    v_mfma_f32_16x16x32_bf16 a[8:11], a[160:163], v[152:155], a[8:11]
    v_mfma_f32_16x16x32_bf16 a[12:15], a[160:163], v[156:159], a[12:15]
    v_mfma_f32_16x16x32_bf16 a[16:19], a[164:167], v[144:147], a[16:19]
    ds_read_b64_tr_b16 a[160:161], v234 offset:24576
    v_mfma_f32_16x16x32_bf16 a[20:23], a[164:167], v[148:151], a[20:23]
    ds_read_b64_tr_b16 a[162:163], v234 offset:25088
    v_mfma_f32_16x16x32_bf16 a[24:27], a[164:167], v[152:155], a[24:27]
    v_mfma_f32_16x16x32_bf16 a[28:31], a[164:167], v[156:159], a[28:31]
    v_mfma_f32_16x16x32_bf16 a[32:35], a[168:171], v[144:147], a[32:35]
    ds_read_b64_tr_b16 a[164:165], v235 offset:24576
    v_mfma_f32_16x16x32_bf16 a[36:39], a[168:171], v[148:151], a[36:39]
    ds_read_b64_tr_b16 a[166:167], v235 offset:25088
    v_mfma_f32_16x16x32_bf16 a[40:43], a[168:171], v[152:155], a[40:43]
    v_mfma_f32_16x16x32_bf16 a[44:47], a[168:171], v[156:159], a[44:47]
    v_mfma_f32_16x16x32_bf16 a[48:51], a[172:175], v[144:147], a[48:51]
    ds_read_b64_tr_b16 a[168:169], v236 offset:24576
    v_mfma_f32_16x16x32_bf16 a[52:55], a[172:175], v[148:151], a[52:55]
    ds_read_b64_tr_b16 a[170:171], v236 offset:25088
    v_mfma_f32_16x16x32_bf16 a[56:59], a[172:175], v[152:155], a[56:59]
    v_mfma_f32_16x16x32_bf16 a[60:63], a[172:175], v[156:159], a[60:63]
    s_waitcnt lgkmcnt(15)
    v_mfma_f32_16x16x32_bf16 a[64:67], a[176:179], v[144:147], a[64:67]
    ds_read_b64_tr_b16 a[172:173], v237 offset:24576
    s_add_u32 s50, s50, 16384
    v_mfma_f32_16x16x32_bf16 a[68:71], a[176:179], v[148:151], a[68:71]
    ds_read_b64_tr_b16 a[174:175], v237 offset:25088
    s_add_u32 s51, s51, 262144
    v_mfma_f32_16x16x32_bf16 a[72:75], a[176:179], v[152:155], a[72:75]
    s_add_u32 s52, s52, 114688
    v_mfma_f32_16x16x32_bf16 a[76:79], a[176:179], v[156:159], a[76:79]
    v_mfma_f32_16x16x32_bf16 a[80:83], a[180:183], v[144:147], a[80:83]
    ds_read_b64_tr_b16 a[176:177], v234 offset:28672
    v_mfma_f32_16x16x32_bf16 a[84:87], a[180:183], v[148:151], a[84:87]
    ds_read_b64_tr_b16 a[178:179], v234 offset:29184
    v_mfma_f32_16x16x32_bf16 a[88:91], a[180:183], v[152:155], a[88:91]
    v_mfma_f32_16x16x32_bf16 a[92:95], a[180:183], v[156:159], a[92:95]
    v_mfma_f32_16x16x32_bf16 a[96:99], a[184:187], v[144:147], a[96:99]
    ds_read_b64_tr_b16 a[180:181], v235 offset:28672
    v_mfma_f32_16x16x32_bf16 a[100:103], a[184:187], v[148:151], a[100:103]
    ds_read_b64_tr_b16 a[182:183], v235 offset:29184
    v_mfma_f32_16x16x32_bf16 a[104:107], a[184:187], v[152:155], a[104:107]
    v_mfma_f32_16x16x32_bf16 a[108:111], a[184:187], v[156:159], a[108:111]
    v_mfma_f32_16x16x32_bf16 a[112:115], a[188:191], v[144:147], a[112:115]
    ds_read_b64_tr_b16 a[184:185], v236 offset:28672
    v_mfma_f32_16x16x32_bf16 a[116:119], a[188:191], v[148:151], a[116:119]
    ds_read_b64_tr_b16 a[186:187], v236 offset:29184
    v_mfma_f32_16x16x32_bf16 a[120:123], a[188:191], v[152:155], a[120:123]
    v_mfma_f32_16x16x32_bf16 a[124:127], a[188:191], v[156:159], a[124:127]
    ds_read_b64_tr_b16 a[188:189], v237 offset:28672
    ds_read_b64_tr_b16 a[190:191], v237 offset:29184
    s_mov_b32 s6, 0
    s_mov_b32 s7, 16384
    s_waitcnt vmcnt(8) lgkmcnt(15)
    s_barrier
    v_mfma_f32_16x16x32_bf16 v[16:19], a[128:131], v[160:163], v[16:19]
    v_mfma_f32_16x16x32_bf16 v[20:23], a[128:131], v[164:167], v[20:23]
    s_add_u32 m0, s25, 49152
    v_mfma_f32_16x16x32_bf16 v[24:27], a[128:131], v[168:171], v[24:27]
    buffer_load_dwordx4 v220, s[16:19], 0 offen lds
    v_mfma_f32_16x16x32_bf16 v[28:31], a[128:131], v[172:175], v[28:31]
    v_mfma_f32_16x16x32_bf16 v[32:35], a[132:135], v[160:163], v[32:35]
    ds_read_b64_tr_b16 a[128:129], v230 offset:32768
    v_mfma_f32_16x16x32_bf16 v[36:39], a[132:135], v[164:167], v[36:39]
    ds_read_b64_tr_b16 a[130:131], v230 offset:33792
    v_mfma_f32_16x16x32_bf16 v[40:43], a[132:135], v[168:171], v[40:43]
    buffer_load_dwordx4 v221, s[16:19], 0 offen offset:1024 lds
    v_mfma_f32_16x16x32_bf16 v[44:47], a[132:135], v[172:175], v[44:47]
    v_mfma_f32_16x16x32_bf16 v[48:51], a[136:139], v[160:163], v[48:51]
    ds_read_b64_tr_b16 a[132:133], v230 offset:32776
    v_mfma_f32_16x16x32_bf16 v[52:55], a[136:139], v[164:167], v[52:55]
    ds_read_b64_tr_b16 a[134:135], v230 offset:33800
    v_mfma_f32_16x16x32_bf16 v[56:59], a[136:139], v[168:171], v[56:59]
    buffer_load_dwordx4 v222, s[16:19], 0 offen offset:2048 lds
    v_mfma_f32_16x16x32_bf16 v[60:63], a[136:139], v[172:175], v[60:63]
    v_mfma_f32_16x16x32_bf16 v[64:67], a[140:143], v[160:163], v[64:67]
    ds_read_b64_tr_b16 a[136:137], v231 offset:32768
    v_mfma_f32_16x16x32_bf16 v[68:71], a[140:143], v[164:167], v[68:71]
    ds_read_b64_tr_b16 a[138:139], v231 offset:33792
    v_mfma_f32_16x16x32_bf16 v[72:75], a[140:143], v[168:171], v[72:75]
    buffer_load_dwordx4 v223, s[16:19], 0 offen offset:3072 lds
    v_mfma_f32_16x16x32_bf16 v[76:79], a[140:143], v[172:175], v[76:79]
    v_mfma_f32_16x16x32_bf16 v[80:83], a[144:147], v[160:163], v[80:83]
    ds_read_b64_tr_b16 a[140:141], v231 offset:32776
    v_mfma_f32_16x16x32_bf16 v[84:87], a[144:147], v[164:167], v[84:87]
    ds_read_b64_tr_b16 a[142:143], v231 offset:33800
    s_add_u32 m0, s25, 65536
    v_mfma_f32_16x16x32_bf16 v[88:91], a[144:147], v[168:171], v[88:91]
    buffer_load_dwordx4 v224, s[12:15], s6 offen lds
    v_mfma_f32_16x16x32_bf16 v[92:95], a[144:147], v[172:175], v[92:95]
    v_mfma_f32_16x16x32_bf16 v[96:99], a[148:151], v[160:163], v[96:99]
    ds_read_b64_tr_b16 a[144:145], v232 offset:32768
    v_mfma_f32_16x16x32_bf16 v[100:103], a[148:151], v[164:167], v[100:103]
    ds_read_b64_tr_b16 a[146:147], v232 offset:33792
    v_mfma_f32_16x16x32_bf16 v[104:107], a[148:151], v[168:171], v[104:107]
    buffer_load_dwordx4 v225, s[12:15], s6 offen offset:1024 lds
    v_mfma_f32_16x16x32_bf16 v[108:111], a[148:151], v[172:175], v[108:111]
    v_mfma_f32_16x16x32_bf16 v[112:115], a[152:155], v[160:163], v[112:115]
    ds_read_b64_tr_b16 a[148:149], v232 offset:32776
    v_mfma_f32_16x16x32_bf16 v[116:119], a[152:155], v[164:167], v[116:119]
    ds_read_b64_tr_b16 a[150:151], v232 offset:33800
    v_mfma_f32_16x16x32_bf16 v[120:123], a[152:155], v[168:171], v[120:123]
    buffer_load_dwordx4 v224, s[12:15], s6 offen offset:2048 lds
    v_mfma_f32_16x16x32_bf16 v[124:127], a[152:155], v[172:175], v[124:127]
    v_mfma_f32_16x16x32_bf16 v[128:131], a[156:159], v[160:163], v[128:131]
    ds_read_b64_tr_b16 a[152:153], v233 offset:32768
    v_mfma_f32_16x16x32_bf16 v[132:135], a[156:159], v[164:167], v[132:135]
    ds_read_b64_tr_b16 a[154:155], v233 offset:33792
    v_mfma_f32_16x16x32_bf16 v[136:139], a[156:159], v[168:171], v[136:139]
    buffer_load_dwordx4 v225, s[12:15], s6 offen offset:3072 lds
    v_mfma_f32_16x16x32_bf16 v[140:143], a[156:159], v[172:175], v[140:143]
    s_waitcnt lgkmcnt(15)
    v_mfma_f32_16x16x32_bf16 a[0:3], a[160:163], v[160:163], a[0:3]
    ds_read_b64_tr_b16 a[156:157], v233 offset:32776
    v_mfma_f32_16x16x32_bf16 a[4:7], a[160:163], v[164:167], a[4:7]
    ds_read_b64_tr_b16 a[158:159], v233 offset:33800
    v_mfma_f32_16x16x32_bf16 a[8:11], a[160:163], v[168:171], a[8:11]
    v_mfma_f32_16x16x32_bf16 a[12:15], a[160:163], v[172:175], a[12:15]
    v_mfma_f32_16x16x32_bf16 a[16:19], a[164:167], v[160:163], a[16:19]
    ds_read_b64_tr_b16 a[160:161], v234 offset:40960
    v_mfma_f32_16x16x32_bf16 a[20:23], a[164:167], v[164:167], a[20:23]
    ds_read_b64_tr_b16 a[162:163], v234 offset:41472
    v_mfma_f32_16x16x32_bf16 a[24:27], a[164:167], v[168:171], a[24:27]
    v_mfma_f32_16x16x32_bf16 a[28:31], a[164:167], v[172:175], a[28:31]
    v_mfma_f32_16x16x32_bf16 a[32:35], a[168:171], v[160:163], a[32:35]
    ds_read_b64_tr_b16 a[164:165], v235 offset:40960
    v_mfma_f32_16x16x32_bf16 a[36:39], a[168:171], v[164:167], a[36:39]
    ds_read_b64_tr_b16 a[166:167], v235 offset:41472
    v_mfma_f32_16x16x32_bf16 a[40:43], a[168:171], v[168:171], a[40:43]
    v_mfma_f32_16x16x32_bf16 a[44:47], a[168:171], v[172:175], a[44:47]
    v_mfma_f32_16x16x32_bf16 a[48:51], a[172:175], v[160:163], a[48:51]
    ds_read_b64_tr_b16 a[168:169], v236 offset:40960
    v_mfma_f32_16x16x32_bf16 a[52:55], a[172:175], v[164:167], a[52:55]
    ds_read_b64_tr_b16 a[170:171], v236 offset:41472
    v_mfma_f32_16x16x32_bf16 a[56:59], a[172:175], v[168:171], a[56:59]
    v_mfma_f32_16x16x32_bf16 a[60:63], a[172:175], v[172:175], a[60:63]
    s_waitcnt lgkmcnt(15)
    v_mfma_f32_16x16x32_bf16 a[64:67], a[176:179], v[160:163], a[64:67]
    ds_read_b64_tr_b16 a[172:173], v237 offset:40960
    v_mfma_f32_16x16x32_bf16 a[68:71], a[176:179], v[164:167], a[68:71]
    ds_read_b64_tr_b16 a[174:175], v237 offset:41472
    v_mfma_f32_16x16x32_bf16 a[72:75], a[176:179], v[168:171], a[72:75]
    v_mfma_f32_16x16x32_bf16 a[76:79], a[176:179], v[172:175], a[76:79]
    v_mfma_f32_16x16x32_bf16 a[80:83], a[180:183], v[160:163], a[80:83]
    ds_read_b64_tr_b16 a[176:177], v234 offset:45056
    v_mfma_f32_16x16x32_bf16 a[84:87], a[180:183], v[164:167], a[84:87]
    ds_read_b64_tr_b16 a[178:179], v234 offset:45568
    v_mfma_f32_16x16x32_bf16 a[88:91], a[180:183], v[168:171], a[88:91]
    v_mfma_f32_16x16x32_bf16 a[92:95], a[180:183], v[172:175], a[92:95]
    v_mfma_f32_16x16x32_bf16 a[96:99], a[184:187], v[160:163], a[96:99]
    ds_read_b64_tr_b16 a[180:181], v235 offset:45056
    v_mfma_f32_16x16x32_bf16 a[100:103], a[184:187], v[164:167], a[100:103]
    ds_read_b64_tr_b16 a[182:183], v235 offset:45568
    v_mfma_f32_16x16x32_bf16 a[104:107], a[184:187], v[168:171], a[104:107]
    v_mfma_f32_16x16x32_bf16 a[108:111], a[184:187], v[172:175], a[108:111]
    v_mfma_f32_16x16x32_bf16 a[112:115], a[188:191], v[160:163], a[112:115]
    ds_read_b64_tr_b16 a[184:185], v236 offset:45056
    v_mfma_f32_16x16x32_bf16 a[116:119], a[188:191], v[164:167], a[116:119]
    ds_read_b64_tr_b16 a[186:187], v236 offset:45568
    v_mfma_f32_16x16x32_bf16 a[120:123], a[188:191], v[168:171], a[120:123]
    v_mfma_f32_16x16x32_bf16 a[124:127], a[188:191], v[172:175], a[124:127]
    ds_read_b64_tr_b16 a[188:189], v237 offset:45056
    ds_read_b64_tr_b16 a[190:191], v237 offset:45568
    s_waitcnt vmcnt(8) lgkmcnt(15)
    s_barrier
    v_mfma_f32_16x16x32_bf16 v[16:19], a[128:131], v[176:179], v[16:19]
    v_mfma_f32_16x16x32_bf16 v[20:23], a[128:131], v[180:183], v[20:23]
    s_add_u32 m0, s25, 0
    v_mfma_f32_16x16x32_bf16 v[24:27], a[128:131], v[184:187], v[24:27]
    buffer_load_dwordx4 v220, s[8:11], s6 offen lds
    v_mfma_f32_16x16x32_bf16 v[28:31], a[128:131], v[188:191], v[28:31]
    v_mfma_f32_16x16x32_bf16 v[32:35], a[132:135], v[176:179], v[32:35]
    ds_read_b64_tr_b16 a[128:129], v230 offset:49152
    v_mfma_f32_16x16x32_bf16 v[36:39], a[132:135], v[180:183], v[36:39]
    ds_read_b64_tr_b16 a[130:131], v230 offset:50176
    v_mfma_f32_16x16x32_bf16 v[40:43], a[132:135], v[184:187], v[40:43]
    buffer_load_dwordx4 v221, s[8:11], s6 offen offset:1024 lds
    v_mfma_f32_16x16x32_bf16 v[44:47], a[132:135], v[188:191], v[44:47]
    v_mfma_f32_16x16x32_bf16 v[48:51], a[136:139], v[176:179], v[48:51]
    ds_read_b64_tr_b16 a[132:133], v230 offset:49160
    v_mfma_f32_16x16x32_bf16 v[52:55], a[136:139], v[180:183], v[52:55]
    ds_read_b64_tr_b16 a[134:135], v230 offset:50184
    v_mfma_f32_16x16x32_bf16 v[56:59], a[136:139], v[184:187], v[56:59]
    buffer_load_dwordx4 v222, s[8:11], s6 offen offset:2048 lds
    v_mfma_f32_16x16x32_bf16 v[60:63], a[136:139], v[188:191], v[60:63]
    v_mfma_f32_16x16x32_bf16 v[64:67], a[140:143], v[176:179], v[64:67]
    ds_read_b64_tr_b16 a[136:137], v231 offset:49152
    v_mfma_f32_16x16x32_bf16 v[68:71], a[140:143], v[180:183], v[68:71]
    ds_read_b64_tr_b16 a[138:139], v231 offset:50176
    v_mfma_f32_16x16x32_bf16 v[72:75], a[140:143], v[184:187], v[72:75]
    buffer_load_dwordx4 v223, s[8:11], s6 offen offset:3072 lds
    v_mfma_f32_16x16x32_bf16 v[76:79], a[140:143], v[188:191], v[76:79]
    v_mfma_f32_16x16x32_bf16 v[80:83], a[144:147], v[176:179], v[80:83]
    ds_read_b64_tr_b16 a[140:141], v231 offset:49160
    v_mfma_f32_16x16x32_bf16 v[84:87], a[144:147], v[180:183], v[84:87]
    ds_read_b64_tr_b16 a[142:143], v231 offset:50184
    s_add_u32 m0, s25, 81920
    v_mfma_f32_16x16x32_bf16 v[88:91], a[144:147], v[184:187], v[88:91]
    buffer_load_dwordx4 v224, s[12:15], s7 offen lds
    v_mfma_f32_16x16x32_bf16 v[92:95], a[144:147], v[188:191], v[92:95]
    v_mfma_f32_16x16x32_bf16 v[96:99], a[148:151], v[176:179], v[96:99]
    ds_read_b64_tr_b16 a[144:145], v232 offset:49152
    v_mfma_f32_16x16x32_bf16 v[100:103], a[148:151], v[180:183], v[100:103]
    ds_read_b64_tr_b16 a[146:147], v232 offset:50176
    v_mfma_f32_16x16x32_bf16 v[104:107], a[148:151], v[184:187], v[104:107]
    buffer_load_dwordx4 v225, s[12:15], s7 offen offset:1024 lds
    v_mfma_f32_16x16x32_bf16 v[108:111], a[148:151], v[188:191], v[108:111]
    v_mfma_f32_16x16x32_bf16 v[112:115], a[152:155], v[176:179], v[112:115]
    ds_read_b64_tr_b16 a[148:149], v232 offset:49160
    v_mfma_f32_16x16x32_bf16 v[116:119], a[152:155], v[180:183], v[116:119]
    ds_read_b64_tr_b16 a[150:151], v232 offset:50184
    v_mfma_f32_16x16x32_bf16 v[120:123], a[152:155], v[184:187], v[120:123]
    buffer_load_dwordx4 v224, s[12:15], s7 offen offset:2048 lds
    v_mfma_f32_16x16x32_bf16 v[124:127], a[152:155], v[188:191], v[124:127]
    v_mfma_f32_16x16x32_bf16 v[128:131], a[156:159], v[176:179], v[128:131]
    ds_read_b64_tr_b16 a[152:153], v233 offset:49152
    v_mfma_f32_16x16x32_bf16 v[132:135], a[156:159], v[180:183], v[132:135]
    ds_read_b64_tr_b16 a[154:155], v233 offset:50176
    v_mfma_f32_16x16x32_bf16 v[136:139], a[156:159], v[184:187], v[136:139]
    buffer_load_dwordx4 v225, s[12:15], s7 offen offset:3072 lds
    v_mfma_f32_16x16x32_bf16 v[140:143], a[156:159], v[188:191], v[140:143]
    s_waitcnt lgkmcnt(15)
    v_mfma_f32_16x16x32_bf16 a[0:3], a[160:163], v[176:179], a[0:3]
    ds_read_b64_tr_b16 a[156:157], v233 offset:49160
    v_mfma_f32_16x16x32_bf16 a[4:7], a[160:163], v[180:183], a[4:7]
    ds_read_b64_tr_b16 a[158:159], v233 offset:50184
    v_mfma_f32_16x16x32_bf16 a[8:11], a[160:163], v[184:187], a[8:11]
    v_mfma_f32_16x16x32_bf16 a[12:15], a[160:163], v[188:191], a[12:15]
    v_mfma_f32_16x16x32_bf16 a[16:19], a[164:167], v[176:179], a[16:19]
    ds_read_b64_tr_b16 a[160:161], v234 offset:57344
    v_mfma_f32_16x16x32_bf16 a[20:23], a[164:167], v[180:183], a[20:23]
    ds_read_b64_tr_b16 a[162:163], v234 offset:57856
    v_mfma_f32_16x16x32_bf16 a[24:27], a[164:167], v[184:187], a[24:27]
    v_mfma_f32_16x16x32_bf16 a[28:31], a[164:167], v[188:191], a[28:31]
    v_mfma_f32_16x16x32_bf16 a[32:35], a[168:171], v[176:179], a[32:35]
    ds_read_b64_tr_b16 a[164:165], v235 offset:57344
    v_mfma_f32_16x16x32_bf16 a[36:39], a[168:171], v[180:183], a[36:39]
    ds_read_b64_tr_b16 a[166:167], v235 offset:57856
    v_mfma_f32_16x16x32_bf16 a[40:43], a[168:171], v[184:187], a[40:43]
    v_mfma_f32_16x16x32_bf16 a[44:47], a[168:171], v[188:191], a[44:47]
    v_mfma_f32_16x16x32_bf16 a[48:51], a[172:175], v[176:179], a[48:51]
    ds_read_b64_tr_b16 a[168:169], v236 offset:57344
    v_mfma_f32_16x16x32_bf16 a[52:55], a[172:175], v[180:183], a[52:55]
    ds_read_b64_tr_b16 a[170:171], v236 offset:57856
    v_mfma_f32_16x16x32_bf16 a[56:59], a[172:175], v[184:187], a[56:59]
    v_mfma_f32_16x16x32_bf16 a[60:63], a[172:175], v[188:191], a[60:63]
    s_waitcnt lgkmcnt(15)
    v_mfma_f32_16x16x32_bf16 a[64:67], a[176:179], v[176:179], a[64:67]
    ds_read_b64_tr_b16 a[172:173], v237 offset:57344
    v_mfma_f32_16x16x32_bf16 a[68:71], a[176:179], v[180:183], a[68:71]
    ds_read_b64_tr_b16 a[174:175], v237 offset:57856
    v_mfma_f32_16x16x32_bf16 a[72:75], a[176:179], v[184:187], a[72:75]
    v_mfma_f32_16x16x32_bf16 a[76:79], a[176:179], v[188:191], a[76:79]
    v_mfma_f32_16x16x32_bf16 a[80:83], a[180:183], v[176:179], a[80:83]
    ds_read_b64_tr_b16 a[176:177], v234 offset:61440
    v_mfma_f32_16x16x32_bf16 a[84:87], a[180:183], v[180:183], a[84:87]
    ds_read_b64_tr_b16 a[178:179], v234 offset:61952
    v_mfma_f32_16x16x32_bf16 a[88:91], a[180:183], v[184:187], a[88:91]
    v_mfma_f32_16x16x32_bf16 a[92:95], a[180:183], v[188:191], a[92:95]
    v_mfma_f32_16x16x32_bf16 a[96:99], a[184:187], v[176:179], a[96:99]
    ds_read_b64_tr_b16 a[180:181], v235 offset:61440
    v_mfma_f32_16x16x32_bf16 a[100:103], a[184:187], v[180:183], a[100:103]
    ds_read_b64_tr_b16 a[182:183], v235 offset:61952
    v_mfma_f32_16x16x32_bf16 a[104:107], a[184:187], v[184:187], a[104:107]
    v_mfma_f32_16x16x32_bf16 a[108:111], a[184:187], v[188:191], a[108:111]
    v_mfma_f32_16x16x32_bf16 a[112:115], a[188:191], v[176:179], a[112:115]
    ds_read_b64_tr_b16 a[184:185], v236 offset:61440
    v_mfma_f32_16x16x32_bf16 a[116:119], a[188:191], v[180:183], a[116:119]
    ds_read_b64_tr_b16 a[186:187], v236 offset:61952
    v_mfma_f32_16x16x32_bf16 a[120:123], a[188:191], v[184:187], a[120:123]
    v_mfma_f32_16x16x32_bf16 a[124:127], a[188:191], v[188:191], a[124:127]
    ds_read_b64_tr_b16 a[188:189], v237 offset:61440
    ds_read_b64_tr_b16 a[190:191], v237 offset:61952
    s_waitcnt lgkmcnt(15)
    s_barrier
    v_mfma_f32_16x16x32_bf16 v[16:19], a[128:131], v[192:195], v[16:19]
    v_mfma_f32_16x16x32_bf16 v[20:23], a[128:131], v[196:199], v[20:23]
    s_add_u32 m0, s25, 16384
    v_mfma_f32_16x16x32_bf16 v[24:27], a[128:131], v[200:203], v[24:27]
    buffer_load_dwordx4 v220, s[8:11], s7 offen lds
    v_mfma_f32_16x16x32_bf16 v[28:31], a[128:131], v[204:207], v[28:31]
    v_mfma_f32_16x16x32_bf16 v[32:35], a[132:135], v[192:195], v[32:35]
    v_mfma_f32_16x16x32_bf16 v[36:39], a[132:135], v[196:199], v[36:39]
    v_mfma_f32_16x16x32_bf16 v[40:43], a[132:135], v[200:203], v[40:43]
    buffer_load_dwordx4 v221, s[8:11], s7 offen offset:1024 lds
    v_mfma_f32_16x16x32_bf16 v[44:47], a[132:135], v[204:207], v[44:47]
    v_mfma_f32_16x16x32_bf16 v[48:51], a[136:139], v[192:195], v[48:51]
    v_mfma_f32_16x16x32_bf16 v[52:55], a[136:139], v[196:199], v[52:55]
    v_mfma_f32_16x16x32_bf16 v[56:59], a[136:139], v[200:203], v[56:59]
    buffer_load_dwordx4 v222, s[8:11], s7 offen offset:2048 lds
    v_mfma_f32_16x16x32_bf16 v[60:63], a[136:139], v[204:207], v[60:63]
    v_mfma_f32_16x16x32_bf16 v[64:67], a[140:143], v[192:195], v[64:67]
    v_mfma_f32_16x16x32_bf16 v[68:71], a[140:143], v[196:199], v[68:71]
    v_mfma_f32_16x16x32_bf16 v[72:75], a[140:143], v[200:203], v[72:75]
    buffer_load_dwordx4 v223, s[8:11], s7 offen offset:3072 lds
    v_mfma_f32_16x16x32_bf16 v[76:79], a[140:143], v[204:207], v[76:79]
    v_mfma_f32_16x16x32_bf16 v[80:83], a[144:147], v[192:195], v[80:83]
    v_mfma_f32_16x16x32_bf16 v[84:87], a[144:147], v[196:199], v[84:87]
    v_mfma_f32_16x16x32_bf16 v[88:91], a[144:147], v[200:203], v[88:91]
    v_mfma_f32_16x16x32_bf16 v[92:95], a[144:147], v[204:207], v[92:95]
    v_mfma_f32_16x16x32_bf16 v[96:99], a[148:151], v[192:195], v[96:99]
    v_mfma_f32_16x16x32_bf16 v[100:103], a[148:151], v[196:199], v[100:103]
    v_mfma_f32_16x16x32_bf16 v[104:107], a[148:151], v[200:203], v[104:107]
    v_mfma_f32_16x16x32_bf16 v[108:111], a[148:151], v[204:207], v[108:111]
    v_mfma_f32_16x16x32_bf16 v[112:115], a[152:155], v[192:195], v[112:115]
    v_mfma_f32_16x16x32_bf16 v[116:119], a[152:155], v[196:199], v[116:119]
    v_mfma_f32_16x16x32_bf16 v[120:123], a[152:155], v[200:203], v[120:123]
    v_mfma_f32_16x16x32_bf16 v[124:127], a[152:155], v[204:207], v[124:127]
    v_mfma_f32_16x16x32_bf16 v[128:131], a[156:159], v[192:195], v[128:131]
    v_mfma_f32_16x16x32_bf16 v[132:135], a[156:159], v[196:199], v[132:135]
    v_mfma_f32_16x16x32_bf16 v[136:139], a[156:159], v[200:203], v[136:139]
    v_mfma_f32_16x16x32_bf16 v[140:143], a[156:159], v[204:207], v[140:143]
    s_waitcnt lgkmcnt(8)
    v_mfma_f32_16x16x32_bf16 a[0:3], a[160:163], v[192:195], a[0:3]
    v_mfma_f32_16x16x32_bf16 a[4:7], a[160:163], v[196:199], a[4:7]
    v_mfma_f32_16x16x32_bf16 a[8:11], a[160:163], v[200:203], a[8:11]
    v_mfma_f32_16x16x32_bf16 a[12:15], a[160:163], v[204:207], a[12:15]
    v_mfma_f32_16x16x32_bf16 a[16:19], a[164:167], v[192:195], a[16:19]
    v_mfma_f32_16x16x32_bf16 a[20:23], a[164:167], v[196:199], a[20:23]
    v_mfma_f32_16x16x32_bf16 a[24:27], a[164:167], v[200:203], a[24:27]
    v_mfma_f32_16x16x32_bf16 a[28:31], a[164:167], v[204:207], a[28:31]
    v_mfma_f32_16x16x32_bf16 a[32:35], a[168:171], v[192:195], a[32:35]
    v_mfma_f32_16x16x32_bf16 a[36:39], a[168:171], v[196:199], a[36:39]
    v_mfma_f32_16x16x32_bf16 a[40:43], a[168:171], v[200:203], a[40:43]
    v_mfma_f32_16x16x32_bf16 a[44:47], a[168:171], v[204:207], a[44:47]
    v_mfma_f32_16x16x32_bf16 a[48:51], a[172:175], v[192:195], a[48:51]
    v_mfma_f32_16x16x32_bf16 a[52:55], a[172:175], v[196:199], a[52:55]
    v_mfma_f32_16x16x32_bf16 a[56:59], a[172:175], v[200:203], a[56:59]
    v_mfma_f32_16x16x32_bf16 a[60:63], a[172:175], v[204:207], a[60:63]
    s_waitcnt lgkmcnt(0)
    v_mfma_f32_16x16x32_bf16 a[64:67], a[176:179], v[192:195], a[64:67]
    v_mfma_f32_16x16x32_bf16 a[68:71], a[176:179], v[196:199], a[68:71]
    v_mfma_f32_16x16x32_bf16 a[72:75], a[176:179], v[200:203], a[72:75]
    v_mfma_f32_16x16x32_bf16 a[76:79], a[176:179], v[204:207], a[76:79]
    v_mfma_f32_16x16x32_bf16 a[80:83], a[180:183], v[192:195], a[80:83]
    v_mfma_f32_16x16x32_bf16 a[84:87], a[180:183], v[196:199], a[84:87]
    v_mfma_f32_16x16x32_bf16 a[88:91], a[180:183], v[200:203], a[88:91]
    v_mfma_f32_16x16x32_bf16 a[92:95], a[180:183], v[204:207], a[92:95]
    v_mfma_f32_16x16x32_bf16 a[96:99], a[184:187], v[192:195], a[96:99]
    v_mfma_f32_16x16x32_bf16 a[100:103], a[184:187], v[196:199], a[100:103]
    v_mfma_f32_16x16x32_bf16 a[104:107], a[184:187], v[200:203], a[104:107]
    v_mfma_f32_16x16x32_bf16 a[108:111], a[184:187], v[204:207], a[108:111]
    v_mfma_f32_16x16x32_bf16 a[112:115], a[188:191], v[192:195], a[112:115]
    v_mfma_f32_16x16x32_bf16 a[116:119], a[188:191], v[196:199], a[116:119]
    v_mfma_f32_16x16x32_bf16 a[120:123], a[188:191], v[200:203], a[120:123]
    v_mfma_f32_16x16x32_bf16 a[124:127], a[188:191], v[204:207], a[124:127]
    s_mov_b32 s6, 0x3e0293ee
    s_mov_b32 s7, 0x3e0293ee
    s_nop 7
    v_pk_mul_f32 v[16:17], v[16:17], s[6:7]
    v_pk_mul_f32 v[18:19], v[18:19], s[6:7]
    v_pk_mul_f32 v[32:33], v[32:33], s[6:7]
    v_pk_mul_f32 v[34:35], v[34:35], s[6:7]
    v_cvt_pk_bf16_f32 v144, v16, v17
    v_cvt_pk_bf16_f32 v145, v18, v19
    v_cvt_pk_bf16_f32 v146, v32, v33
    v_cvt_pk_bf16_f32 v147, v34, v35
    v_pk_mul_f32 v[48:49], v[48:49], s[6:7]
    v_pk_mul_f32 v[50:51], v[50:51], s[6:7]
    v_pk_mul_f32 v[64:65], v[64:65], s[6:7]
    v_pk_mul_f32 v[66:67], v[66:67], s[6:7]
    v_cvt_pk_bf16_f32 v148, v48, v49
    v_cvt_pk_bf16_f32 v149, v50, v51
    v_cvt_pk_bf16_f32 v150, v64, v65
    v_cvt_pk_bf16_f32 v151, v66, v67
    v_pk_mul_f32 v[80:81], v[80:81], s[6:7]
    v_pk_mul_f32 v[82:83], v[82:83], s[6:7]
    v_pk_mul_f32 v[96:97], v[96:97], s[6:7]
    v_pk_mul_f32 v[98:99], v[98:99], s[6:7]
    v_cvt_pk_bf16_f32 v152, v80, v81
    v_cvt_pk_bf16_f32 v153, v82, v83
    v_cvt_pk_bf16_f32 v154, v96, v97
    v_cvt_pk_bf16_f32 v155, v98, v99
    v_pk_mul_f32 v[112:113], v[112:113], s[6:7]
    v_pk_mul_f32 v[114:115], v[114:115], s[6:7]
    v_pk_mul_f32 v[128:129], v[128:129], s[6:7]
    v_pk_mul_f32 v[130:131], v[130:131], s[6:7]
    v_cvt_pk_bf16_f32 v156, v112, v113
    v_cvt_pk_bf16_f32 v157, v114, v115
    v_cvt_pk_bf16_f32 v158, v128, v129
    v_cvt_pk_bf16_f32 v159, v130, v131
    v_pk_mul_f32 v[20:21], v[20:21], s[6:7]
    v_pk_mul_f32 v[22:23], v[22:23], s[6:7]
    v_pk_mul_f32 v[36:37], v[36:37], s[6:7]
    v_pk_mul_f32 v[38:39], v[38:39], s[6:7]
    v_cvt_pk_bf16_f32 v160, v20, v21
    v_cvt_pk_bf16_f32 v161, v22, v23
    v_cvt_pk_bf16_f32 v162, v36, v37
    v_cvt_pk_bf16_f32 v163, v38, v39
    v_pk_mul_f32 v[52:53], v[52:53], s[6:7]
    v_pk_mul_f32 v[54:55], v[54:55], s[6:7]
    v_pk_mul_f32 v[68:69], v[68:69], s[6:7]
    v_pk_mul_f32 v[70:71], v[70:71], s[6:7]
    v_cvt_pk_bf16_f32 v164, v52, v53
    v_cvt_pk_bf16_f32 v165, v54, v55
    v_cvt_pk_bf16_f32 v166, v68, v69
    v_cvt_pk_bf16_f32 v167, v70, v71
    v_pk_mul_f32 v[84:85], v[84:85], s[6:7]
    v_pk_mul_f32 v[86:87], v[86:87], s[6:7]
    v_pk_mul_f32 v[100:101], v[100:101], s[6:7]
    v_pk_mul_f32 v[102:103], v[102:103], s[6:7]
    v_cvt_pk_bf16_f32 v168, v84, v85
    v_cvt_pk_bf16_f32 v169, v86, v87
    v_cvt_pk_bf16_f32 v170, v100, v101
    v_cvt_pk_bf16_f32 v171, v102, v103
    v_pk_mul_f32 v[116:117], v[116:117], s[6:7]
    v_pk_mul_f32 v[118:119], v[118:119], s[6:7]
    v_pk_mul_f32 v[132:133], v[132:133], s[6:7]
    v_pk_mul_f32 v[134:135], v[134:135], s[6:7]
    v_cvt_pk_bf16_f32 v172, v116, v117
    v_cvt_pk_bf16_f32 v173, v118, v119
    v_cvt_pk_bf16_f32 v174, v132, v133
    v_cvt_pk_bf16_f32 v175, v134, v135
    v_pk_mul_f32 v[24:25], v[24:25], s[6:7]
    v_pk_mul_f32 v[26:27], v[26:27], s[6:7]
    v_pk_mul_f32 v[40:41], v[40:41], s[6:7]
    v_pk_mul_f32 v[42:43], v[42:43], s[6:7]
    v_cvt_pk_bf16_f32 v176, v24, v25
    v_cvt_pk_bf16_f32 v177, v26, v27
    v_cvt_pk_bf16_f32 v178, v40, v41
    v_cvt_pk_bf16_f32 v179, v42, v43
    v_pk_mul_f32 v[56:57], v[56:57], s[6:7]
    v_pk_mul_f32 v[58:59], v[58:59], s[6:7]
    v_pk_mul_f32 v[72:73], v[72:73], s[6:7]
    v_pk_mul_f32 v[74:75], v[74:75], s[6:7]
    v_cvt_pk_bf16_f32 v180, v56, v57
    v_cvt_pk_bf16_f32 v181, v58, v59
    v_cvt_pk_bf16_f32 v182, v72, v73
    v_cvt_pk_bf16_f32 v183, v74, v75
    v_pk_mul_f32 v[88:89], v[88:89], s[6:7]
    v_pk_mul_f32 v[90:91], v[90:91], s[6:7]
    v_pk_mul_f32 v[104:105], v[104:105], s[6:7]
    v_pk_mul_f32 v[106:107], v[106:107], s[6:7]
    v_cvt_pk_bf16_f32 v184, v88, v89
    v_cvt_pk_bf16_f32 v185, v90, v91
    v_cvt_pk_bf16_f32 v186, v104, v105
    v_cvt_pk_bf16_f32 v187, v106, v107
    v_pk_mul_f32 v[120:121], v[120:121], s[6:7]
    v_pk_mul_f32 v[122:123], v[122:123], s[6:7]
    v_pk_mul_f32 v[136:137], v[136:137], s[6:7]
    v_pk_mul_f32 v[138:139], v[138:139], s[6:7]
    v_cvt_pk_bf16_f32 v188, v120, v121
    v_cvt_pk_bf16_f32 v189, v122, v123
    v_cvt_pk_bf16_f32 v190, v136, v137
    v_cvt_pk_bf16_f32 v191, v138, v139
    v_pk_mul_f32 v[28:29], v[28:29], s[6:7]
    v_pk_mul_f32 v[30:31], v[30:31], s[6:7]
    v_pk_mul_f32 v[44:45], v[44:45], s[6:7]
    v_pk_mul_f32 v[46:47], v[46:47], s[6:7]
    v_cvt_pk_bf16_f32 v192, v28, v29
    v_cvt_pk_bf16_f32 v193, v30, v31
    v_cvt_pk_bf16_f32 v194, v44, v45
    v_cvt_pk_bf16_f32 v195, v46, v47
    v_pk_mul_f32 v[60:61], v[60:61], s[6:7]
    v_pk_mul_f32 v[62:63], v[62:63], s[6:7]
    v_pk_mul_f32 v[76:77], v[76:77], s[6:7]
    v_pk_mul_f32 v[78:79], v[78:79], s[6:7]
    v_cvt_pk_bf16_f32 v196, v60, v61
    v_cvt_pk_bf16_f32 v197, v62, v63
    v_cvt_pk_bf16_f32 v198, v76, v77
    v_cvt_pk_bf16_f32 v199, v78, v79
    v_pk_mul_f32 v[92:93], v[92:93], s[6:7]
    v_pk_mul_f32 v[94:95], v[94:95], s[6:7]
    v_pk_mul_f32 v[108:109], v[108:109], s[6:7]
    v_pk_mul_f32 v[110:111], v[110:111], s[6:7]
    v_cvt_pk_bf16_f32 v200, v92, v93
    v_cvt_pk_bf16_f32 v201, v94, v95
    v_cvt_pk_bf16_f32 v202, v108, v109
    v_cvt_pk_bf16_f32 v203, v110, v111
    v_pk_mul_f32 v[124:125], v[124:125], s[6:7]
    v_pk_mul_f32 v[126:127], v[126:127], s[6:7]
    v_pk_mul_f32 v[140:141], v[140:141], s[6:7]
    v_pk_mul_f32 v[142:143], v[142:143], s[6:7]
    v_cvt_pk_bf16_f32 v204, v124, v125
    v_cvt_pk_bf16_f32 v205, v126, v127
    v_cvt_pk_bf16_f32 v206, v140, v141
    v_cvt_pk_bf16_f32 v207, v142, v143
    s_cmp_ge_u32 s4, 28
    s_cbranch_scc1 K_noh
    s_lshl_b32 s6, s5, 1
    s_lshr_b32 s7, s3, 1
    s_add_u32 s6, s6, s7
    s_mul_i32 s6, s6, 1511424
    s_add_u32 s7, s4, 64
    s_lshl_b32 s7, s7, 14
    s_add_u32 s6, s6, s7
    s_and_b32 s7, s3, 1
    s_lshl_b32 s7, s7, 12
    s_add_u32 s6, s6, s7
    s_add_u32 s6, s6, 4194304
    v_and_b32 v2, 15, v1
    v_lshrrev_b32 v3, 4, v1
    v_bfe_u32 v4, v1, 2, 1
    v_lshlrev_b32 v4, 1, v4
    v_bfe_u32 v5, v1, 3, 1
    v_mul_u32_u24 v5, 3, v5
    v_xor_b32 v4, v4, v5
    v_xor_b32 v4, v4, v3
    v_lshlrev_b32 v4, 4, v4
    v_lshl_add_u32 v2, v2, 6, v4
    v_add_u32 v3, 8192, v2
    s_mov_b32 s26, 0xbfb8aa3b
    s_mov_b32 s27, 0xbfb8aa3b
    s_mov_b32 s78, 1.0
    s_mov_b32 s79, 1.0
    v_accvgpr_read_b32 v16, a0
    v_accvgpr_read_b32 v24, a64
    v_accvgpr_read_b32 v17, a1
    v_accvgpr_read_b32 v25, a65
    v_accvgpr_read_b32 v18, a2
    v_accvgpr_read_b32 v26, a66
    v_accvgpr_read_b32 v19, a3
    v_accvgpr_read_b32 v27, a67
    v_accvgpr_read_b32 v20, a16
    v_accvgpr_read_b32 v28, a80
    v_accvgpr_read_b32 v21, a17
    v_accvgpr_read_b32 v29, a81
    v_accvgpr_read_b32 v22, a18
    v_accvgpr_read_b32 v30, a82
    v_accvgpr_read_b32 v23, a19
    v_accvgpr_read_b32 v31, a83
    v_pk_mul_f32 v[32:33], v[16:17], s[26:27]
    v_pk_mul_f32 v[34:35], v[18:19], s[26:27]
    v_pk_mul_f32 v[36:37], v[20:21], s[26:27]
    v_pk_mul_f32 v[38:39], v[22:23], s[26:27]
    v_exp_f32 v32, v32
    v_exp_f32 v33, v33
    v_exp_f32 v34, v34
    v_exp_f32 v35, v35
    v_exp_f32 v36, v36
    v_exp_f32 v37, v37
    v_exp_f32 v38, v38
    v_exp_f32 v39, v39
    v_pk_mul_f32 v[16:17], v[16:17], v[24:25]
    v_pk_mul_f32 v[18:19], v[18:19], v[26:27]
    v_pk_mul_f32 v[20:21], v[20:21], v[28:29]
    v_pk_mul_f32 v[22:23], v[22:23], v[30:31]
    v_pk_add_f32 v[32:33], v[32:33], s[78:79]
    v_pk_add_f32 v[34:35], v[34:35], s[78:79]
    v_pk_add_f32 v[36:37], v[36:37], s[78:79]
    v_pk_add_f32 v[38:39], v[38:39], s[78:79]
    v_rcp_f32 v32, v32
    v_rcp_f32 v33, v33
    v_rcp_f32 v34, v34
    v_rcp_f32 v35, v35
    v_rcp_f32 v36, v36
    v_rcp_f32 v37, v37
    v_rcp_f32 v38, v38
    v_rcp_f32 v39, v39
    v_pk_mul_f32 v[16:17], v[16:17], v[32:33]
    v_pk_mul_f32 v[18:19], v[18:19], v[34:35]
    v_pk_mul_f32 v[20:21], v[20:21], v[36:37]
    v_pk_mul_f32 v[22:23], v[22:23], v[38:39]
    v_cvt_pk_bf16_f32 v40, v16, v17
    v_cvt_pk_bf16_f32 v41, v18, v19
    v_cvt_pk_bf16_f32 v42, v20, v21
    v_cvt_pk_bf16_f32 v43, v22, v23
    buffer_store_dwordx4 v[40:43], v2, s[20:23], s6 offen offset:0
    v_accvgpr_read_b32 v48, a32
    v_accvgpr_read_b32 v56, a96
    v_accvgpr_read_b32 v49, a33
    v_accvgpr_read_b32 v57, a97
    v_accvgpr_read_b32 v50, a34
    v_accvgpr_read_b32 v58, a98
    v_accvgpr_read_b32 v51, a35
    v_accvgpr_read_b32 v59, a99
    v_accvgpr_read_b32 v52, a48
    v_accvgpr_read_b32 v60, a112
    v_accvgpr_read_b32 v53, a49
    v_accvgpr_read_b32 v61, a113
    v_accvgpr_read_b32 v54, a50
    v_accvgpr_read_b32 v62, a114
    v_accvgpr_read_b32 v55, a51
    v_accvgpr_read_b32 v63, a115
    v_pk_mul_f32 v[64:65], v[48:49], s[26:27]
    v_pk_mul_f32 v[66:67], v[50:51], s[26:27]
    v_pk_mul_f32 v[68:69], v[52:53], s[26:27]
    v_pk_mul_f32 v[70:71], v[54:55], s[26:27]
    v_exp_f32 v64, v64
    v_exp_f32 v65, v65
    v_exp_f32 v66, v66
    v_exp_f32 v67, v67
    v_exp_f32 v68, v68
    v_exp_f32 v69, v69
    v_exp_f32 v70, v70
    v_exp_f32 v71, v71
    v_pk_mul_f32 v[48:49], v[48:49], v[56:57]
    v_pk_mul_f32 v[50:51], v[50:51], v[58:59]
    v_pk_mul_f32 v[52:53], v[52:53], v[60:61]
    v_pk_mul_f32 v[54:55], v[54:55], v[62:63]
    v_pk_add_f32 v[64:65], v[64:65], s[78:79]
    v_pk_add_f32 v[66:67], v[66:67], s[78:79]
    v_pk_add_f32 v[68:69], v[68:69], s[78:79]
    v_pk_add_f32 v[70:71], v[70:71], s[78:79]
    v_rcp_f32 v64, v64
    v_rcp_f32 v65, v65
    v_rcp_f32 v66, v66
    v_rcp_f32 v67, v67
    v_rcp_f32 v68, v68
    v_rcp_f32 v69, v69
    v_rcp_f32 v70, v70
    v_rcp_f32 v71, v71
    v_pk_mul_f32 v[48:49], v[48:49], v[64:65]
    v_pk_mul_f32 v[50:51], v[50:51], v[66:67]
    v_pk_mul_f32 v[52:53], v[52:53], v[68:69]
    v_pk_mul_f32 v[54:55], v[54:55], v[70:71]
    v_cvt_pk_bf16_f32 v72, v48, v49
    v_cvt_pk_bf16_f32 v73, v50, v51
    v_cvt_pk_bf16_f32 v74, v52, v53
    v_cvt_pk_bf16_f32 v75, v54, v55
    buffer_store_dwordx4 v[72:75], v3, s[20:23], s6 offen offset:0
    v_accvgpr_read_b32 v16, a4
    v_accvgpr_read_b32 v24, a68
    v_accvgpr_read_b32 v17, a5
    v_accvgpr_read_b32 v25, a69
    v_accvgpr_read_b32 v18, a6
    v_accvgpr_read_b32 v26, a70
    v_accvgpr_read_b32 v19, a7
    v_accvgpr_read_b32 v27, a71
    v_accvgpr_read_b32 v20, a20
    v_accvgpr_read_b32 v28, a84
    v_accvgpr_read_b32 v21, a21
    v_accvgpr_read_b32 v29, a85
    v_accvgpr_read_b32 v22, a22
    v_accvgpr_read_b32 v30, a86
    v_accvgpr_read_b32 v23, a23
    v_accvgpr_read_b32 v31, a87
    v_pk_mul_f32 v[32:33], v[16:17], s[26:27]
    v_pk_mul_f32 v[34:35], v[18:19], s[26:27]
    v_pk_mul_f32 v[36:37], v[20:21], s[26:27]
    v_pk_mul_f32 v[38:39], v[22:23], s[26:27]
    v_exp_f32 v32, v32
    v_exp_f32 v33, v33
    v_exp_f32 v34, v34
    v_exp_f32 v35, v35
    v_exp_f32 v36, v36
    v_exp_f32 v37, v37
    v_exp_f32 v38, v38
    v_exp_f32 v39, v39
    v_pk_mul_f32 v[16:17], v[16:17], v[24:25]
    v_pk_mul_f32 v[18:19], v[18:19], v[26:27]
    v_pk_mul_f32 v[20:21], v[20:21], v[28:29]
    v_pk_mul_f32 v[22:23], v[22:23], v[30:31]
    v_pk_add_f32 v[32:33], v[32:33], s[78:79]
    v_pk_add_f32 v[34:35], v[34:35], s[78:79]
    v_pk_add_f32 v[36:37], v[36:37], s[78:79]
    v_pk_add_f32 v[38:39], v[38:39], s[78:79]
    v_rcp_f32 v32, v32
    v_rcp_f32 v33, v33
    v_rcp_f32 v34, v34
    v_rcp_f32 v35, v35
    v_rcp_f32 v36, v36
    v_rcp_f32 v37, v37
    v_rcp_f32 v38, v38
    v_rcp_f32 v39, v39
    v_pk_mul_f32 v[16:17], v[16:17], v[32:33]
    v_pk_mul_f32 v[18:19], v[18:19], v[34:35]
    v_pk_mul_f32 v[20:21], v[20:21], v[36:37]
    v_pk_mul_f32 v[22:23], v[22:23], v[38:39]
    v_cvt_pk_bf16_f32 v40, v16, v17
    v_cvt_pk_bf16_f32 v41, v18, v19
    v_cvt_pk_bf16_f32 v42, v20, v21
    v_cvt_pk_bf16_f32 v43, v22, v23
    buffer_store_dwordx4 v[40:43], v2, s[20:23], s6 offen offset:1024
    v_accvgpr_read_b32 v48, a36
    v_accvgpr_read_b32 v56, a100
    v_accvgpr_read_b32 v49, a37
    v_accvgpr_read_b32 v57, a101
    v_accvgpr_read_b32 v50, a38
    v_accvgpr_read_b32 v58, a102
    v_accvgpr_read_b32 v51, a39
    v_accvgpr_read_b32 v59, a103
    v_accvgpr_read_b32 v52, a52
    v_accvgpr_read_b32 v60, a116
    v_accvgpr_read_b32 v53, a53
    v_accvgpr_read_b32 v61, a117
    v_accvgpr_read_b32 v54, a54
    v_accvgpr_read_b32 v62, a118
    v_accvgpr_read_b32 v55, a55
    v_accvgpr_read_b32 v63, a119
    v_pk_mul_f32 v[64:65], v[48:49], s[26:27]
    v_pk_mul_f32 v[66:67], v[50:51], s[26:27]
    v_pk_mul_f32 v[68:69], v[52:53], s[26:27]
    v_pk_mul_f32 v[70:71], v[54:55], s[26:27]
    v_exp_f32 v64, v64
    v_exp_f32 v65, v65
    v_exp_f32 v66, v66
    v_exp_f32 v67, v67
    v_exp_f32 v68, v68
    v_exp_f32 v69, v69
    v_exp_f32 v70, v70
    v_exp_f32 v71, v71
    v_pk_mul_f32 v[48:49], v[48:49], v[56:57]
    v_pk_mul_f32 v[50:51], v[50:51], v[58:59]
    v_pk_mul_f32 v[52:53], v[52:53], v[60:61]
    v_pk_mul_f32 v[54:55], v[54:55], v[62:63]
    v_pk_add_f32 v[64:65], v[64:65], s[78:79]
    v_pk_add_f32 v[66:67], v[66:67], s[78:79]
    v_pk_add_f32 v[68:69], v[68:69], s[78:79]
    v_pk_add_f32 v[70:71], v[70:71], s[78:79]
    v_rcp_f32 v64, v64
    v_rcp_f32 v65, v65
    v_rcp_f32 v66, v66
    v_rcp_f32 v67, v67
    v_rcp_f32 v68, v68
    v_rcp_f32 v69, v69
    v_rcp_f32 v70, v70
    v_rcp_f32 v71, v71
    v_pk_mul_f32 v[48:49], v[48:49], v[64:65]
    v_pk_mul_f32 v[50:51], v[50:51], v[66:67]
    v_pk_mul_f32 v[52:53], v[52:53], v[68:69]
    v_pk_mul_f32 v[54:55], v[54:55], v[70:71]
    v_cvt_pk_bf16_f32 v72, v48, v49
    v_cvt_pk_bf16_f32 v73, v50, v51
    v_cvt_pk_bf16_f32 v74, v52, v53
    v_cvt_pk_bf16_f32 v75, v54, v55
    buffer_store_dwordx4 v[72:75], v3, s[20:23], s6 offen offset:1024
    v_accvgpr_read_b32 v16, a8
    v_accvgpr_read_b32 v24, a72
    v_accvgpr_read_b32 v17, a9
    v_accvgpr_read_b32 v25, a73
    v_accvgpr_read_b32 v18, a10
    v_accvgpr_read_b32 v26, a74
    v_accvgpr_read_b32 v19, a11
    v_accvgpr_read_b32 v27, a75
    v_accvgpr_read_b32 v20, a24
    v_accvgpr_read_b32 v28, a88
    v_accvgpr_read_b32 v21, a25
    v_accvgpr_read_b32 v29, a89
    v_accvgpr_read_b32 v22, a26
    v_accvgpr_read_b32 v30, a90
    v_accvgpr_read_b32 v23, a27
    v_accvgpr_read_b32 v31, a91
    v_pk_mul_f32 v[32:33], v[16:17], s[26:27]
    v_pk_mul_f32 v[34:35], v[18:19], s[26:27]
    v_pk_mul_f32 v[36:37], v[20:21], s[26:27]
    v_pk_mul_f32 v[38:39], v[22:23], s[26:27]
    v_exp_f32 v32, v32
    v_exp_f32 v33, v33
    v_exp_f32 v34, v34
    v_exp_f32 v35, v35
    v_exp_f32 v36, v36
    v_exp_f32 v37, v37
    v_exp_f32 v38, v38
    v_exp_f32 v39, v39
    v_pk_mul_f32 v[16:17], v[16:17], v[24:25]
    v_pk_mul_f32 v[18:19], v[18:19], v[26:27]
    v_pk_mul_f32 v[20:21], v[20:21], v[28:29]
    v_pk_mul_f32 v[22:23], v[22:23], v[30:31]
    v_pk_add_f32 v[32:33], v[32:33], s[78:79]
    v_pk_add_f32 v[34:35], v[34:35], s[78:79]
    v_pk_add_f32 v[36:37], v[36:37], s[78:79]
    v_pk_add_f32 v[38:39], v[38:39], s[78:79]
    v_rcp_f32 v32, v32
    v_rcp_f32 v33, v33
    v_rcp_f32 v34, v34
    v_rcp_f32 v35, v35
    v_rcp_f32 v36, v36
    v_rcp_f32 v37, v37
    v_rcp_f32 v38, v38
    v_rcp_f32 v39, v39
    v_pk_mul_f32 v[16:17], v[16:17], v[32:33]
    v_pk_mul_f32 v[18:19], v[18:19], v[34:35]
    v_pk_mul_f32 v[20:21], v[20:21], v[36:37]
    v_pk_mul_f32 v[22:23], v[22:23], v[38:39]
    v_cvt_pk_bf16_f32 v40, v16, v17
    v_cvt_pk_bf16_f32 v41, v18, v19
    v_cvt_pk_bf16_f32 v42, v20, v21
    v_cvt_pk_bf16_f32 v43, v22, v23
    buffer_store_dwordx4 v[40:43], v2, s[20:23], s6 offen offset:2048
    v_accvgpr_read_b32 v48, a40
    v_accvgpr_read_b32 v56, a104
    v_accvgpr_read_b32 v49, a41
    v_accvgpr_read_b32 v57, a105
    v_accvgpr_read_b32 v50, a42
    v_accvgpr_read_b32 v58, a106
    v_accvgpr_read_b32 v51, a43
    v_accvgpr_read_b32 v59, a107
    v_accvgpr_read_b32 v52, a56
    v_accvgpr_read_b32 v60, a120
    v_accvgpr_read_b32 v53, a57
    v_accvgpr_read_b32 v61, a121
    v_accvgpr_read_b32 v54, a58
    v_accvgpr_read_b32 v62, a122
    v_accvgpr_read_b32 v55, a59
    v_accvgpr_read_b32 v63, a123
    v_pk_mul_f32 v[64:65], v[48:49], s[26:27]
    v_pk_mul_f32 v[66:67], v[50:51], s[26:27]
    v_pk_mul_f32 v[68:69], v[52:53], s[26:27]
    v_pk_mul_f32 v[70:71], v[54:55], s[26:27]
    v_exp_f32 v64, v64
    v_exp_f32 v65, v65
    v_exp_f32 v66, v66
    v_exp_f32 v67, v67
    v_exp_f32 v68, v68
    v_exp_f32 v69, v69
    v_exp_f32 v70, v70
    v_exp_f32 v71, v71
    v_pk_mul_f32 v[48:49], v[48:49], v[56:57]
    v_pk_mul_f32 v[50:51], v[50:51], v[58:59]
    v_pk_mul_f32 v[52:53], v[52:53], v[60:61]
    v_pk_mul_f32 v[54:55], v[54:55], v[62:63]
    v_pk_add_f32 v[64:65], v[64:65], s[78:79]
    v_pk_add_f32 v[66:67], v[66:67], s[78:79]
    v_pk_add_f32 v[68:69], v[68:69], s[78:79]
    v_pk_add_f32 v[70:71], v[70:71], s[78:79]
    v_rcp_f32 v64, v64
    v_rcp_f32 v65, v65
    v_rcp_f32 v66, v66
    v_rcp_f32 v67, v67
    v_rcp_f32 v68, v68
    v_rcp_f32 v69, v69
    v_rcp_f32 v70, v70
    v_rcp_f32 v71, v71
    v_pk_mul_f32 v[48:49], v[48:49], v[64:65]
    v_pk_mul_f32 v[50:51], v[50:51], v[66:67]
    v_pk_mul_f32 v[52:53], v[52:53], v[68:69]
    v_pk_mul_f32 v[54:55], v[54:55], v[70:71]
    v_cvt_pk_bf16_f32 v72, v48, v49
    v_cvt_pk_bf16_f32 v73, v50, v51
    v_cvt_pk_bf16_f32 v74, v52, v53
    v_cvt_pk_bf16_f32 v75, v54, v55
    buffer_store_dwordx4 v[72:75], v3, s[20:23], s6 offen offset:2048
    v_accvgpr_read_b32 v16, a12
    v_accvgpr_read_b32 v24, a76
    v_accvgpr_read_b32 v17, a13
    v_accvgpr_read_b32 v25, a77
    v_accvgpr_read_b32 v18, a14
    v_accvgpr_read_b32 v26, a78
    v_accvgpr_read_b32 v19, a15
    v_accvgpr_read_b32 v27, a79
    v_accvgpr_read_b32 v20, a28
    v_accvgpr_read_b32 v28, a92
    v_accvgpr_read_b32 v21, a29
    v_accvgpr_read_b32 v29, a93
    v_accvgpr_read_b32 v22, a30
    v_accvgpr_read_b32 v30, a94
    v_accvgpr_read_b32 v23, a31
    v_accvgpr_read_b32 v31, a95
    v_pk_mul_f32 v[32:33], v[16:17], s[26:27]
    v_pk_mul_f32 v[34:35], v[18:19], s[26:27]
    v_pk_mul_f32 v[36:37], v[20:21], s[26:27]
    v_pk_mul_f32 v[38:39], v[22:23], s[26:27]
    v_exp_f32 v32, v32
    v_exp_f32 v33, v33
    v_exp_f32 v34, v34
    v_exp_f32 v35, v35
    v_exp_f32 v36, v36
    v_exp_f32 v37, v37
    v_exp_f32 v38, v38
    v_exp_f32 v39, v39
    v_pk_mul_f32 v[16:17], v[16:17], v[24:25]
    v_pk_mul_f32 v[18:19], v[18:19], v[26:27]
    v_pk_mul_f32 v[20:21], v[20:21], v[28:29]
    v_pk_mul_f32 v[22:23], v[22:23], v[30:31]
    v_pk_add_f32 v[32:33], v[32:33], s[78:79]
    v_pk_add_f32 v[34:35], v[34:35], s[78:79]
    v_pk_add_f32 v[36:37], v[36:37], s[78:79]
    v_pk_add_f32 v[38:39], v[38:39], s[78:79]
    v_rcp_f32 v32, v32
    v_rcp_f32 v33, v33
    v_rcp_f32 v34, v34
    v_rcp_f32 v35, v35
    v_rcp_f32 v36, v36
    v_rcp_f32 v37, v37
    v_rcp_f32 v38, v38
    v_rcp_f32 v39, v39
    v_pk_mul_f32 v[16:17], v[16:17], v[32:33]
    v_pk_mul_f32 v[18:19], v[18:19], v[34:35]
    v_pk_mul_f32 v[20:21], v[20:21], v[36:37]
    v_pk_mul_f32 v[22:23], v[22:23], v[38:39]
    v_cvt_pk_bf16_f32 v40, v16, v17
    v_cvt_pk_bf16_f32 v41, v18, v19
    v_cvt_pk_bf16_f32 v42, v20, v21
    v_cvt_pk_bf16_f32 v43, v22, v23
    buffer_store_dwordx4 v[40:43], v2, s[20:23], s6 offen offset:3072
    v_accvgpr_read_b32 v48, a44
    v_accvgpr_read_b32 v56, a108
    v_accvgpr_read_b32 v49, a45
    v_accvgpr_read_b32 v57, a109
    v_accvgpr_read_b32 v50, a46
    v_accvgpr_read_b32 v58, a110
    v_accvgpr_read_b32 v51, a47
    v_accvgpr_read_b32 v59, a111
    v_accvgpr_read_b32 v52, a60
    v_accvgpr_read_b32 v60, a124
    v_accvgpr_read_b32 v53, a61
    v_accvgpr_read_b32 v61, a125
    v_accvgpr_read_b32 v54, a62
    v_accvgpr_read_b32 v62, a126
    v_accvgpr_read_b32 v55, a63
    v_accvgpr_read_b32 v63, a127
    v_pk_mul_f32 v[64:65], v[48:49], s[26:27]
    v_pk_mul_f32 v[66:67], v[50:51], s[26:27]
    v_pk_mul_f32 v[68:69], v[52:53], s[26:27]
    v_pk_mul_f32 v[70:71], v[54:55], s[26:27]
    v_exp_f32 v64, v64
    v_exp_f32 v65, v65
    v_exp_f32 v66, v66
    v_exp_f32 v67, v67
    v_exp_f32 v68, v68
    v_exp_f32 v69, v69
    v_exp_f32 v70, v70
    v_exp_f32 v71, v71
    v_pk_mul_f32 v[48:49], v[48:49], v[56:57]
    v_pk_mul_f32 v[50:51], v[50:51], v[58:59]
    v_pk_mul_f32 v[52:53], v[52:53], v[60:61]
    v_pk_mul_f32 v[54:55], v[54:55], v[62:63]
    v_pk_add_f32 v[64:65], v[64:65], s[78:79]
    v_pk_add_f32 v[66:67], v[66:67], s[78:79]
    v_pk_add_f32 v[68:69], v[68:69], s[78:79]
    v_pk_add_f32 v[70:71], v[70:71], s[78:79]
    v_rcp_f32 v64, v64
    v_rcp_f32 v65, v65
    v_rcp_f32 v66, v66
    v_rcp_f32 v67, v67
    v_rcp_f32 v68, v68
    v_rcp_f32 v69, v69
    v_rcp_f32 v70, v70
    v_rcp_f32 v71, v71
    v_pk_mul_f32 v[48:49], v[48:49], v[64:65]
    v_pk_mul_f32 v[50:51], v[50:51], v[66:67]
    v_pk_mul_f32 v[52:53], v[52:53], v[68:69]
    v_pk_mul_f32 v[54:55], v[54:55], v[70:71]
    v_cvt_pk_bf16_f32 v72, v48, v49
    v_cvt_pk_bf16_f32 v73, v50, v51
    v_cvt_pk_bf16_f32 v74, v52, v53
    v_cvt_pk_bf16_f32 v75, v54, v55
    buffer_store_dwordx4 v[72:75], v3, s[20:23], s6 offen offset:3072
K_noh:
    s_mov_b32 s27, 0
K_astart:
    v_accvgpr_write_b32 a0, 0
    v_accvgpr_write_b32 a1, 0
    v_accvgpr_write_b32 a2, 0
    v_accvgpr_write_b32 a3, 0
    v_accvgpr_write_b32 a4, 0
    v_accvgpr_write_b32 a5, 0
    v_accvgpr_write_b32 a6, 0
    v_accvgpr_write_b32 a7, 0
    v_accvgpr_write_b32 a8, 0
    v_accvgpr_write_b32 a9, 0
    v_accvgpr_write_b32 a10, 0
    v_accvgpr_write_b32 a11, 0
    v_accvgpr_write_b32 a12, 0
    v_accvgpr_write_b32 a13, 0
    v_accvgpr_write_b32 a14, 0
    v_accvgpr_write_b32 a15, 0
    v_accvgpr_write_b32 a16, 0
    v_accvgpr_write_b32 a17, 0
    v_accvgpr_write_b32 a18, 0
    v_accvgpr_write_b32 a19, 0
    v_accvgpr_write_b32 a20, 0
    v_accvgpr_write_b32 a21, 0
    v_accvgpr_write_b32 a22, 0
    v_accvgpr_write_b32 a23, 0
    v_accvgpr_write_b32 a24, 0
    v_accvgpr_write_b32 a25, 0
    v_accvgpr_write_b32 a26, 0
    v_accvgpr_write_b32 a27, 0
    v_accvgpr_write_b32 a28, 0
    v_accvgpr_write_b32 a29, 0
    v_accvgpr_write_b32 a30, 0
    v_accvgpr_write_b32 a31, 0
    v_accvgpr_write_b32 a32, 0
    v_accvgpr_write_b32 a33, 0
    v_accvgpr_write_b32 a34, 0
    v_accvgpr_write_b32 a35, 0
    v_accvgpr_write_b32 a36, 0
    v_accvgpr_write_b32 a37, 0
    v_accvgpr_write_b32 a38, 0
    v_accvgpr_write_b32 a39, 0
    v_accvgpr_write_b32 a40, 0
    v_accvgpr_write_b32 a41, 0
    v_accvgpr_write_b32 a42, 0
    v_accvgpr_write_b32 a43, 0
    v_accvgpr_write_b32 a44, 0
    v_accvgpr_write_b32 a45, 0
    v_accvgpr_write_b32 a46, 0
    v_accvgpr_write_b32 a47, 0
    v_accvgpr_write_b32 a48, 0
    v_accvgpr_write_b32 a49, 0
    v_accvgpr_write_b32 a50, 0
    v_accvgpr_write_b32 a51, 0
    v_accvgpr_write_b32 a52, 0
    v_accvgpr_write_b32 a53, 0
    v_accvgpr_write_b32 a54, 0
    v_accvgpr_write_b32 a55, 0
    v_accvgpr_write_b32 a56, 0
    v_accvgpr_write_b32 a57, 0
    v_accvgpr_write_b32 a58, 0
    v_accvgpr_write_b32 a59, 0
    v_accvgpr_write_b32 a60, 0
    v_accvgpr_write_b32 a61, 0
    v_accvgpr_write_b32 a62, 0
    v_accvgpr_write_b32 a63, 0
    v_accvgpr_write_b32 a64, 0
    v_accvgpr_write_b32 a65, 0
    v_accvgpr_write_b32 a66, 0
    v_accvgpr_write_b32 a67, 0
    v_accvgpr_write_b32 a68, 0
    v_accvgpr_write_b32 a69, 0
    v_accvgpr_write_b32 a70, 0
    v_accvgpr_write_b32 a71, 0
    v_accvgpr_write_b32 a72, 0
    v_accvgpr_write_b32 a73, 0
    v_accvgpr_write_b32 a74, 0
    v_accvgpr_write_b32 a75, 0
    v_accvgpr_write_b32 a76, 0
    v_accvgpr_write_b32 a77, 0
    v_accvgpr_write_b32 a78, 0
    v_accvgpr_write_b32 a79, 0
    v_accvgpr_write_b32 a80, 0
    v_accvgpr_write_b32 a81, 0
    v_accvgpr_write_b32 a82, 0
    v_accvgpr_write_b32 a83, 0
    v_accvgpr_write_b32 a84, 0
    v_accvgpr_write_b32 a85, 0
    v_accvgpr_write_b32 a86, 0
    v_accvgpr_write_b32 a87, 0
    v_accvgpr_write_b32 a88, 0
    v_accvgpr_write_b32 a89, 0
    v_accvgpr_write_b32 a90, 0
    v_accvgpr_write_b32 a91, 0
    v_accvgpr_write_b32 a92, 0
    v_accvgpr_write_b32 a93, 0
    v_accvgpr_write_b32 a94, 0
    v_accvgpr_write_b32 a95, 0
    v_accvgpr_write_b32 a96, 0
    v_accvgpr_write_b32 a97, 0
    v_accvgpr_write_b32 a98, 0
    v_accvgpr_write_b32 a99, 0
    v_accvgpr_write_b32 a100, 0
    v_accvgpr_write_b32 a101, 0
    v_accvgpr_write_b32 a102, 0
    v_accvgpr_write_b32 a103, 0
    v_accvgpr_write_b32 a104, 0
    v_accvgpr_write_b32 a105, 0
    v_accvgpr_write_b32 a106, 0
    v_accvgpr_write_b32 a107, 0
    v_accvgpr_write_b32 a108, 0
    v_accvgpr_write_b32 a109, 0
    v_accvgpr_write_b32 a110, 0
    v_accvgpr_write_b32 a111, 0
    v_accvgpr_write_b32 a112, 0
    v_accvgpr_write_b32 a113, 0
    v_accvgpr_write_b32 a114, 0
    v_accvgpr_write_b32 a115, 0
    v_accvgpr_write_b32 a116, 0
    v_accvgpr_write_b32 a117, 0
    v_accvgpr_write_b32 a118, 0
    v_accvgpr_write_b32 a119, 0
    v_accvgpr_write_b32 a120, 0
    v_accvgpr_write_b32 a121, 0
    v_accvgpr_write_b32 a122, 0
    v_accvgpr_write_b32 a123, 0
    v_accvgpr_write_b32 a124, 0
    v_accvgpr_write_b32 a125, 0
    v_accvgpr_write_b32 a126, 0
    v_accvgpr_write_b32 a127, 0
    v_mov_b32 v226, 0
    v_mov_b32 v227, 0
    v_mov_b32 v228, 0
    v_mov_b32 v229, 0
    v_mov_b32 v128, 0x3f803f80
    v_mov_b32 v129, 0x3f803f80
    v_mov_b32 v130, 0x3f803f80
    v_mov_b32 v131, 0x3f803f80
    v_mov_b32 v132, 0
    v_mov_b32 v133, 0
    v_mov_b32 v134, 0
    v_mov_b32 v135, 0
    v_mov_b32 v136, 0
    v_mov_b32 v137, 0
    v_mov_b32 v138, 0
    v_mov_b32 v139, 0
    s_mov_b32 s24, 32768
    s_waitcnt vmcnt(0) lgkmcnt(0)
    s_barrier
    ds_read_b128 a[128:131], v208 offset:49152
    ds_read_b128 a[132:135], v209 offset:49152
    ds_read_b128 a[136:139], v210 offset:49152
    ds_read_b128 a[140:143], v211 offset:49152
    s_and_b32 s58, s2, 3
    s_bfe_u32 s59, s2, 0x10002
    s_lshl_b32 s59, s59, 3
    s_bfe_u32 s6, s2, 0x30003
    s_add_u32 s59, s59, s6
    s_lshl_b32 s59, s59, 2
    s_lshr_b32 s6, s2, 6
    s_add_u32 s59, s59, s6
    s_mul_i32 s59, s59, 164096
    s_add_u32 s59, s59, 33554432
    s_lshl_b32 s58, s58, 13
    s_add_u32 s59, s59, s58
    s_lshl_b32 s6, s3, 11
    s_add_u32 s59, s59, s6
    v_lshlrev_b32 v8, 4, v1
    v_mov_b32 v4, -1
    v_mov_b32 v5, -1
    v_mov_b32 v6, -1
    v_mov_b32 v7, -1
    buffer_store_dwordx4 v[4:7], v8, s[20:23], s59 offen offset:0
    buffer_store_dwordx4 v[4:7], v8, s[20:23], s59 offen offset:1024
    s_add_u32 s59, s59, 32768
    buffer_store_dwordx4 v[4:7], v8, s[20:23], s59 offen offset:0
    buffer_store_dwordx4 v[4:7], v8, s[20:23], s59 offen offset:1024
    s_add_u32 s59, s59, 32768
    buffer_store_dwordx4 v[4:7], v8, s[20:23], s59 offen offset:0
    buffer_store_dwordx4 v[4:7], v8, s[20:23], s59 offen offset:1024
    s_add_u32 s59, s59, 32768
    buffer_store_dwordx4 v[4:7], v8, s[20:23], s59 offen offset:0
    buffer_store_dwordx4 v[4:7], v8, s[20:23], s59 offen offset:1024
    s_add_u32 s59, s59, 32768
    buffer_store_dwordx4 v[4:7], v8, s[20:23], s59 offen offset:0
    buffer_store_dwordx4 v[4:7], v8, s[20:23], s59 offen offset:1024
    s_waitcnt lgkmcnt(0)
    v_mfma_f32_16x16x32_bf16 v[16:19], a[128:131], v[144:147], 0
    v_mfma_f32_16x16x32_bf16 v[16:19], a[132:135], v[148:151], v[16:19]
    ds_read_b128 a[144:147], v208 offset:53248
    v_mfma_f32_16x16x32_bf16 v[16:19], a[136:139], v[152:155], v[16:19]
    v_mfma_f32_16x16x32_bf16 v[16:19], a[140:143], v[156:159], v[16:19]
    ds_read_b128 a[148:151], v209 offset:53248
    v_mfma_f32_16x16x32_bf16 v[20:23], a[128:131], v[160:163], 0
    v_mfma_f32_16x16x32_bf16 v[20:23], a[132:135], v[164:167], v[20:23]
    v_mfma_f32_16x16x32_bf16 v[20:23], a[136:139], v[168:171], v[20:23]
    v_mfma_f32_16x16x32_bf16 v[20:23], a[140:143], v[172:175], v[20:23]
    ds_read_b128 a[152:155], v210 offset:53248
    v_mfma_f32_16x16x32_bf16 v[24:27], a[128:131], v[176:179], 0
    v_mfma_f32_16x16x32_bf16 v[24:27], a[132:135], v[180:183], v[24:27]
    v_mfma_f32_16x16x32_bf16 v[24:27], a[136:139], v[184:187], v[24:27]
    v_mfma_f32_16x16x32_bf16 v[24:27], a[140:143], v[188:191], v[24:27]
    ds_read_b128 a[156:159], v211 offset:53248
    v_mfma_f32_16x16x32_bf16 v[28:31], a[128:131], v[192:195], 0
    v_mfma_f32_16x16x32_bf16 v[28:31], a[132:135], v[196:199], v[28:31]
    v_mfma_f32_16x16x32_bf16 v[28:31], a[136:139], v[200:203], v[28:31]
    v_mfma_f32_16x16x32_bf16 v[28:31], a[140:143], v[204:207], v[28:31]
    s_waitcnt lgkmcnt(0)
    v_mfma_f32_16x16x32_bf16 v[32:35], a[144:147], v[144:147], 0
    v_mfma_f32_16x16x32_bf16 v[32:35], a[148:151], v[148:151], v[32:35]
    ds_read_b128 a[128:131], v208 offset:57344
    v_mfma_f32_16x16x32_bf16 v[32:35], a[152:155], v[152:155], v[32:35]
    v_mfma_f32_16x16x32_bf16 v[32:35], a[156:159], v[156:159], v[32:35]
    ds_read_b128 a[132:135], v209 offset:57344
    v_mfma_f32_16x16x32_bf16 v[36:39], a[144:147], v[160:163], 0
    v_mfma_f32_16x16x32_bf16 v[36:39], a[148:151], v[164:167], v[36:39]
    v_mfma_f32_16x16x32_bf16 v[36:39], a[152:155], v[168:171], v[36:39]
    v_mfma_f32_16x16x32_bf16 v[36:39], a[156:159], v[172:175], v[36:39]
    ds_read_b128 a[136:139], v210 offset:57344
    v_mfma_f32_16x16x32_bf16 v[40:43], a[144:147], v[176:179], 0
    v_mfma_f32_16x16x32_bf16 v[40:43], a[148:151], v[180:183], v[40:43]
    v_mfma_f32_16x16x32_bf16 v[40:43], a[152:155], v[184:187], v[40:43]
    v_mfma_f32_16x16x32_bf16 v[40:43], a[156:159], v[188:191], v[40:43]
    ds_read_b128 a[140:143], v211 offset:57344
    v_mfma_f32_16x16x32_bf16 v[44:47], a[144:147], v[192:195], 0
    v_mfma_f32_16x16x32_bf16 v[44:47], a[148:151], v[196:199], v[44:47]
    v_mfma_f32_16x16x32_bf16 v[44:47], a[152:155], v[200:203], v[44:47]
    v_mfma_f32_16x16x32_bf16 v[44:47], a[156:159], v[204:207], v[44:47]
    s_cmp_lg_u32 s27, 0
    s_cbranch_scc1 K_havemax
    s_nop 7
    v_max3_f32 v244, v16, v17, v18
    v_max3_f32 v244, v244, v19, v32
    v_max3_f32 v244, v244, v33, v34
    v_max_f32 v244, v244, v35
    v_mov_b32 v248, v244
    s_nop 1
    v_permlane32_swap_b32 v248, v244
    v_max_f32 v244, v244, v248
    v_mov_b32 v248, v244
    s_nop 1
    v_permlane16_swap_b32 v248, v244
    v_max_f32 v244, v244, v248
    v_max3_f32 v245, v20, v21, v22
    v_max3_f32 v245, v245, v23, v36
    v_max3_f32 v245, v245, v37, v38
    v_max_f32 v245, v245, v39
    v_mov_b32 v248, v245
    s_nop 1
    v_permlane32_swap_b32 v248, v245
    v_max_f32 v245, v245, v248
    v_mov_b32 v248, v245
    s_nop 1
    v_permlane16_swap_b32 v248, v245
    v_max_f32 v245, v245, v248
    v_max3_f32 v246, v24, v25, v26
    v_max3_f32 v246, v246, v27, v40
    v_max3_f32 v246, v246, v41, v42
    v_max_f32 v246, v246, v43
    v_mov_b32 v248, v246
    s_nop 1
    v_permlane32_swap_b32 v248, v246
    v_max_f32 v246, v246, v248
    v_mov_b32 v248, v246
    s_nop 1
    v_permlane16_swap_b32 v248, v246
    v_max_f32 v246, v246, v248
    v_max3_f32 v247, v28, v29, v30
    v_max3_f32 v247, v247, v31, v44
    v_max3_f32 v247, v247, v45, v46
    v_max_f32 v247, v247, v47
    v_mov_b32 v248, v247
    s_nop 1
    v_permlane32_swap_b32 v248, v247
    v_max_f32 v247, v247, v248
    v_mov_b32 v248, v247
    s_nop 1
    v_permlane16_swap_b32 v248, v247
    v_max_f32 v247, v247, v248
K_havemax:
    s_nop 7
    v_sub_f32 v112, 0, v244
    v_sub_f32 v113, 0, v244
    v_sub_f32 v114, 0, v244
    v_sub_f32 v115, 0, v244
    v_sub_f32 v16, v16, v244
    v_sub_f32 v17, v17, v244
    v_sub_f32 v18, v18, v244
    v_sub_f32 v19, v19, v244
    v_sub_f32 v32, v32, v244
    v_sub_f32 v33, v33, v244
    v_sub_f32 v34, v34, v244
    v_sub_f32 v35, v35, v244
    v_sub_f32 v116, 0, v245
    v_sub_f32 v117, 0, v245
    v_sub_f32 v118, 0, v245
    v_sub_f32 v119, 0, v245
    v_sub_f32 v20, v20, v245
    v_sub_f32 v21, v21, v245
    v_sub_f32 v22, v22, v245
    v_sub_f32 v23, v23, v245
    v_sub_f32 v36, v36, v245
    v_sub_f32 v37, v37, v245
    v_sub_f32 v38, v38, v245
    v_sub_f32 v39, v39, v245
    v_sub_f32 v120, 0, v246
    v_sub_f32 v121, 0, v246
    v_sub_f32 v122, 0, v246
    v_sub_f32 v123, 0, v246
    v_sub_f32 v24, v24, v246
    v_sub_f32 v25, v25, v246
    v_sub_f32 v26, v26, v246
    v_sub_f32 v27, v27, v246
    v_sub_f32 v40, v40, v246
    v_sub_f32 v41, v41, v246
    v_sub_f32 v42, v42, v246
    v_sub_f32 v43, v43, v246
    v_sub_f32 v124, 0, v247
    v_sub_f32 v125, 0, v247
    v_sub_f32 v126, 0, v247
    v_sub_f32 v127, 0, v247
    v_sub_f32 v28, v28, v247
    v_sub_f32 v29, v29, v247
    v_sub_f32 v30, v30, v247
    v_sub_f32 v31, v31, v247
    v_sub_f32 v44, v44, v247
    v_sub_f32 v45, v45, v247
    v_sub_f32 v46, v46, v247
    v_sub_f32 v47, v47, v247
    s_waitcnt lgkmcnt(0)
    v_mfma_f32_16x16x32_bf16 v[48:51], a[128:131], v[144:147], v[112:115]
    v_exp_f32 v16, v16
    v_mfma_f32_16x16x32_bf16 v[48:51], a[132:135], v[148:151], v[48:51]
    ds_read_b128 a[144:147], v208 offset:61440
    v_add_f32 v226, v226, v16
    v_mfma_f32_16x16x32_bf16 v[48:51], a[136:139], v[152:155], v[48:51]
    v_exp_f32 v17, v17
    v_mfma_f32_16x16x32_bf16 v[48:51], a[140:143], v[156:159], v[48:51]
    v_exp_f32 v18, v18
    v_exp_f32 v19, v19
    ds_read_b128 a[148:151], v209 offset:61440
    v_add_f32 v226, v226, v17
    v_cvt_pk_bf16_f32 v80, v16, v17
    v_exp_f32 v20, v20
    v_add_f32 v226, v226, v18
    v_add_f32 v226, v226, v19
    v_mfma_f32_16x16x32_bf16 v[52:55], a[128:131], v[160:163], v[116:119]
    v_cvt_pk_bf16_f32 v81, v18, v19
    v_add_f32 v227, v227, v20
    v_mfma_f32_16x16x32_bf16 v[52:55], a[132:135], v[164:167], v[52:55]
    v_exp_f32 v21, v21
    v_mfma_f32_16x16x32_bf16 v[52:55], a[136:139], v[168:171], v[52:55]
    v_cvt_pk_bf16_f32 v84, v20, v21
    v_add_f32 v227, v227, v21
    v_mfma_f32_16x16x32_bf16 v[52:55], a[140:143], v[172:175], v[52:55]
    v_exp_f32 v22, v22
    s_nop 0
    v_add_f32 v227, v227, v22
    ds_read_b128 a[152:155], v210 offset:61440
    v_exp_f32 v23, v23
    s_nop 0
    v_cvt_pk_bf16_f32 v85, v22, v23
    v_add_f32 v227, v227, v23
    v_exp_f32 v24, v24
    v_mfma_f32_16x16x32_bf16 v[56:59], a[128:131], v[176:179], v[120:123]
    v_mfma_f32_16x16x32_bf16 v[56:59], a[132:135], v[180:183], v[56:59]
    v_exp_f32 v25, v25
    v_mfma_f32_16x16x32_bf16 v[56:59], a[136:139], v[184:187], v[56:59]
    v_cvt_pk_bf16_f32 v88, v24, v25
    v_mfma_f32_16x16x32_bf16 v[56:59], a[140:143], v[188:191], v[56:59]
    v_exp_f32 v26, v26
    ds_read_b128 a[156:159], v211 offset:61440
    v_exp_f32 v27, v27
    s_nop 0
    v_cvt_pk_bf16_f32 v89, v26, v27
    v_exp_f32 v28, v28
    v_mfma_f32_16x16x32_bf16 v[60:63], a[128:131], v[192:195], v[124:127]
    v_mfma_f32_16x16x32_bf16 v[60:63], a[132:135], v[196:199], v[60:63]
    v_exp_f32 v29, v29
    v_mfma_f32_16x16x32_bf16 v[60:63], a[136:139], v[200:203], v[60:63]
    v_cvt_pk_bf16_f32 v92, v28, v29
    v_mfma_f32_16x16x32_bf16 v[60:63], a[140:143], v[204:207], v[60:63]
    v_exp_f32 v30, v30
    v_exp_f32 v31, v31
    s_nop 0
    v_cvt_pk_bf16_f32 v93, v30, v31
    v_exp_f32 v32, v32
    s_nop 0
    v_add_f32 v226, v226, v32
    s_waitcnt vmcnt(8) lgkmcnt(0)
    s_barrier
    v_mfma_f32_16x16x32_bf16 v[64:67], a[144:147], v[144:147], v[112:115]
    v_exp_f32 v33, v33
    v_mfma_f32_16x16x32_bf16 v[64:67], a[148:151], v[148:151], v[64:67]
    ds_read_b128 a[128:131], v208 offset:0
    v_cvt_pk_bf16_f32 v82, v32, v33
    v_mfma_f32_16x16x32_bf16 v[64:67], a[152:155], v[152:155], v[64:67]
    v_exp_f32 v34, v34
    v_mfma_f32_16x16x32_bf16 v[64:67], a[156:159], v[156:159], v[64:67]
    ds_read_b64_tr_b16 a[160:161], v212 offset:0
    v_add_f32 v226, v226, v33
    v_exp_f32 v35, v35
    ds_read_b128 a[132:135], v209 offset:0
    v_cvt_pk_bf16_f32 v83, v34, v35
    s_add_u32 m0, s25, 32768
    s_nop 0
    buffer_load_dwordx4 v220, s[8:11], s24 offen lds
    v_exp_f32 v36, v36
    ds_read_b64_tr_b16 a[162:163], v212 offset:4096
    v_add_f32 v226, v226, v34
    v_add_f32 v226, v226, v35
    v_mfma_f32_16x16x32_bf16 v[68:71], a[144:147], v[160:163], v[116:119]
    v_add_f32 v227, v227, v36
    v_mfma_f32_16x16x32_bf16 v[68:71], a[148:151], v[164:167], v[68:71]
    v_exp_f32 v37, v37
    v_mfma_f32_16x16x32_bf16 v[68:71], a[152:155], v[168:171], v[68:71]
    v_cvt_pk_bf16_f32 v86, v36, v37
    v_add_f32 v227, v227, v37
    v_mfma_f32_16x16x32_bf16 v[68:71], a[156:159], v[172:175], v[68:71]
    ds_read_b64_tr_b16 a[164:165], v213 offset:0
    v_exp_f32 v38, v38
    ds_read_b128 a[136:139], v210 offset:0
    v_exp_f32 v39, v39
    buffer_load_dwordx4 v221, s[8:11], s24 offen offset:1024 lds
    v_cvt_pk_bf16_f32 v87, v38, v39
    v_add_f32 v227, v227, v38
    ds_read_b64_tr_b16 a[166:167], v213 offset:4096
    v_exp_f32 v40, v40
    v_mfma_f32_16x16x32_bf16 v[72:75], a[144:147], v[176:179], v[120:123]
    v_add_f32 v227, v227, v39
    v_mfma_f32_16x16x32_bf16 v[72:75], a[148:151], v[180:183], v[72:75]
    v_exp_f32 v41, v41
    v_mfma_f32_16x16x32_bf16 v[72:75], a[152:155], v[184:187], v[72:75]
    v_cvt_pk_bf16_f32 v90, v40, v41
    v_mfma_f32_16x16x32_bf16 v[72:75], a[156:159], v[188:191], v[72:75]
    ds_read_b64_tr_b16 a[168:169], v214 offset:0
    v_exp_f32 v42, v42
    ds_read_b128 a[140:143], v211 offset:0
    v_exp_f32 v43, v43
    buffer_load_dwordx4 v222, s[8:11], s24 offen offset:2048 lds
    v_cvt_pk_bf16_f32 v91, v42, v43
    ds_read_b64_tr_b16 a[170:171], v214 offset:4096
    v_exp_f32 v44, v44
    v_mfma_f32_16x16x32_bf16 v[76:79], a[144:147], v[192:195], v[124:127]
    v_mfma_f32_16x16x32_bf16 v[76:79], a[148:151], v[196:199], v[76:79]
    v_exp_f32 v45, v45
    v_mfma_f32_16x16x32_bf16 v[76:79], a[152:155], v[200:203], v[76:79]
    v_cvt_pk_bf16_f32 v94, v44, v45
    v_mfma_f32_16x16x32_bf16 v[76:79], a[156:159], v[204:207], v[76:79]
    ds_read_b64_tr_b16 a[172:173], v215 offset:0
    v_exp_f32 v46, v46
    v_exp_f32 v47, v47
    s_nop 0
    v_cvt_pk_bf16_f32 v95, v46, v47
    ds_read_b64_tr_b16 a[174:175], v215 offset:4096
    s_mov_b32 s26, 7
K_aloop:
    s_waitcnt lgkmcnt(3)
    v_mfma_f32_16x16x32_bf16 v[16:19], a[128:131], v[144:147], v[112:115]
    v_exp_f32 v48, v48
    v_mfma_f32_16x16x32_bf16 v[16:19], a[132:135], v[148:151], v[16:19]
    ds_read_b128 a[144:147], v208 offset:4096
    v_add_f32 v226, v226, v48
    v_mfma_f32_16x16x32_bf16 v[16:19], a[136:139], v[152:155], v[16:19]
    v_exp_f32 v49, v49
    v_mfma_f32_16x16x32_bf16 v[16:19], a[140:143], v[156:159], v[16:19]
    ds_read_b64_tr_b16 a[176:177], v216 offset:0
    v_add_f32 v226, v226, v49
    v_mfma_f32_16x16x32_bf16 a[0:3], a[160:163], v[80:83], a[0:3]
    v_exp_f32 v50, v50
    v_mfma_f32_16x16x32_bf16 a[4:7], a[160:163], v[84:87], a[4:7]
    ds_read_b128 a[148:151], v209 offset:4096
    v_cvt_pk_bf16_f32 v96, v48, v49
    v_mfma_f32_16x16x32_bf16 a[8:11], a[160:163], v[88:91], a[8:11]
    buffer_load_dwordx4 v223, s[8:11], s24 offen offset:3072 lds
    v_add_f32 v226, v226, v50
    v_mfma_f32_16x16x32_bf16 a[12:15], a[160:163], v[92:95], a[12:15]
    ds_read_b64_tr_b16 a[178:179], v216 offset:4096
    v_mfma_f32_16x16x32_bf16 v[20:23], a[128:131], v[160:163], v[116:119]
    v_exp_f32 v51, v51
    v_mfma_f32_16x16x32_bf16 v[20:23], a[132:135], v[164:167], v[20:23]
    v_exp_f32 v52, v52
    v_mfma_f32_16x16x32_bf16 v[20:23], a[136:139], v[168:171], v[20:23]
    v_exp_f32 v53, v53
    v_mfma_f32_16x16x32_bf16 v[20:23], a[140:143], v[172:175], v[20:23]
    ds_read_b64_tr_b16 a[180:181], v217 offset:0
    v_add_f32 v226, v226, v51
    v_mfma_f32_16x16x32_bf16 a[16:19], a[164:167], v[80:83], a[16:19]
    v_exp_f32 v54, v54
    v_mfma_f32_16x16x32_bf16 a[20:23], a[164:167], v[84:87], a[20:23]
    ds_read_b128 a[152:155], v210 offset:4096
    s_add_u32 m0, s25, 98304
    v_mfma_f32_16x16x32_bf16 a[24:27], a[164:167], v[88:91], a[24:27]
    buffer_load_dwordx4 v224, s[12:15], s24 offen lds
    v_cvt_pk_bf16_f32 v97, v50, v51
    v_mfma_f32_16x16x32_bf16 a[28:31], a[164:167], v[92:95], a[28:31]
    ds_read_b64_tr_b16 a[182:183], v217 offset:4096
    v_cvt_pk_bf16_f32 v100, v52, v53
    v_mfma_f32_16x16x32_bf16 v[24:27], a[128:131], v[176:179], v[120:123]
    v_exp_f32 v55, v55
    v_mfma_f32_16x16x32_bf16 v[24:27], a[132:135], v[180:183], v[24:27]
    v_exp_f32 v56, v56
    v_mfma_f32_16x16x32_bf16 v[24:27], a[136:139], v[184:187], v[24:27]
    v_exp_f32 v57, v57
    v_mfma_f32_16x16x32_bf16 v[24:27], a[140:143], v[188:191], v[24:27]
    ds_read_b64_tr_b16 a[184:185], v218 offset:0
    s_waitcnt lgkmcnt(8)
    v_mfma_f32_16x16x32_bf16 a[32:35], a[168:171], v[80:83], a[32:35]
    v_exp_f32 v58, v58
    v_mfma_f32_16x16x32_bf16 a[36:39], a[168:171], v[84:87], a[36:39]
    ds_read_b128 a[156:159], v211 offset:4096
    v_cvt_pk_bf16_f32 v101, v54, v55
    v_mfma_f32_16x16x32_bf16 a[40:43], a[168:171], v[88:91], a[40:43]
    buffer_load_dwordx4 v225, s[12:15], s24 offen offset:1024 lds
    v_cvt_pk_bf16_f32 v104, v56, v57
    v_mfma_f32_16x16x32_bf16 a[44:47], a[168:171], v[92:95], a[44:47]
    ds_read_b64_tr_b16 a[186:187], v218 offset:4096
    v_add_f32 v227, v227, v52
    v_mfma_f32_16x16x32_bf16 v[28:31], a[128:131], v[192:195], v[124:127]
    v_exp_f32 v59, v59
    v_mfma_f32_16x16x32_bf16 v[28:31], a[132:135], v[196:199], v[28:31]
    v_exp_f32 v60, v60
    v_mfma_f32_16x16x32_bf16 v[28:31], a[136:139], v[200:203], v[28:31]
    v_exp_f32 v61, v61
    v_mfma_f32_16x16x32_bf16 v[28:31], a[140:143], v[204:207], v[28:31]
    ds_read_b64_tr_b16 a[188:189], v219 offset:0
    v_cvt_pk_bf16_f32 v105, v58, v59
    v_mfma_f32_16x16x32_bf16 a[48:51], a[172:175], v[80:83], a[48:51]
    v_exp_f32 v62, v62
    v_mfma_f32_16x16x32_bf16 a[52:55], a[172:175], v[84:87], a[52:55]
    v_exp_f32 v63, v63
    v_mfma_f32_16x16x32_bf16 a[56:59], a[172:175], v[88:91], a[56:59]
    buffer_load_dwordx4 v224, s[12:15], s24 offen offset:2048 lds
    v_cvt_pk_bf16_f32 v108, v60, v61
    v_mfma_f32_16x16x32_bf16 a[60:63], a[172:175], v[92:95], a[60:63]
    ds_read_b64_tr_b16 a[190:191], v219 offset:4096
    v_cvt_pk_bf16_f32 v109, v62, v63
    v_mfma_f32_16x16x32_bf16 v[132:135], v[128:131], v[88:91], v[132:135]
    v_add_f32 v227, v227, v53
    s_waitcnt lgkmcnt(3)
    v_mfma_f32_16x16x32_bf16 v[32:35], a[144:147], v[144:147], v[112:115]
    v_exp_f32 v64, v64
    v_mfma_f32_16x16x32_bf16 v[32:35], a[148:151], v[148:151], v[32:35]
    ds_read_b128 a[128:131], v208 offset:8192
    v_add_f32 v227, v227, v54
    v_mfma_f32_16x16x32_bf16 v[32:35], a[152:155], v[152:155], v[32:35]
    v_exp_f32 v65, v65
    v_mfma_f32_16x16x32_bf16 v[32:35], a[156:159], v[156:159], v[32:35]
    ds_read_b64_tr_b16 a[160:161], v212 offset:8192
    v_cvt_pk_bf16_f32 v98, v64, v65
    v_mfma_f32_16x16x32_bf16 a[64:67], a[176:179], v[80:83], a[64:67]
    v_exp_f32 v66, v66
    v_mfma_f32_16x16x32_bf16 a[68:71], a[176:179], v[84:87], a[68:71]
    ds_read_b128 a[132:135], v209 offset:8192
    v_add_f32 v227, v227, v55
    v_mfma_f32_16x16x32_bf16 a[72:75], a[176:179], v[88:91], a[72:75]
    buffer_load_dwordx4 v225, s[12:15], s24 offen offset:3072 lds
    v_add_f32 v226, v226, v64
    v_mfma_f32_16x16x32_bf16 a[76:79], a[176:179], v[92:95], a[76:79]
    ds_read_b64_tr_b16 a[162:163], v212 offset:12288
    v_add_f32 v226, v226, v65
    v_mfma_f32_16x16x32_bf16 v[36:39], a[144:147], v[160:163], v[116:119]
    v_exp_f32 v67, v67
    v_mfma_f32_16x16x32_bf16 v[36:39], a[148:151], v[164:167], v[36:39]
    v_exp_f32 v68, v68
    v_mfma_f32_16x16x32_bf16 v[36:39], a[152:155], v[168:171], v[36:39]
    v_exp_f32 v69, v69
    v_mfma_f32_16x16x32_bf16 v[36:39], a[156:159], v[172:175], v[36:39]
    ds_read_b64_tr_b16 a[164:165], v213 offset:8192
    v_cvt_pk_bf16_f32 v99, v66, v67
    v_mfma_f32_16x16x32_bf16 a[80:83], a[180:183], v[80:83], a[80:83]
    v_exp_f32 v70, v70
    v_mfma_f32_16x16x32_bf16 a[84:87], a[180:183], v[84:87], a[84:87]
    ds_read_b128 a[136:139], v210 offset:8192
    v_cvt_pk_bf16_f32 v102, v68, v69
    v_mfma_f32_16x16x32_bf16 a[88:91], a[180:183], v[88:91], a[88:91]
    v_exp_f32 v71, v71
    v_mfma_f32_16x16x32_bf16 a[92:95], a[180:183], v[92:95], a[92:95]
    ds_read_b64_tr_b16 a[166:167], v213 offset:12288
    s_add_u32 s24, s24, 16384
    v_mfma_f32_16x16x32_bf16 v[40:43], a[144:147], v[176:179], v[120:123]
    v_exp_f32 v72, v72
    v_mfma_f32_16x16x32_bf16 v[40:43], a[148:151], v[180:183], v[40:43]
    v_exp_f32 v73, v73
    v_mfma_f32_16x16x32_bf16 v[40:43], a[152:155], v[184:187], v[40:43]
    v_cvt_pk_bf16_f32 v103, v70, v71
    v_cvt_pk_bf16_f32 v106, v72, v73
    v_mfma_f32_16x16x32_bf16 v[40:43], a[156:159], v[188:191], v[40:43]
    ds_read_b64_tr_b16 a[168:169], v214 offset:8192
    s_waitcnt lgkmcnt(8)
    v_mfma_f32_16x16x32_bf16 a[96:99], a[184:187], v[80:83], a[96:99]
    v_exp_f32 v74, v74
    v_mfma_f32_16x16x32_bf16 a[100:103], a[184:187], v[84:87], a[100:103]
    ds_read_b128 a[140:143], v211 offset:8192
    v_add_f32 v226, v226, v66
    v_mfma_f32_16x16x32_bf16 a[104:107], a[184:187], v[88:91], a[104:107]
    v_exp_f32 v75, v75
    v_mfma_f32_16x16x32_bf16 a[108:111], a[184:187], v[92:95], a[108:111]
    ds_read_b64_tr_b16 a[170:171], v214 offset:12288
    v_cvt_pk_bf16_f32 v107, v74, v75
    v_mfma_f32_16x16x32_bf16 v[44:47], a[144:147], v[192:195], v[124:127]
    v_exp_f32 v76, v76
    v_mfma_f32_16x16x32_bf16 v[44:47], a[148:151], v[196:199], v[44:47]
    v_exp_f32 v77, v77
    v_mfma_f32_16x16x32_bf16 v[44:47], a[152:155], v[200:203], v[44:47]
    v_cvt_pk_bf16_f32 v110, v76, v77
    v_add_f32 v226, v226, v67
    v_mfma_f32_16x16x32_bf16 v[44:47], a[156:159], v[204:207], v[44:47]
    ds_read_b64_tr_b16 a[172:173], v215 offset:8192
    v_add_f32 v227, v227, v68
    v_mfma_f32_16x16x32_bf16 a[112:115], a[188:191], v[80:83], a[112:115]
    v_exp_f32 v78, v78
    v_mfma_f32_16x16x32_bf16 a[116:119], a[188:191], v[84:87], a[116:119]
    v_exp_f32 v79, v79
    v_mfma_f32_16x16x32_bf16 a[120:123], a[188:191], v[88:91], a[120:123]
    v_cvt_pk_bf16_f32 v111, v78, v79
    v_add_f32 v227, v227, v69
    v_mfma_f32_16x16x32_bf16 a[124:127], a[188:191], v[92:95], a[124:127]
    ds_read_b64_tr_b16 a[174:175], v215 offset:12288
    v_add_f32 v227, v227, v70
    v_mfma_f32_16x16x32_bf16 v[136:139], v[128:131], v[92:95], v[136:139]
    v_add_f32 v227, v227, v71
    s_waitcnt lgkmcnt(3)
    v_mfma_f32_16x16x32_bf16 v[48:51], a[128:131], v[144:147], v[112:115]
    v_exp_f32 v16, v16
    v_mfma_f32_16x16x32_bf16 v[48:51], a[132:135], v[148:151], v[48:51]
    ds_read_b128 a[144:147], v208 offset:12288
    v_add_f32 v226, v226, v16
    v_mfma_f32_16x16x32_bf16 v[48:51], a[136:139], v[152:155], v[48:51]
    v_exp_f32 v17, v17
    v_mfma_f32_16x16x32_bf16 v[48:51], a[140:143], v[156:159], v[48:51]
    ds_read_b64_tr_b16 a[176:177], v216 offset:8192
    v_add_f32 v226, v226, v17
    v_mfma_f32_16x16x32_bf16 a[0:3], a[160:163], v[96:99], a[0:3]
    v_exp_f32 v18, v18
    v_mfma_f32_16x16x32_bf16 a[4:7], a[160:163], v[100:103], a[4:7]
    ds_read_b128 a[148:151], v209 offset:12288
    v_cvt_pk_bf16_f32 v80, v16, v17
    v_mfma_f32_16x16x32_bf16 a[8:11], a[160:163], v[104:107], a[8:11]
    v_exp_f32 v19, v19
    v_mfma_f32_16x16x32_bf16 a[12:15], a[160:163], v[108:111], a[12:15]
    ds_read_b64_tr_b16 a[178:179], v216 offset:12288
    v_add_f32 v226, v226, v18
    v_mfma_f32_16x16x32_bf16 v[52:55], a[128:131], v[160:163], v[116:119]
    v_exp_f32 v20, v20
    v_mfma_f32_16x16x32_bf16 v[52:55], a[132:135], v[164:167], v[52:55]
    v_exp_f32 v21, v21
    v_mfma_f32_16x16x32_bf16 v[52:55], a[136:139], v[168:171], v[52:55]
    v_add_f32 v226, v226, v19
    v_cvt_pk_bf16_f32 v81, v18, v19
    v_mfma_f32_16x16x32_bf16 v[52:55], a[140:143], v[172:175], v[52:55]
    ds_read_b64_tr_b16 a[180:181], v217 offset:8192
    v_cvt_pk_bf16_f32 v84, v20, v21
    v_mfma_f32_16x16x32_bf16 a[16:19], a[164:167], v[96:99], a[16:19]
    v_exp_f32 v22, v22
    v_mfma_f32_16x16x32_bf16 a[20:23], a[164:167], v[100:103], a[20:23]
    ds_read_b128 a[152:155], v210 offset:12288
    v_add_f32 v227, v227, v20
    v_mfma_f32_16x16x32_bf16 a[24:27], a[164:167], v[104:107], a[24:27]
    v_exp_f32 v23, v23
    v_mfma_f32_16x16x32_bf16 a[28:31], a[164:167], v[108:111], a[28:31]
    ds_read_b64_tr_b16 a[182:183], v217 offset:12288
    v_cvt_pk_bf16_f32 v85, v22, v23
    v_mfma_f32_16x16x32_bf16 v[56:59], a[128:131], v[176:179], v[120:123]
    v_exp_f32 v24, v24
    v_mfma_f32_16x16x32_bf16 v[56:59], a[132:135], v[180:183], v[56:59]
    v_exp_f32 v25, v25
    v_mfma_f32_16x16x32_bf16 v[56:59], a[136:139], v[184:187], v[56:59]
    v_cvt_pk_bf16_f32 v88, v24, v25
    v_add_f32 v227, v227, v21
    v_mfma_f32_16x16x32_bf16 v[56:59], a[140:143], v[188:191], v[56:59]
    ds_read_b64_tr_b16 a[184:185], v218 offset:8192
    s_waitcnt lgkmcnt(8)
    v_mfma_f32_16x16x32_bf16 a[32:35], a[168:171], v[96:99], a[32:35]
    v_exp_f32 v26, v26
    v_mfma_f32_16x16x32_bf16 a[36:39], a[168:171], v[100:103], a[36:39]
    ds_read_b128 a[156:159], v211 offset:12288
    v_add_f32 v227, v227, v22
    v_mfma_f32_16x16x32_bf16 a[40:43], a[168:171], v[104:107], a[40:43]
    v_exp_f32 v27, v27
    v_mfma_f32_16x16x32_bf16 a[44:47], a[168:171], v[108:111], a[44:47]
    ds_read_b64_tr_b16 a[186:187], v218 offset:12288
    v_cvt_pk_bf16_f32 v89, v26, v27
    v_mfma_f32_16x16x32_bf16 v[60:63], a[128:131], v[192:195], v[124:127]
    v_exp_f32 v28, v28
    v_mfma_f32_16x16x32_bf16 v[60:63], a[132:135], v[196:199], v[60:63]
    v_exp_f32 v29, v29
    v_mfma_f32_16x16x32_bf16 v[60:63], a[136:139], v[200:203], v[60:63]
    v_cvt_pk_bf16_f32 v92, v28, v29
    v_add_f32 v227, v227, v23
    v_mfma_f32_16x16x32_bf16 v[60:63], a[140:143], v[204:207], v[60:63]
    ds_read_b64_tr_b16 a[188:189], v219 offset:8192
    v_mfma_f32_16x16x32_bf16 a[48:51], a[172:175], v[96:99], a[48:51]
    v_exp_f32 v30, v30
    v_mfma_f32_16x16x32_bf16 a[52:55], a[172:175], v[100:103], a[52:55]
    v_exp_f32 v31, v31
    v_mfma_f32_16x16x32_bf16 a[56:59], a[172:175], v[104:107], a[56:59]
    v_cvt_pk_bf16_f32 v93, v30, v31
    v_mfma_f32_16x16x32_bf16 a[60:63], a[172:175], v[108:111], a[60:63]
    ds_read_b64_tr_b16 a[190:191], v219 offset:12288
    v_mfma_f32_16x16x32_bf16 v[132:135], v[128:131], v[104:107], v[132:135]
    s_waitcnt vmcnt(8) lgkmcnt(3)
    s_barrier
    v_mfma_f32_16x16x32_bf16 v[64:67], a[144:147], v[144:147], v[112:115]
    v_exp_f32 v32, v32
    v_mfma_f32_16x16x32_bf16 v[64:67], a[148:151], v[148:151], v[64:67]
    ds_read_b128 a[128:131], v208 offset:16384
    v_add_f32 v226, v226, v32
    v_mfma_f32_16x16x32_bf16 v[64:67], a[152:155], v[152:155], v[64:67]
    v_exp_f32 v33, v33
    v_mfma_f32_16x16x32_bf16 v[64:67], a[156:159], v[156:159], v[64:67]
    ds_read_b64_tr_b16 a[160:161], v212 offset:16384
    v_cvt_pk_bf16_f32 v82, v32, v33
    v_mfma_f32_16x16x32_bf16 a[64:67], a[176:179], v[96:99], a[64:67]
    v_exp_f32 v34, v34
    v_mfma_f32_16x16x32_bf16 a[68:71], a[176:179], v[100:103], a[68:71]
    ds_read_b128 a[132:135], v209 offset:16384
    s_add_u32 m0, s25, 49152
    v_mfma_f32_16x16x32_bf16 a[72:75], a[176:179], v[104:107], a[72:75]
    buffer_load_dwordx4 v220, s[8:11], s24 offen lds
    v_add_f32 v226, v226, v33
    v_mfma_f32_16x16x32_bf16 a[76:79], a[176:179], v[108:111], a[76:79]
    ds_read_b64_tr_b16 a[162:163], v212 offset:20480
    v_add_f32 v226, v226, v34
    v_mfma_f32_16x16x32_bf16 v[68:71], a[144:147], v[160:163], v[116:119]
    v_exp_f32 v35, v35
    v_mfma_f32_16x16x32_bf16 v[68:71], a[148:151], v[164:167], v[68:71]
    v_exp_f32 v36, v36
    v_mfma_f32_16x16x32_bf16 v[68:71], a[152:155], v[168:171], v[68:71]
    v_exp_f32 v37, v37
    v_mfma_f32_16x16x32_bf16 v[68:71], a[156:159], v[172:175], v[68:71]
    ds_read_b64_tr_b16 a[164:165], v213 offset:16384
    v_cvt_pk_bf16_f32 v83, v34, v35
    v_mfma_f32_16x16x32_bf16 a[80:83], a[180:183], v[96:99], a[80:83]
    v_exp_f32 v38, v38
    v_mfma_f32_16x16x32_bf16 a[84:87], a[180:183], v[100:103], a[84:87]
    ds_read_b128 a[136:139], v210 offset:16384
    v_cvt_pk_bf16_f32 v86, v36, v37
    v_mfma_f32_16x16x32_bf16 a[88:91], a[180:183], v[104:107], a[88:91]
    buffer_load_dwordx4 v221, s[8:11], s24 offen offset:1024 lds
    v_add_f32 v226, v226, v35
    v_mfma_f32_16x16x32_bf16 a[92:95], a[180:183], v[108:111], a[92:95]
    ds_read_b64_tr_b16 a[166:167], v213 offset:20480
    v_add_f32 v227, v227, v36
    v_mfma_f32_16x16x32_bf16 v[72:75], a[144:147], v[176:179], v[120:123]
    v_exp_f32 v39, v39
    v_mfma_f32_16x16x32_bf16 v[72:75], a[148:151], v[180:183], v[72:75]
    v_exp_f32 v40, v40
    v_mfma_f32_16x16x32_bf16 v[72:75], a[152:155], v[184:187], v[72:75]
    v_exp_f32 v41, v41
    v_mfma_f32_16x16x32_bf16 v[72:75], a[156:159], v[188:191], v[72:75]
    ds_read_b64_tr_b16 a[168:169], v214 offset:16384
    s_waitcnt lgkmcnt(8)
    v_mfma_f32_16x16x32_bf16 a[96:99], a[184:187], v[96:99], a[96:99]
    v_exp_f32 v42, v42
    v_mfma_f32_16x16x32_bf16 a[100:103], a[184:187], v[100:103], a[100:103]
    ds_read_b128 a[140:143], v211 offset:16384
    v_cvt_pk_bf16_f32 v87, v38, v39
    v_mfma_f32_16x16x32_bf16 a[104:107], a[184:187], v[104:107], a[104:107]
    buffer_load_dwordx4 v222, s[8:11], s24 offen offset:2048 lds
    v_cvt_pk_bf16_f32 v90, v40, v41
    v_mfma_f32_16x16x32_bf16 a[108:111], a[184:187], v[108:111], a[108:111]
    ds_read_b64_tr_b16 a[170:171], v214 offset:20480
    v_add_f32 v227, v227, v37
    v_mfma_f32_16x16x32_bf16 v[76:79], a[144:147], v[192:195], v[124:127]
    v_exp_f32 v43, v43
    v_mfma_f32_16x16x32_bf16 v[76:79], a[148:151], v[196:199], v[76:79]
    v_exp_f32 v44, v44
    v_mfma_f32_16x16x32_bf16 v[76:79], a[152:155], v[200:203], v[76:79]
    v_exp_f32 v45, v45
    v_mfma_f32_16x16x32_bf16 v[76:79], a[156:159], v[204:207], v[76:79]
    ds_read_b64_tr_b16 a[172:173], v215 offset:16384
    v_cvt_pk_bf16_f32 v91, v42, v43
    v_mfma_f32_16x16x32_bf16 a[112:115], a[188:191], v[96:99], a[112:115]
    v_exp_f32 v46, v46
    v_mfma_f32_16x16x32_bf16 a[116:119], a[188:191], v[100:103], a[116:119]
    v_exp_f32 v47, v47
    v_mfma_f32_16x16x32_bf16 a[120:123], a[188:191], v[104:107], a[120:123]
    v_cvt_pk_bf16_f32 v94, v44, v45
    v_cvt_pk_bf16_f32 v95, v46, v47
    v_mfma_f32_16x16x32_bf16 a[124:127], a[188:191], v[108:111], a[124:127]
    ds_read_b64_tr_b16 a[174:175], v215 offset:20480
    v_add_f32 v227, v227, v38
    v_mfma_f32_16x16x32_bf16 v[136:139], v[128:131], v[108:111], v[136:139]
    v_add_f32 v227, v227, v39
    s_waitcnt lgkmcnt(3)
    v_mfma_f32_16x16x32_bf16 v[16:19], a[128:131], v[144:147], v[112:115]
    v_exp_f32 v48, v48
    v_mfma_f32_16x16x32_bf16 v[16:19], a[132:135], v[148:151], v[16:19]
    ds_read_b128 a[144:147], v208 offset:20480
    v_add_f32 v226, v226, v48
    v_mfma_f32_16x16x32_bf16 v[16:19], a[136:139], v[152:155], v[16:19]
    v_exp_f32 v49, v49
    v_mfma_f32_16x16x32_bf16 v[16:19], a[140:143], v[156:159], v[16:19]
    ds_read_b64_tr_b16 a[176:177], v216 offset:16384
    v_add_f32 v226, v226, v49
    v_mfma_f32_16x16x32_bf16 a[0:3], a[160:163], v[80:83], a[0:3]
    v_exp_f32 v50, v50
    v_mfma_f32_16x16x32_bf16 a[4:7], a[160:163], v[84:87], a[4:7]
    ds_read_b128 a[148:151], v209 offset:20480
    v_cvt_pk_bf16_f32 v96, v48, v49
    v_mfma_f32_16x16x32_bf16 a[8:11], a[160:163], v[88:91], a[8:11]
    buffer_load_dwordx4 v223, s[8:11], s24 offen offset:3072 lds
    v_add_f32 v226, v226, v50
    v_mfma_f32_16x16x32_bf16 a[12:15], a[160:163], v[92:95], a[12:15]
    ds_read_b64_tr_b16 a[178:179], v216 offset:20480
    v_mfma_f32_16x16x32_bf16 v[20:23], a[128:131], v[160:163], v[116:119]
    v_exp_f32 v51, v51
    v_mfma_f32_16x16x32_bf16 v[20:23], a[132:135], v[164:167], v[20:23]
    v_exp_f32 v52, v52
    v_mfma_f32_16x16x32_bf16 v[20:23], a[136:139], v[168:171], v[20:23]
    v_exp_f32 v53, v53
    v_mfma_f32_16x16x32_bf16 v[20:23], a[140:143], v[172:175], v[20:23]
    ds_read_b64_tr_b16 a[180:181], v217 offset:16384
    v_add_f32 v226, v226, v51
    v_mfma_f32_16x16x32_bf16 a[16:19], a[164:167], v[80:83], a[16:19]
    v_exp_f32 v54, v54
    v_mfma_f32_16x16x32_bf16 a[20:23], a[164:167], v[84:87], a[20:23]
    ds_read_b128 a[152:155], v210 offset:20480
    s_add_u32 m0, s25, 114688
    v_mfma_f32_16x16x32_bf16 a[24:27], a[164:167], v[88:91], a[24:27]
    buffer_load_dwordx4 v224, s[12:15], s24 offen lds
    v_cvt_pk_bf16_f32 v97, v50, v51
    v_mfma_f32_16x16x32_bf16 a[28:31], a[164:167], v[92:95], a[28:31]
    ds_read_b64_tr_b16 a[182:183], v217 offset:20480
    v_cvt_pk_bf16_f32 v100, v52, v53
    v_mfma_f32_16x16x32_bf16 v[24:27], a[128:131], v[176:179], v[120:123]
    v_exp_f32 v55, v55
    v_mfma_f32_16x16x32_bf16 v[24:27], a[132:135], v[180:183], v[24:27]
    v_exp_f32 v56, v56
    v_mfma_f32_16x16x32_bf16 v[24:27], a[136:139], v[184:187], v[24:27]
    v_exp_f32 v57, v57
    v_mfma_f32_16x16x32_bf16 v[24:27], a[140:143], v[188:191], v[24:27]
    ds_read_b64_tr_b16 a[184:185], v218 offset:16384
    s_waitcnt lgkmcnt(8)
    v_mfma_f32_16x16x32_bf16 a[32:35], a[168:171], v[80:83], a[32:35]
    v_exp_f32 v58, v58
    v_mfma_f32_16x16x32_bf16 a[36:39], a[168:171], v[84:87], a[36:39]
    ds_read_b128 a[156:159], v211 offset:20480
    v_cvt_pk_bf16_f32 v101, v54, v55
    v_mfma_f32_16x16x32_bf16 a[40:43], a[168:171], v[88:91], a[40:43]
    buffer_load_dwordx4 v225, s[12:15], s24 offen offset:1024 lds
    v_cvt_pk_bf16_f32 v104, v56, v57
    v_mfma_f32_16x16x32_bf16 a[44:47], a[168:171], v[92:95], a[44:47]
    ds_read_b64_tr_b16 a[186:187], v218 offset:20480
    v_add_f32 v227, v227, v52
    v_mfma_f32_16x16x32_bf16 v[28:31], a[128:131], v[192:195], v[124:127]
    v_exp_f32 v59, v59
    v_mfma_f32_16x16x32_bf16 v[28:31], a[132:135], v[196:199], v[28:31]
    v_exp_f32 v60, v60
    v_mfma_f32_16x16x32_bf16 v[28:31], a[136:139], v[200:203], v[28:31]
    v_exp_f32 v61, v61
    v_mfma_f32_16x16x32_bf16 v[28:31], a[140:143], v[204:207], v[28:31]
    ds_read_b64_tr_b16 a[188:189], v219 offset:16384
    v_cvt_pk_bf16_f32 v105, v58, v59
    v_mfma_f32_16x16x32_bf16 a[48:51], a[172:175], v[80:83], a[48:51]
    v_exp_f32 v62, v62
    v_mfma_f32_16x16x32_bf16 a[52:55], a[172:175], v[84:87], a[52:55]
    v_exp_f32 v63, v63
    v_mfma_f32_16x16x32_bf16 a[56:59], a[172:175], v[88:91], a[56:59]
    buffer_load_dwordx4 v224, s[12:15], s24 offen offset:2048 lds
    v_cvt_pk_bf16_f32 v108, v60, v61
    v_mfma_f32_16x16x32_bf16 a[60:63], a[172:175], v[92:95], a[60:63]
    ds_read_b64_tr_b16 a[190:191], v219 offset:20480
    v_cvt_pk_bf16_f32 v109, v62, v63
    v_mfma_f32_16x16x32_bf16 v[132:135], v[128:131], v[88:91], v[132:135]
    v_add_f32 v227, v227, v53
    s_waitcnt lgkmcnt(3)
    v_mfma_f32_16x16x32_bf16 v[32:35], a[144:147], v[144:147], v[112:115]
    v_exp_f32 v64, v64
    v_mfma_f32_16x16x32_bf16 v[32:35], a[148:151], v[148:151], v[32:35]
    ds_read_b128 a[128:131], v208 offset:24576
    v_add_f32 v227, v227, v54
    v_mfma_f32_16x16x32_bf16 v[32:35], a[152:155], v[152:155], v[32:35]
    v_exp_f32 v65, v65
    v_mfma_f32_16x16x32_bf16 v[32:35], a[156:159], v[156:159], v[32:35]
    ds_read_b64_tr_b16 a[160:161], v212 offset:24576
    v_cvt_pk_bf16_f32 v98, v64, v65
    v_mfma_f32_16x16x32_bf16 a[64:67], a[176:179], v[80:83], a[64:67]
    v_exp_f32 v66, v66
    v_mfma_f32_16x16x32_bf16 a[68:71], a[176:179], v[84:87], a[68:71]
    ds_read_b128 a[132:135], v209 offset:24576
    v_add_f32 v227, v227, v55
    v_mfma_f32_16x16x32_bf16 a[72:75], a[176:179], v[88:91], a[72:75]
    buffer_load_dwordx4 v225, s[12:15], s24 offen offset:3072 lds
    v_add_f32 v226, v226, v64
    v_mfma_f32_16x16x32_bf16 a[76:79], a[176:179], v[92:95], a[76:79]
    ds_read_b64_tr_b16 a[162:163], v212 offset:28672
    v_add_f32 v226, v226, v65
    v_mfma_f32_16x16x32_bf16 v[36:39], a[144:147], v[160:163], v[116:119]
    v_exp_f32 v67, v67
    v_mfma_f32_16x16x32_bf16 v[36:39], a[148:151], v[164:167], v[36:39]
    v_exp_f32 v68, v68
    v_mfma_f32_16x16x32_bf16 v[36:39], a[152:155], v[168:171], v[36:39]
    v_exp_f32 v69, v69
    v_mfma_f32_16x16x32_bf16 v[36:39], a[156:159], v[172:175], v[36:39]
    ds_read_b64_tr_b16 a[164:165], v213 offset:24576
    v_cvt_pk_bf16_f32 v99, v66, v67
    v_mfma_f32_16x16x32_bf16 a[80:83], a[180:183], v[80:83], a[80:83]
    v_exp_f32 v70, v70
    v_mfma_f32_16x16x32_bf16 a[84:87], a[180:183], v[84:87], a[84:87]
    ds_read_b128 a[136:139], v210 offset:24576
    v_cvt_pk_bf16_f32 v102, v68, v69
    v_mfma_f32_16x16x32_bf16 a[88:91], a[180:183], v[88:91], a[88:91]
    v_exp_f32 v71, v71
    v_mfma_f32_16x16x32_bf16 a[92:95], a[180:183], v[92:95], a[92:95]
    ds_read_b64_tr_b16 a[166:167], v213 offset:28672
    s_add_u32 s24, s24, 16384
    v_mfma_f32_16x16x32_bf16 v[40:43], a[144:147], v[176:179], v[120:123]
    v_exp_f32 v72, v72
    v_mfma_f32_16x16x32_bf16 v[40:43], a[148:151], v[180:183], v[40:43]
    v_exp_f32 v73, v73
    v_mfma_f32_16x16x32_bf16 v[40:43], a[152:155], v[184:187], v[40:43]
    v_cvt_pk_bf16_f32 v103, v70, v71
    v_cvt_pk_bf16_f32 v106, v72, v73
    v_mfma_f32_16x16x32_bf16 v[40:43], a[156:159], v[188:191], v[40:43]
    ds_read_b64_tr_b16 a[168:169], v214 offset:24576
    s_waitcnt lgkmcnt(8)
    v_mfma_f32_16x16x32_bf16 a[96:99], a[184:187], v[80:83], a[96:99]
    v_exp_f32 v74, v74
    v_mfma_f32_16x16x32_bf16 a[100:103], a[184:187], v[84:87], a[100:103]
    ds_read_b128 a[140:143], v211 offset:24576
    v_add_f32 v226, v226, v66
    v_mfma_f32_16x16x32_bf16 a[104:107], a[184:187], v[88:91], a[104:107]
    v_exp_f32 v75, v75
    v_mfma_f32_16x16x32_bf16 a[108:111], a[184:187], v[92:95], a[108:111]
    ds_read_b64_tr_b16 a[170:171], v214 offset:28672
    v_cvt_pk_bf16_f32 v107, v74, v75
    v_mfma_f32_16x16x32_bf16 v[44:47], a[144:147], v[192:195], v[124:127]
    v_exp_f32 v76, v76
    v_mfma_f32_16x16x32_bf16 v[44:47], a[148:151], v[196:199], v[44:47]
    v_exp_f32 v77, v77
    v_mfma_f32_16x16x32_bf16 v[44:47], a[152:155], v[200:203], v[44:47]
    v_cvt_pk_bf16_f32 v110, v76, v77
    v_add_f32 v226, v226, v67
    v_mfma_f32_16x16x32_bf16 v[44:47], a[156:159], v[204:207], v[44:47]
    ds_read_b64_tr_b16 a[172:173], v215 offset:24576
    v_add_f32 v227, v227, v68
    v_mfma_f32_16x16x32_bf16 a[112:115], a[188:191], v[80:83], a[112:115]
    v_exp_f32 v78, v78
    v_mfma_f32_16x16x32_bf16 a[116:119], a[188:191], v[84:87], a[116:119]
    v_exp_f32 v79, v79
    v_mfma_f32_16x16x32_bf16 a[120:123], a[188:191], v[88:91], a[120:123]
    v_cvt_pk_bf16_f32 v111, v78, v79
    v_add_f32 v227, v227, v69
    v_mfma_f32_16x16x32_bf16 a[124:127], a[188:191], v[92:95], a[124:127]
    ds_read_b64_tr_b16 a[174:175], v215 offset:28672
    v_add_f32 v227, v227, v70
    v_mfma_f32_16x16x32_bf16 v[136:139], v[128:131], v[92:95], v[136:139]
    v_add_f32 v227, v227, v71
    s_waitcnt lgkmcnt(3)
    v_mfma_f32_16x16x32_bf16 v[48:51], a[128:131], v[144:147], v[112:115]
    v_exp_f32 v16, v16
    v_mfma_f32_16x16x32_bf16 v[48:51], a[132:135], v[148:151], v[48:51]
    ds_read_b128 a[144:147], v208 offset:28672
    v_add_f32 v226, v226, v16
    v_mfma_f32_16x16x32_bf16 v[48:51], a[136:139], v[152:155], v[48:51]
    v_exp_f32 v17, v17
    v_mfma_f32_16x16x32_bf16 v[48:51], a[140:143], v[156:159], v[48:51]
    ds_read_b64_tr_b16 a[176:177], v216 offset:24576
    v_add_f32 v226, v226, v17
    v_mfma_f32_16x16x32_bf16 a[0:3], a[160:163], v[96:99], a[0:3]
    v_exp_f32 v18, v18
    v_mfma_f32_16x16x32_bf16 a[4:7], a[160:163], v[100:103], a[4:7]
    ds_read_b128 a[148:151], v209 offset:28672
    v_cvt_pk_bf16_f32 v80, v16, v17
    v_mfma_f32_16x16x32_bf16 a[8:11], a[160:163], v[104:107], a[8:11]
    v_exp_f32 v19, v19
    v_mfma_f32_16x16x32_bf16 a[12:15], a[160:163], v[108:111], a[12:15]
    ds_read_b64_tr_b16 a[178:179], v216 offset:28672
    v_add_f32 v226, v226, v18
    v_mfma_f32_16x16x32_bf16 v[52:55], a[128:131], v[160:163], v[116:119]
    v_exp_f32 v20, v20
    v_mfma_f32_16x16x32_bf16 v[52:55], a[132:135], v[164:167], v[52:55]
    v_exp_f32 v21, v21
    v_mfma_f32_16x16x32_bf16 v[52:55], a[136:139], v[168:171], v[52:55]
    v_add_f32 v226, v226, v19
    v_cvt_pk_bf16_f32 v81, v18, v19
    v_mfma_f32_16x16x32_bf16 v[52:55], a[140:143], v[172:175], v[52:55]
    ds_read_b64_tr_b16 a[180:181], v217 offset:24576
    v_cvt_pk_bf16_f32 v84, v20, v21
    v_mfma_f32_16x16x32_bf16 a[16:19], a[164:167], v[96:99], a[16:19]
    v_exp_f32 v22, v22
    v_mfma_f32_16x16x32_bf16 a[20:23], a[164:167], v[100:103], a[20:23]
    ds_read_b128 a[152:155], v210 offset:28672
    v_add_f32 v227, v227, v20
    v_mfma_f32_16x16x32_bf16 a[24:27], a[164:167], v[104:107], a[24:27]
    v_exp_f32 v23, v23
    v_mfma_f32_16x16x32_bf16 a[28:31], a[164:167], v[108:111], a[28:31]
    ds_read_b64_tr_b16 a[182:183], v217 offset:28672
    v_cvt_pk_bf16_f32 v85, v22, v23
    v_mfma_f32_16x16x32_bf16 v[56:59], a[128:131], v[176:179], v[120:123]
    v_exp_f32 v24, v24
    v_mfma_f32_16x16x32_bf16 v[56:59], a[132:135], v[180:183], v[56:59]
    v_exp_f32 v25, v25
    v_mfma_f32_16x16x32_bf16 v[56:59], a[136:139], v[184:187], v[56:59]
    v_cvt_pk_bf16_f32 v88, v24, v25
    v_add_f32 v227, v227, v21
    v_mfma_f32_16x16x32_bf16 v[56:59], a[140:143], v[188:191], v[56:59]
    ds_read_b64_tr_b16 a[184:185], v218 offset:24576
    s_waitcnt lgkmcnt(8)
    v_mfma_f32_16x16x32_bf16 a[32:35], a[168:171], v[96:99], a[32:35]
    v_exp_f32 v26, v26
    v_mfma_f32_16x16x32_bf16 a[36:39], a[168:171], v[100:103], a[36:39]
    ds_read_b128 a[156:159], v211 offset:28672
    v_add_f32 v227, v227, v22
    v_mfma_f32_16x16x32_bf16 a[40:43], a[168:171], v[104:107], a[40:43]
    v_exp_f32 v27, v27
    v_mfma_f32_16x16x32_bf16 a[44:47], a[168:171], v[108:111], a[44:47]
    ds_read_b64_tr_b16 a[186:187], v218 offset:28672
    v_cvt_pk_bf16_f32 v89, v26, v27
    v_mfma_f32_16x16x32_bf16 v[60:63], a[128:131], v[192:195], v[124:127]
    v_exp_f32 v28, v28
    v_mfma_f32_16x16x32_bf16 v[60:63], a[132:135], v[196:199], v[60:63]
    v_exp_f32 v29, v29
    v_mfma_f32_16x16x32_bf16 v[60:63], a[136:139], v[200:203], v[60:63]
    v_cvt_pk_bf16_f32 v92, v28, v29
    v_add_f32 v227, v227, v23
    v_mfma_f32_16x16x32_bf16 v[60:63], a[140:143], v[204:207], v[60:63]
    ds_read_b64_tr_b16 a[188:189], v219 offset:24576
    v_mfma_f32_16x16x32_bf16 a[48:51], a[172:175], v[96:99], a[48:51]
    v_exp_f32 v30, v30
    v_mfma_f32_16x16x32_bf16 a[52:55], a[172:175], v[100:103], a[52:55]
    v_exp_f32 v31, v31
    v_mfma_f32_16x16x32_bf16 a[56:59], a[172:175], v[104:107], a[56:59]
    v_cvt_pk_bf16_f32 v93, v30, v31
    v_mfma_f32_16x16x32_bf16 a[60:63], a[172:175], v[108:111], a[60:63]
    ds_read_b64_tr_b16 a[190:191], v219 offset:28672
    v_mfma_f32_16x16x32_bf16 v[132:135], v[128:131], v[104:107], v[132:135]
    s_waitcnt vmcnt(8) lgkmcnt(3)
    s_barrier
    v_mfma_f32_16x16x32_bf16 v[64:67], a[144:147], v[144:147], v[112:115]
    v_exp_f32 v32, v32
    v_mfma_f32_16x16x32_bf16 v[64:67], a[148:151], v[148:151], v[64:67]
    ds_read_b128 a[128:131], v208 offset:32768
    v_add_f32 v226, v226, v32
    v_mfma_f32_16x16x32_bf16 v[64:67], a[152:155], v[152:155], v[64:67]
    v_exp_f32 v33, v33
    v_mfma_f32_16x16x32_bf16 v[64:67], a[156:159], v[156:159], v[64:67]
    ds_read_b64_tr_b16 a[160:161], v212 offset:32768
    v_cvt_pk_bf16_f32 v82, v32, v33
    v_mfma_f32_16x16x32_bf16 a[64:67], a[176:179], v[96:99], a[64:67]
    v_exp_f32 v34, v34
    v_mfma_f32_16x16x32_bf16 a[68:71], a[176:179], v[100:103], a[68:71]
    ds_read_b128 a[132:135], v209 offset:32768
    s_add_u32 m0, s25, 0
    v_mfma_f32_16x16x32_bf16 a[72:75], a[176:179], v[104:107], a[72:75]
    buffer_load_dwordx4 v220, s[8:11], s24 offen lds
    v_add_f32 v226, v226, v33
    v_mfma_f32_16x16x32_bf16 a[76:79], a[176:179], v[108:111], a[76:79]
    ds_read_b64_tr_b16 a[162:163], v212 offset:36864
    v_add_f32 v226, v226, v34
    v_mfma_f32_16x16x32_bf16 v[68:71], a[144:147], v[160:163], v[116:119]
    v_exp_f32 v35, v35
    v_mfma_f32_16x16x32_bf16 v[68:71], a[148:151], v[164:167], v[68:71]
    v_exp_f32 v36, v36
    v_mfma_f32_16x16x32_bf16 v[68:71], a[152:155], v[168:171], v[68:71]
    v_exp_f32 v37, v37
    v_mfma_f32_16x16x32_bf16 v[68:71], a[156:159], v[172:175], v[68:71]
    ds_read_b64_tr_b16 a[164:165], v213 offset:32768
    v_cvt_pk_bf16_f32 v83, v34, v35
    v_mfma_f32_16x16x32_bf16 a[80:83], a[180:183], v[96:99], a[80:83]
    v_exp_f32 v38, v38
    v_mfma_f32_16x16x32_bf16 a[84:87], a[180:183], v[100:103], a[84:87]
    ds_read_b128 a[136:139], v210 offset:32768
    v_cvt_pk_bf16_f32 v86, v36, v37
    v_mfma_f32_16x16x32_bf16 a[88:91], a[180:183], v[104:107], a[88:91]
    buffer_load_dwordx4 v221, s[8:11], s24 offen offset:1024 lds
    v_add_f32 v226, v226, v35
    v_mfma_f32_16x16x32_bf16 a[92:95], a[180:183], v[108:111], a[92:95]
    ds_read_b64_tr_b16 a[166:167], v213 offset:36864
    v_add_f32 v227, v227, v36
    v_mfma_f32_16x16x32_bf16 v[72:75], a[144:147], v[176:179], v[120:123]
    v_exp_f32 v39, v39
    v_mfma_f32_16x16x32_bf16 v[72:75], a[148:151], v[180:183], v[72:75]
    v_exp_f32 v40, v40
    v_mfma_f32_16x16x32_bf16 v[72:75], a[152:155], v[184:187], v[72:75]
    v_exp_f32 v41, v41
    v_mfma_f32_16x16x32_bf16 v[72:75], a[156:159], v[188:191], v[72:75]
    ds_read_b64_tr_b16 a[168:169], v214 offset:32768
    s_waitcnt lgkmcnt(8)
    v_mfma_f32_16x16x32_bf16 a[96:99], a[184:187], v[96:99], a[96:99]
    v_exp_f32 v42, v42
    v_mfma_f32_16x16x32_bf16 a[100:103], a[184:187], v[100:103], a[100:103]
    ds_read_b128 a[140:143], v211 offset:32768
    v_cvt_pk_bf16_f32 v87, v38, v39
    v_mfma_f32_16x16x32_bf16 a[104:107], a[184:187], v[104:107], a[104:107]
    buffer_load_dwordx4 v222, s[8:11], s24 offen offset:2048 lds
    v_cvt_pk_bf16_f32 v90, v40, v41
    v_mfma_f32_16x16x32_bf16 a[108:111], a[184:187], v[108:111], a[108:111]
    ds_read_b64_tr_b16 a[170:171], v214 offset:36864
    v_add_f32 v227, v227, v37
    v_mfma_f32_16x16x32_bf16 v[76:79], a[144:147], v[192:195], v[124:127]
    v_exp_f32 v43, v43
    v_mfma_f32_16x16x32_bf16 v[76:79], a[148:151], v[196:199], v[76:79]
    v_exp_f32 v44, v44
    v_mfma_f32_16x16x32_bf16 v[76:79], a[152:155], v[200:203], v[76:79]
    v_exp_f32 v45, v45
    v_mfma_f32_16x16x32_bf16 v[76:79], a[156:159], v[204:207], v[76:79]
    ds_read_b64_tr_b16 a[172:173], v215 offset:32768
    v_cvt_pk_bf16_f32 v91, v42, v43
    v_mfma_f32_16x16x32_bf16 a[112:115], a[188:191], v[96:99], a[112:115]
    v_exp_f32 v46, v46
    v_mfma_f32_16x16x32_bf16 a[116:119], a[188:191], v[100:103], a[116:119]
    v_exp_f32 v47, v47
    v_mfma_f32_16x16x32_bf16 a[120:123], a[188:191], v[104:107], a[120:123]
    v_cvt_pk_bf16_f32 v94, v44, v45
    v_cvt_pk_bf16_f32 v95, v46, v47
    v_mfma_f32_16x16x32_bf16 a[124:127], a[188:191], v[108:111], a[124:127]
    ds_read_b64_tr_b16 a[174:175], v215 offset:36864
    v_add_f32 v227, v227, v38
    v_mfma_f32_16x16x32_bf16 v[136:139], v[128:131], v[108:111], v[136:139]
    v_add_f32 v227, v227, v39
    s_waitcnt lgkmcnt(3)
    v_mfma_f32_16x16x32_bf16 v[16:19], a[128:131], v[144:147], v[112:115]
    v_exp_f32 v48, v48
    v_mfma_f32_16x16x32_bf16 v[16:19], a[132:135], v[148:151], v[16:19]
    ds_read_b128 a[144:147], v208 offset:36864
    v_add_f32 v226, v226, v48
    v_mfma_f32_16x16x32_bf16 v[16:19], a[136:139], v[152:155], v[16:19]
    v_exp_f32 v49, v49
    v_mfma_f32_16x16x32_bf16 v[16:19], a[140:143], v[156:159], v[16:19]
    ds_read_b64_tr_b16 a[176:177], v216 offset:32768
    v_add_f32 v226, v226, v49
    v_mfma_f32_16x16x32_bf16 a[0:3], a[160:163], v[80:83], a[0:3]
    v_exp_f32 v50, v50
    v_mfma_f32_16x16x32_bf16 a[4:7], a[160:163], v[84:87], a[4:7]
    ds_read_b128 a[148:151], v209 offset:36864
    v_cvt_pk_bf16_f32 v96, v48, v49
    v_mfma_f32_16x16x32_bf16 a[8:11], a[160:163], v[88:91], a[8:11]
    buffer_load_dwordx4 v223, s[8:11], s24 offen offset:3072 lds
    v_add_f32 v226, v226, v50
    v_mfma_f32_16x16x32_bf16 a[12:15], a[160:163], v[92:95], a[12:15]
    ds_read_b64_tr_b16 a[178:179], v216 offset:36864
    v_mfma_f32_16x16x32_bf16 v[20:23], a[128:131], v[160:163], v[116:119]
    v_exp_f32 v51, v51
    v_mfma_f32_16x16x32_bf16 v[20:23], a[132:135], v[164:167], v[20:23]
    v_exp_f32 v52, v52
    v_mfma_f32_16x16x32_bf16 v[20:23], a[136:139], v[168:171], v[20:23]
    v_exp_f32 v53, v53
    v_mfma_f32_16x16x32_bf16 v[20:23], a[140:143], v[172:175], v[20:23]
    ds_read_b64_tr_b16 a[180:181], v217 offset:32768
    v_add_f32 v226, v226, v51
    v_mfma_f32_16x16x32_bf16 a[16:19], a[164:167], v[80:83], a[16:19]
    v_exp_f32 v54, v54
    v_mfma_f32_16x16x32_bf16 a[20:23], a[164:167], v[84:87], a[20:23]
    ds_read_b128 a[152:155], v210 offset:36864
    s_add_u32 m0, s25, 65536
    v_mfma_f32_16x16x32_bf16 a[24:27], a[164:167], v[88:91], a[24:27]
    buffer_load_dwordx4 v224, s[12:15], s24 offen lds
    v_cvt_pk_bf16_f32 v97, v50, v51
    v_mfma_f32_16x16x32_bf16 a[28:31], a[164:167], v[92:95], a[28:31]
    ds_read_b64_tr_b16 a[182:183], v217 offset:36864
    v_cvt_pk_bf16_f32 v100, v52, v53
    v_mfma_f32_16x16x32_bf16 v[24:27], a[128:131], v[176:179], v[120:123]
    v_exp_f32 v55, v55
    v_mfma_f32_16x16x32_bf16 v[24:27], a[132:135], v[180:183], v[24:27]
    v_exp_f32 v56, v56
    v_mfma_f32_16x16x32_bf16 v[24:27], a[136:139], v[184:187], v[24:27]
    v_exp_f32 v57, v57
    v_mfma_f32_16x16x32_bf16 v[24:27], a[140:143], v[188:191], v[24:27]
    ds_read_b64_tr_b16 a[184:185], v218 offset:32768
    s_waitcnt lgkmcnt(8)
    v_mfma_f32_16x16x32_bf16 a[32:35], a[168:171], v[80:83], a[32:35]
    v_exp_f32 v58, v58
    v_mfma_f32_16x16x32_bf16 a[36:39], a[168:171], v[84:87], a[36:39]
    ds_read_b128 a[156:159], v211 offset:36864
    v_cvt_pk_bf16_f32 v101, v54, v55
    v_mfma_f32_16x16x32_bf16 a[40:43], a[168:171], v[88:91], a[40:43]
    buffer_load_dwordx4 v225, s[12:15], s24 offen offset:1024 lds
    v_cvt_pk_bf16_f32 v104, v56, v57
    v_mfma_f32_16x16x32_bf16 a[44:47], a[168:171], v[92:95], a[44:47]
    ds_read_b64_tr_b16 a[186:187], v218 offset:36864
    v_add_f32 v227, v227, v52
    v_mfma_f32_16x16x32_bf16 v[28:31], a[128:131], v[192:195], v[124:127]
    v_exp_f32 v59, v59
    v_mfma_f32_16x16x32_bf16 v[28:31], a[132:135], v[196:199], v[28:31]
    v_exp_f32 v60, v60
    v_mfma_f32_16x16x32_bf16 v[28:31], a[136:139], v[200:203], v[28:31]
    v_exp_f32 v61, v61
    v_mfma_f32_16x16x32_bf16 v[28:31], a[140:143], v[204:207], v[28:31]
    ds_read_b64_tr_b16 a[188:189], v219 offset:32768
    v_cvt_pk_bf16_f32 v105, v58, v59
    v_mfma_f32_16x16x32_bf16 a[48:51], a[172:175], v[80:83], a[48:51]
    v_exp_f32 v62, v62
    v_mfma_f32_16x16x32_bf16 a[52:55], a[172:175], v[84:87], a[52:55]
    v_exp_f32 v63, v63
    v_mfma_f32_16x16x32_bf16 a[56:59], a[172:175], v[88:91], a[56:59]
    buffer_load_dwordx4 v224, s[12:15], s24 offen offset:2048 lds
    v_cvt_pk_bf16_f32 v108, v60, v61
    v_mfma_f32_16x16x32_bf16 a[60:63], a[172:175], v[92:95], a[60:63]
    ds_read_b64_tr_b16 a[190:191], v219 offset:36864
    v_cvt_pk_bf16_f32 v109, v62, v63
    v_mfma_f32_16x16x32_bf16 v[132:135], v[128:131], v[88:91], v[132:135]
    v_add_f32 v227, v227, v53
    s_waitcnt lgkmcnt(3)
    v_mfma_f32_16x16x32_bf16 v[32:35], a[144:147], v[144:147], v[112:115]
    v_exp_f32 v64, v64
    v_mfma_f32_16x16x32_bf16 v[32:35], a[148:151], v[148:151], v[32:35]
    ds_read_b128 a[128:131], v208 offset:40960
    v_add_f32 v227, v227, v54
    v_mfma_f32_16x16x32_bf16 v[32:35], a[152:155], v[152:155], v[32:35]
    v_exp_f32 v65, v65
    v_mfma_f32_16x16x32_bf16 v[32:35], a[156:159], v[156:159], v[32:35]
    ds_read_b64_tr_b16 a[160:161], v212 offset:40960
    v_cvt_pk_bf16_f32 v98, v64, v65
    v_mfma_f32_16x16x32_bf16 a[64:67], a[176:179], v[80:83], a[64:67]
    v_exp_f32 v66, v66
    v_mfma_f32_16x16x32_bf16 a[68:71], a[176:179], v[84:87], a[68:71]
    ds_read_b128 a[132:135], v209 offset:40960
    v_add_f32 v227, v227, v55
    v_mfma_f32_16x16x32_bf16 a[72:75], a[176:179], v[88:91], a[72:75]
    buffer_load_dwordx4 v225, s[12:15], s24 offen offset:3072 lds
    v_add_f32 v226, v226, v64
    v_mfma_f32_16x16x32_bf16 a[76:79], a[176:179], v[92:95], a[76:79]
    ds_read_b64_tr_b16 a[162:163], v212 offset:45056
    v_add_f32 v226, v226, v65
    v_mfma_f32_16x16x32_bf16 v[36:39], a[144:147], v[160:163], v[116:119]
    v_exp_f32 v67, v67
    v_mfma_f32_16x16x32_bf16 v[36:39], a[148:151], v[164:167], v[36:39]
    v_exp_f32 v68, v68
    v_mfma_f32_16x16x32_bf16 v[36:39], a[152:155], v[168:171], v[36:39]
    v_exp_f32 v69, v69
    v_mfma_f32_16x16x32_bf16 v[36:39], a[156:159], v[172:175], v[36:39]
    ds_read_b64_tr_b16 a[164:165], v213 offset:40960
    v_cvt_pk_bf16_f32 v99, v66, v67
    v_mfma_f32_16x16x32_bf16 a[80:83], a[180:183], v[80:83], a[80:83]
    v_exp_f32 v70, v70
    v_mfma_f32_16x16x32_bf16 a[84:87], a[180:183], v[84:87], a[84:87]
    ds_read_b128 a[136:139], v210 offset:40960
    v_cvt_pk_bf16_f32 v102, v68, v69
    v_mfma_f32_16x16x32_bf16 a[88:91], a[180:183], v[88:91], a[88:91]
    v_exp_f32 v71, v71
    v_mfma_f32_16x16x32_bf16 a[92:95], a[180:183], v[92:95], a[92:95]
    ds_read_b64_tr_b16 a[166:167], v213 offset:45056
    s_add_u32 s24, s24, 16384
    v_mfma_f32_16x16x32_bf16 v[40:43], a[144:147], v[176:179], v[120:123]
    v_exp_f32 v72, v72
    v_mfma_f32_16x16x32_bf16 v[40:43], a[148:151], v[180:183], v[40:43]
    v_exp_f32 v73, v73
    v_mfma_f32_16x16x32_bf16 v[40:43], a[152:155], v[184:187], v[40:43]
    v_cvt_pk_bf16_f32 v103, v70, v71
    v_cvt_pk_bf16_f32 v106, v72, v73
    v_mfma_f32_16x16x32_bf16 v[40:43], a[156:159], v[188:191], v[40:43]
    ds_read_b64_tr_b16 a[168:169], v214 offset:40960
    s_waitcnt lgkmcnt(8)
    v_mfma_f32_16x16x32_bf16 a[96:99], a[184:187], v[80:83], a[96:99]
    v_exp_f32 v74, v74
    v_mfma_f32_16x16x32_bf16 a[100:103], a[184:187], v[84:87], a[100:103]
    ds_read_b128 a[140:143], v211 offset:40960
    v_add_f32 v226, v226, v66
    v_mfma_f32_16x16x32_bf16 a[104:107], a[184:187], v[88:91], a[104:107]
    v_exp_f32 v75, v75
    v_mfma_f32_16x16x32_bf16 a[108:111], a[184:187], v[92:95], a[108:111]
    ds_read_b64_tr_b16 a[170:171], v214 offset:45056
    v_cvt_pk_bf16_f32 v107, v74, v75
    v_mfma_f32_16x16x32_bf16 v[44:47], a[144:147], v[192:195], v[124:127]
    v_exp_f32 v76, v76
    v_mfma_f32_16x16x32_bf16 v[44:47], a[148:151], v[196:199], v[44:47]
    v_exp_f32 v77, v77
    v_mfma_f32_16x16x32_bf16 v[44:47], a[152:155], v[200:203], v[44:47]
    v_cvt_pk_bf16_f32 v110, v76, v77
    v_add_f32 v226, v226, v67
    v_mfma_f32_16x16x32_bf16 v[44:47], a[156:159], v[204:207], v[44:47]
    ds_read_b64_tr_b16 a[172:173], v215 offset:40960
    v_add_f32 v227, v227, v68
    v_mfma_f32_16x16x32_bf16 a[112:115], a[188:191], v[80:83], a[112:115]
    v_exp_f32 v78, v78
    v_mfma_f32_16x16x32_bf16 a[116:119], a[188:191], v[84:87], a[116:119]
    v_exp_f32 v79, v79
    v_mfma_f32_16x16x32_bf16 a[120:123], a[188:191], v[88:91], a[120:123]
    v_cvt_pk_bf16_f32 v111, v78, v79
    v_add_f32 v227, v227, v69
    v_mfma_f32_16x16x32_bf16 a[124:127], a[188:191], v[92:95], a[124:127]
    ds_read_b64_tr_b16 a[174:175], v215 offset:45056
    v_add_f32 v227, v227, v70
    v_mfma_f32_16x16x32_bf16 v[136:139], v[128:131], v[92:95], v[136:139]
    v_add_f32 v227, v227, v71
    s_waitcnt lgkmcnt(3)
    v_mfma_f32_16x16x32_bf16 v[48:51], a[128:131], v[144:147], v[112:115]
    v_exp_f32 v16, v16
    v_mfma_f32_16x16x32_bf16 v[48:51], a[132:135], v[148:151], v[48:51]
    ds_read_b128 a[144:147], v208 offset:45056
    v_add_f32 v226, v226, v16
    v_mfma_f32_16x16x32_bf16 v[48:51], a[136:139], v[152:155], v[48:51]
    v_exp_f32 v17, v17
    v_mfma_f32_16x16x32_bf16 v[48:51], a[140:143], v[156:159], v[48:51]
    ds_read_b64_tr_b16 a[176:177], v216 offset:40960
    v_add_f32 v226, v226, v17
    v_mfma_f32_16x16x32_bf16 a[0:3], a[160:163], v[96:99], a[0:3]
    v_exp_f32 v18, v18
    v_mfma_f32_16x16x32_bf16 a[4:7], a[160:163], v[100:103], a[4:7]
    ds_read_b128 a[148:151], v209 offset:45056
    v_cvt_pk_bf16_f32 v80, v16, v17
    v_mfma_f32_16x16x32_bf16 a[8:11], a[160:163], v[104:107], a[8:11]
    v_exp_f32 v19, v19
    v_mfma_f32_16x16x32_bf16 a[12:15], a[160:163], v[108:111], a[12:15]
    ds_read_b64_tr_b16 a[178:179], v216 offset:45056
    v_add_f32 v226, v226, v18
    v_mfma_f32_16x16x32_bf16 v[52:55], a[128:131], v[160:163], v[116:119]
    v_exp_f32 v20, v20
    v_mfma_f32_16x16x32_bf16 v[52:55], a[132:135], v[164:167], v[52:55]
    v_exp_f32 v21, v21
    v_mfma_f32_16x16x32_bf16 v[52:55], a[136:139], v[168:171], v[52:55]
    v_add_f32 v226, v226, v19
    v_cvt_pk_bf16_f32 v81, v18, v19
    v_mfma_f32_16x16x32_bf16 v[52:55], a[140:143], v[172:175], v[52:55]
    ds_read_b64_tr_b16 a[180:181], v217 offset:40960
    v_cvt_pk_bf16_f32 v84, v20, v21
    v_mfma_f32_16x16x32_bf16 a[16:19], a[164:167], v[96:99], a[16:19]
    v_exp_f32 v22, v22
    v_mfma_f32_16x16x32_bf16 a[20:23], a[164:167], v[100:103], a[20:23]
    ds_read_b128 a[152:155], v210 offset:45056
    v_add_f32 v227, v227, v20
    v_mfma_f32_16x16x32_bf16 a[24:27], a[164:167], v[104:107], a[24:27]
    v_exp_f32 v23, v23
    v_mfma_f32_16x16x32_bf16 a[28:31], a[164:167], v[108:111], a[28:31]
    ds_read_b64_tr_b16 a[182:183], v217 offset:45056
    v_cvt_pk_bf16_f32 v85, v22, v23
    v_mfma_f32_16x16x32_bf16 v[56:59], a[128:131], v[176:179], v[120:123]
    v_exp_f32 v24, v24
    v_mfma_f32_16x16x32_bf16 v[56:59], a[132:135], v[180:183], v[56:59]
    v_exp_f32 v25, v25
    v_mfma_f32_16x16x32_bf16 v[56:59], a[136:139], v[184:187], v[56:59]
    v_cvt_pk_bf16_f32 v88, v24, v25
    v_add_f32 v227, v227, v21
    v_mfma_f32_16x16x32_bf16 v[56:59], a[140:143], v[188:191], v[56:59]
    ds_read_b64_tr_b16 a[184:185], v218 offset:40960
    s_waitcnt lgkmcnt(8)
    v_mfma_f32_16x16x32_bf16 a[32:35], a[168:171], v[96:99], a[32:35]
    v_exp_f32 v26, v26
    v_mfma_f32_16x16x32_bf16 a[36:39], a[168:171], v[100:103], a[36:39]
    ds_read_b128 a[156:159], v211 offset:45056
    v_add_f32 v227, v227, v22
    v_mfma_f32_16x16x32_bf16 a[40:43], a[168:171], v[104:107], a[40:43]
    v_exp_f32 v27, v27
    v_mfma_f32_16x16x32_bf16 a[44:47], a[168:171], v[108:111], a[44:47]
    ds_read_b64_tr_b16 a[186:187], v218 offset:45056
    v_cvt_pk_bf16_f32 v89, v26, v27
    v_mfma_f32_16x16x32_bf16 v[60:63], a[128:131], v[192:195], v[124:127]
    v_exp_f32 v28, v28
    v_mfma_f32_16x16x32_bf16 v[60:63], a[132:135], v[196:199], v[60:63]
    v_exp_f32 v29, v29
    v_mfma_f32_16x16x32_bf16 v[60:63], a[136:139], v[200:203], v[60:63]
    v_cvt_pk_bf16_f32 v92, v28, v29
    v_add_f32 v227, v227, v23
    v_mfma_f32_16x16x32_bf16 v[60:63], a[140:143], v[204:207], v[60:63]
    ds_read_b64_tr_b16 a[188:189], v219 offset:40960
    v_mfma_f32_16x16x32_bf16 a[48:51], a[172:175], v[96:99], a[48:51]
    v_exp_f32 v30, v30
    v_mfma_f32_16x16x32_bf16 a[52:55], a[172:175], v[100:103], a[52:55]
    v_exp_f32 v31, v31
    v_mfma_f32_16x16x32_bf16 a[56:59], a[172:175], v[104:107], a[56:59]
    v_cvt_pk_bf16_f32 v93, v30, v31
    v_mfma_f32_16x16x32_bf16 a[60:63], a[172:175], v[108:111], a[60:63]
    ds_read_b64_tr_b16 a[190:191], v219 offset:45056
    v_mfma_f32_16x16x32_bf16 v[132:135], v[128:131], v[104:107], v[132:135]
    s_waitcnt vmcnt(8) lgkmcnt(3)
    s_barrier
    v_mfma_f32_16x16x32_bf16 v[64:67], a[144:147], v[144:147], v[112:115]
    v_exp_f32 v32, v32
    v_mfma_f32_16x16x32_bf16 v[64:67], a[148:151], v[148:151], v[64:67]
    ds_read_b128 a[128:131], v208 offset:49152
    v_add_f32 v226, v226, v32
    v_mfma_f32_16x16x32_bf16 v[64:67], a[152:155], v[152:155], v[64:67]
    v_exp_f32 v33, v33
    v_mfma_f32_16x16x32_bf16 v[64:67], a[156:159], v[156:159], v[64:67]
    ds_read_b64_tr_b16 a[160:161], v212 offset:49152
    v_cvt_pk_bf16_f32 v82, v32, v33
    v_mfma_f32_16x16x32_bf16 a[64:67], a[176:179], v[96:99], a[64:67]
    v_exp_f32 v34, v34
    v_mfma_f32_16x16x32_bf16 a[68:71], a[176:179], v[100:103], a[68:71]
    ds_read_b128 a[132:135], v209 offset:49152
    s_add_u32 m0, s25, 16384
    v_mfma_f32_16x16x32_bf16 a[72:75], a[176:179], v[104:107], a[72:75]
    buffer_load_dwordx4 v220, s[8:11], s24 offen lds
    v_add_f32 v226, v226, v33
    v_mfma_f32_16x16x32_bf16 a[76:79], a[176:179], v[108:111], a[76:79]
    ds_read_b64_tr_b16 a[162:163], v212 offset:53248
    v_add_f32 v226, v226, v34
    v_mfma_f32_16x16x32_bf16 v[68:71], a[144:147], v[160:163], v[116:119]
    v_exp_f32 v35, v35
    v_mfma_f32_16x16x32_bf16 v[68:71], a[148:151], v[164:167], v[68:71]
    v_exp_f32 v36, v36
    v_mfma_f32_16x16x32_bf16 v[68:71], a[152:155], v[168:171], v[68:71]
    v_exp_f32 v37, v37
    v_mfma_f32_16x16x32_bf16 v[68:71], a[156:159], v[172:175], v[68:71]
    ds_read_b64_tr_b16 a[164:165], v213 offset:49152
    v_cvt_pk_bf16_f32 v83, v34, v35
    v_mfma_f32_16x16x32_bf16 a[80:83], a[180:183], v[96:99], a[80:83]
    v_exp_f32 v38, v38
    v_mfma_f32_16x16x32_bf16 a[84:87], a[180:183], v[100:103], a[84:87]
    ds_read_b128 a[136:139], v210 offset:49152
    v_cvt_pk_bf16_f32 v86, v36, v37
    v_mfma_f32_16x16x32_bf16 a[88:91], a[180:183], v[104:107], a[88:91]
    buffer_load_dwordx4 v221, s[8:11], s24 offen offset:1024 lds
    v_add_f32 v226, v226, v35
    v_mfma_f32_16x16x32_bf16 a[92:95], a[180:183], v[108:111], a[92:95]
    ds_read_b64_tr_b16 a[166:167], v213 offset:53248
    v_add_f32 v227, v227, v36
    v_mfma_f32_16x16x32_bf16 v[72:75], a[144:147], v[176:179], v[120:123]
    v_exp_f32 v39, v39
    v_mfma_f32_16x16x32_bf16 v[72:75], a[148:151], v[180:183], v[72:75]
    v_exp_f32 v40, v40
    v_mfma_f32_16x16x32_bf16 v[72:75], a[152:155], v[184:187], v[72:75]
    v_exp_f32 v41, v41
    v_mfma_f32_16x16x32_bf16 v[72:75], a[156:159], v[188:191], v[72:75]
    ds_read_b64_tr_b16 a[168:169], v214 offset:49152
    s_waitcnt lgkmcnt(8)
    v_mfma_f32_16x16x32_bf16 a[96:99], a[184:187], v[96:99], a[96:99]
    v_exp_f32 v42, v42
    v_mfma_f32_16x16x32_bf16 a[100:103], a[184:187], v[100:103], a[100:103]
    ds_read_b128 a[140:143], v211 offset:49152
    v_cvt_pk_bf16_f32 v87, v38, v39
    v_mfma_f32_16x16x32_bf16 a[104:107], a[184:187], v[104:107], a[104:107]
    buffer_load_dwordx4 v222, s[8:11], s24 offen offset:2048 lds
    v_cvt_pk_bf16_f32 v90, v40, v41
    v_mfma_f32_16x16x32_bf16 a[108:111], a[184:187], v[108:111], a[108:111]
    ds_read_b64_tr_b16 a[170:171], v214 offset:53248
    v_add_f32 v227, v227, v37
    v_mfma_f32_16x16x32_bf16 v[76:79], a[144:147], v[192:195], v[124:127]
    v_exp_f32 v43, v43
    v_mfma_f32_16x16x32_bf16 v[76:79], a[148:151], v[196:199], v[76:79]
    v_exp_f32 v44, v44
    v_mfma_f32_16x16x32_bf16 v[76:79], a[152:155], v[200:203], v[76:79]
    v_exp_f32 v45, v45
    v_mfma_f32_16x16x32_bf16 v[76:79], a[156:159], v[204:207], v[76:79]
    ds_read_b64_tr_b16 a[172:173], v215 offset:49152
    v_cvt_pk_bf16_f32 v91, v42, v43
    v_mfma_f32_16x16x32_bf16 a[112:115], a[188:191], v[96:99], a[112:115]
    v_exp_f32 v46, v46
    v_mfma_f32_16x16x32_bf16 a[116:119], a[188:191], v[100:103], a[116:119]
    v_exp_f32 v47, v47
    v_mfma_f32_16x16x32_bf16 a[120:123], a[188:191], v[104:107], a[120:123]
    v_cvt_pk_bf16_f32 v94, v44, v45
    v_cvt_pk_bf16_f32 v95, v46, v47
    v_mfma_f32_16x16x32_bf16 a[124:127], a[188:191], v[108:111], a[124:127]
    ds_read_b64_tr_b16 a[174:175], v215 offset:53248
    v_add_f32 v227, v227, v38
    v_mfma_f32_16x16x32_bf16 v[136:139], v[128:131], v[108:111], v[136:139]
    v_add_f32 v227, v227, v39
    s_waitcnt lgkmcnt(3)
    v_mfma_f32_16x16x32_bf16 v[16:19], a[128:131], v[144:147], v[112:115]
    v_exp_f32 v48, v48
    v_mfma_f32_16x16x32_bf16 v[16:19], a[132:135], v[148:151], v[16:19]
    ds_read_b128 a[144:147], v208 offset:53248
    v_add_f32 v226, v226, v48
    v_mfma_f32_16x16x32_bf16 v[16:19], a[136:139], v[152:155], v[16:19]
    v_exp_f32 v49, v49
    v_mfma_f32_16x16x32_bf16 v[16:19], a[140:143], v[156:159], v[16:19]
    ds_read_b64_tr_b16 a[176:177], v216 offset:49152
    v_add_f32 v226, v226, v49
    v_mfma_f32_16x16x32_bf16 a[0:3], a[160:163], v[80:83], a[0:3]
    v_exp_f32 v50, v50
    v_mfma_f32_16x16x32_bf16 a[4:7], a[160:163], v[84:87], a[4:7]
    ds_read_b128 a[148:151], v209 offset:53248
    v_cvt_pk_bf16_f32 v96, v48, v49
    v_mfma_f32_16x16x32_bf16 a[8:11], a[160:163], v[88:91], a[8:11]
    buffer_load_dwordx4 v223, s[8:11], s24 offen offset:3072 lds
    v_add_f32 v226, v226, v50
    v_mfma_f32_16x16x32_bf16 a[12:15], a[160:163], v[92:95], a[12:15]
    ds_read_b64_tr_b16 a[178:179], v216 offset:53248
    v_mfma_f32_16x16x32_bf16 v[20:23], a[128:131], v[160:163], v[116:119]
    v_exp_f32 v51, v51
    v_mfma_f32_16x16x32_bf16 v[20:23], a[132:135], v[164:167], v[20:23]
    v_exp_f32 v52, v52
    v_mfma_f32_16x16x32_bf16 v[20:23], a[136:139], v[168:171], v[20:23]
    v_exp_f32 v53, v53
    v_mfma_f32_16x16x32_bf16 v[20:23], a[140:143], v[172:175], v[20:23]
    ds_read_b64_tr_b16 a[180:181], v217 offset:49152
    v_add_f32 v226, v226, v51
    v_mfma_f32_16x16x32_bf16 a[16:19], a[164:167], v[80:83], a[16:19]
    v_exp_f32 v54, v54
    v_mfma_f32_16x16x32_bf16 a[20:23], a[164:167], v[84:87], a[20:23]
    ds_read_b128 a[152:155], v210 offset:53248
    s_add_u32 m0, s25, 81920
    v_mfma_f32_16x16x32_bf16 a[24:27], a[164:167], v[88:91], a[24:27]
    buffer_load_dwordx4 v224, s[12:15], s24 offen lds
    v_cvt_pk_bf16_f32 v97, v50, v51
    v_mfma_f32_16x16x32_bf16 a[28:31], a[164:167], v[92:95], a[28:31]
    ds_read_b64_tr_b16 a[182:183], v217 offset:53248
    v_cvt_pk_bf16_f32 v100, v52, v53
    v_mfma_f32_16x16x32_bf16 v[24:27], a[128:131], v[176:179], v[120:123]
    v_exp_f32 v55, v55
    v_mfma_f32_16x16x32_bf16 v[24:27], a[132:135], v[180:183], v[24:27]
    v_exp_f32 v56, v56
    v_mfma_f32_16x16x32_bf16 v[24:27], a[136:139], v[184:187], v[24:27]
    v_exp_f32 v57, v57
    v_mfma_f32_16x16x32_bf16 v[24:27], a[140:143], v[188:191], v[24:27]
    ds_read_b64_tr_b16 a[184:185], v218 offset:49152
    s_waitcnt lgkmcnt(8)
    v_mfma_f32_16x16x32_bf16 a[32:35], a[168:171], v[80:83], a[32:35]
    v_exp_f32 v58, v58
    v_mfma_f32_16x16x32_bf16 a[36:39], a[168:171], v[84:87], a[36:39]
    ds_read_b128 a[156:159], v211 offset:53248
    v_cvt_pk_bf16_f32 v101, v54, v55
    v_mfma_f32_16x16x32_bf16 a[40:43], a[168:171], v[88:91], a[40:43]
    buffer_load_dwordx4 v225, s[12:15], s24 offen offset:1024 lds
    v_cvt_pk_bf16_f32 v104, v56, v57
    v_mfma_f32_16x16x32_bf16 a[44:47], a[168:171], v[92:95], a[44:47]
    ds_read_b64_tr_b16 a[186:187], v218 offset:53248
    v_add_f32 v227, v227, v52
    v_mfma_f32_16x16x32_bf16 v[28:31], a[128:131], v[192:195], v[124:127]
    v_exp_f32 v59, v59
    v_mfma_f32_16x16x32_bf16 v[28:31], a[132:135], v[196:199], v[28:31]
    v_exp_f32 v60, v60
    v_mfma_f32_16x16x32_bf16 v[28:31], a[136:139], v[200:203], v[28:31]
    v_exp_f32 v61, v61
    v_mfma_f32_16x16x32_bf16 v[28:31], a[140:143], v[204:207], v[28:31]
    ds_read_b64_tr_b16 a[188:189], v219 offset:49152
    v_cvt_pk_bf16_f32 v105, v58, v59
    v_mfma_f32_16x16x32_bf16 a[48:51], a[172:175], v[80:83], a[48:51]
    v_exp_f32 v62, v62
    v_mfma_f32_16x16x32_bf16 a[52:55], a[172:175], v[84:87], a[52:55]
    v_exp_f32 v63, v63
    v_mfma_f32_16x16x32_bf16 a[56:59], a[172:175], v[88:91], a[56:59]
    buffer_load_dwordx4 v224, s[12:15], s24 offen offset:2048 lds
    v_cvt_pk_bf16_f32 v108, v60, v61
    v_mfma_f32_16x16x32_bf16 a[60:63], a[172:175], v[92:95], a[60:63]
    ds_read_b64_tr_b16 a[190:191], v219 offset:53248
    v_cvt_pk_bf16_f32 v109, v62, v63
    v_mfma_f32_16x16x32_bf16 v[132:135], v[128:131], v[88:91], v[132:135]
    v_add_f32 v227, v227, v53
    s_waitcnt lgkmcnt(3)
    v_mfma_f32_16x16x32_bf16 v[32:35], a[144:147], v[144:147], v[112:115]
    v_exp_f32 v64, v64
    v_mfma_f32_16x16x32_bf16 v[32:35], a[148:151], v[148:151], v[32:35]
    ds_read_b128 a[128:131], v208 offset:57344
    v_add_f32 v227, v227, v54
    v_mfma_f32_16x16x32_bf16 v[32:35], a[152:155], v[152:155], v[32:35]
    v_exp_f32 v65, v65
    v_mfma_f32_16x16x32_bf16 v[32:35], a[156:159], v[156:159], v[32:35]
    ds_read_b64_tr_b16 a[160:161], v212 offset:57344
    v_cvt_pk_bf16_f32 v98, v64, v65
    v_mfma_f32_16x16x32_bf16 a[64:67], a[176:179], v[80:83], a[64:67]
    v_exp_f32 v66, v66
    v_mfma_f32_16x16x32_bf16 a[68:71], a[176:179], v[84:87], a[68:71]
    ds_read_b128 a[132:135], v209 offset:57344
    v_add_f32 v227, v227, v55
    v_mfma_f32_16x16x32_bf16 a[72:75], a[176:179], v[88:91], a[72:75]
    buffer_load_dwordx4 v225, s[12:15], s24 offen offset:3072 lds
    v_add_f32 v226, v226, v64
    v_mfma_f32_16x16x32_bf16 a[76:79], a[176:179], v[92:95], a[76:79]
    ds_read_b64_tr_b16 a[162:163], v212 offset:61440
    v_add_f32 v226, v226, v65
    v_mfma_f32_16x16x32_bf16 v[36:39], a[144:147], v[160:163], v[116:119]
    v_exp_f32 v67, v67
    v_mfma_f32_16x16x32_bf16 v[36:39], a[148:151], v[164:167], v[36:39]
    v_exp_f32 v68, v68
    v_mfma_f32_16x16x32_bf16 v[36:39], a[152:155], v[168:171], v[36:39]
    v_exp_f32 v69, v69
    v_mfma_f32_16x16x32_bf16 v[36:39], a[156:159], v[172:175], v[36:39]
    ds_read_b64_tr_b16 a[164:165], v213 offset:57344
    v_cvt_pk_bf16_f32 v99, v66, v67
    v_mfma_f32_16x16x32_bf16 a[80:83], a[180:183], v[80:83], a[80:83]
    v_exp_f32 v70, v70
    v_mfma_f32_16x16x32_bf16 a[84:87], a[180:183], v[84:87], a[84:87]
    ds_read_b128 a[136:139], v210 offset:57344
    v_cvt_pk_bf16_f32 v102, v68, v69
    v_mfma_f32_16x16x32_bf16 a[88:91], a[180:183], v[88:91], a[88:91]
    v_exp_f32 v71, v71
    v_mfma_f32_16x16x32_bf16 a[92:95], a[180:183], v[92:95], a[92:95]
    ds_read_b64_tr_b16 a[166:167], v213 offset:61440
    s_add_u32 s24, s24, 16384
    v_mfma_f32_16x16x32_bf16 v[40:43], a[144:147], v[176:179], v[120:123]
    v_exp_f32 v72, v72
    v_mfma_f32_16x16x32_bf16 v[40:43], a[148:151], v[180:183], v[40:43]
    v_exp_f32 v73, v73
    v_mfma_f32_16x16x32_bf16 v[40:43], a[152:155], v[184:187], v[40:43]
    v_cvt_pk_bf16_f32 v103, v70, v71
    v_cvt_pk_bf16_f32 v106, v72, v73
    v_mfma_f32_16x16x32_bf16 v[40:43], a[156:159], v[188:191], v[40:43]
    ds_read_b64_tr_b16 a[168:169], v214 offset:57344
    s_waitcnt lgkmcnt(8)
    v_mfma_f32_16x16x32_bf16 a[96:99], a[184:187], v[80:83], a[96:99]
    v_exp_f32 v74, v74
    v_mfma_f32_16x16x32_bf16 a[100:103], a[184:187], v[84:87], a[100:103]
    ds_read_b128 a[140:143], v211 offset:57344
    v_add_f32 v226, v226, v66
    v_mfma_f32_16x16x32_bf16 a[104:107], a[184:187], v[88:91], a[104:107]
    v_exp_f32 v75, v75
    v_mfma_f32_16x16x32_bf16 a[108:111], a[184:187], v[92:95], a[108:111]
    ds_read_b64_tr_b16 a[170:171], v214 offset:61440
    v_cvt_pk_bf16_f32 v107, v74, v75
    v_mfma_f32_16x16x32_bf16 v[44:47], a[144:147], v[192:195], v[124:127]
    v_exp_f32 v76, v76
    v_mfma_f32_16x16x32_bf16 v[44:47], a[148:151], v[196:199], v[44:47]
    v_exp_f32 v77, v77
    v_mfma_f32_16x16x32_bf16 v[44:47], a[152:155], v[200:203], v[44:47]
    v_cvt_pk_bf16_f32 v110, v76, v77
    v_add_f32 v226, v226, v67
    v_mfma_f32_16x16x32_bf16 v[44:47], a[156:159], v[204:207], v[44:47]
    ds_read_b64_tr_b16 a[172:173], v215 offset:57344
    v_add_f32 v227, v227, v68
    v_mfma_f32_16x16x32_bf16 a[112:115], a[188:191], v[80:83], a[112:115]
    v_exp_f32 v78, v78
    v_mfma_f32_16x16x32_bf16 a[116:119], a[188:191], v[84:87], a[116:119]
    v_exp_f32 v79, v79
    v_mfma_f32_16x16x32_bf16 a[120:123], a[188:191], v[88:91], a[120:123]
    v_cvt_pk_bf16_f32 v111, v78, v79
    v_add_f32 v227, v227, v69
    v_mfma_f32_16x16x32_bf16 a[124:127], a[188:191], v[92:95], a[124:127]
    ds_read_b64_tr_b16 a[174:175], v215 offset:61440
    v_add_f32 v227, v227, v70
    v_mfma_f32_16x16x32_bf16 v[136:139], v[128:131], v[92:95], v[136:139]
    v_add_f32 v227, v227, v71
    s_waitcnt lgkmcnt(3)
    v_mfma_f32_16x16x32_bf16 v[48:51], a[128:131], v[144:147], v[112:115]
    v_exp_f32 v16, v16
    v_mfma_f32_16x16x32_bf16 v[48:51], a[132:135], v[148:151], v[48:51]
    ds_read_b128 a[144:147], v208 offset:61440
    v_add_f32 v226, v226, v16
    v_mfma_f32_16x16x32_bf16 v[48:51], a[136:139], v[152:155], v[48:51]
    v_exp_f32 v17, v17
    v_mfma_f32_16x16x32_bf16 v[48:51], a[140:143], v[156:159], v[48:51]
    ds_read_b64_tr_b16 a[176:177], v216 offset:57344
    v_add_f32 v226, v226, v17
    v_mfma_f32_16x16x32_bf16 a[0:3], a[160:163], v[96:99], a[0:3]
    v_exp_f32 v18, v18
    v_mfma_f32_16x16x32_bf16 a[4:7], a[160:163], v[100:103], a[4:7]
    ds_read_b128 a[148:151], v209 offset:61440
    v_cvt_pk_bf16_f32 v80, v16, v17
    v_mfma_f32_16x16x32_bf16 a[8:11], a[160:163], v[104:107], a[8:11]
    v_exp_f32 v19, v19
    v_mfma_f32_16x16x32_bf16 a[12:15], a[160:163], v[108:111], a[12:15]
    ds_read_b64_tr_b16 a[178:179], v216 offset:61440
    v_add_f32 v226, v226, v18
    v_mfma_f32_16x16x32_bf16 v[52:55], a[128:131], v[160:163], v[116:119]
    v_exp_f32 v20, v20
    v_mfma_f32_16x16x32_bf16 v[52:55], a[132:135], v[164:167], v[52:55]
    v_exp_f32 v21, v21
    v_mfma_f32_16x16x32_bf16 v[52:55], a[136:139], v[168:171], v[52:55]
    v_add_f32 v226, v226, v19
    v_cvt_pk_bf16_f32 v81, v18, v19
    v_mfma_f32_16x16x32_bf16 v[52:55], a[140:143], v[172:175], v[52:55]
    ds_read_b64_tr_b16 a[180:181], v217 offset:57344
    v_cvt_pk_bf16_f32 v84, v20, v21
    v_mfma_f32_16x16x32_bf16 a[16:19], a[164:167], v[96:99], a[16:19]
    v_exp_f32 v22, v22
    v_mfma_f32_16x16x32_bf16 a[20:23], a[164:167], v[100:103], a[20:23]
    ds_read_b128 a[152:155], v210 offset:61440
    v_add_f32 v227, v227, v20
    v_mfma_f32_16x16x32_bf16 a[24:27], a[164:167], v[104:107], a[24:27]
    v_exp_f32 v23, v23
    v_mfma_f32_16x16x32_bf16 a[28:31], a[164:167], v[108:111], a[28:31]
    ds_read_b64_tr_b16 a[182:183], v217 offset:61440
    v_cvt_pk_bf16_f32 v85, v22, v23
    v_mfma_f32_16x16x32_bf16 v[56:59], a[128:131], v[176:179], v[120:123]
    v_exp_f32 v24, v24
    v_mfma_f32_16x16x32_bf16 v[56:59], a[132:135], v[180:183], v[56:59]
    v_exp_f32 v25, v25
    v_mfma_f32_16x16x32_bf16 v[56:59], a[136:139], v[184:187], v[56:59]
    v_cvt_pk_bf16_f32 v88, v24, v25
    v_add_f32 v227, v227, v21
    v_mfma_f32_16x16x32_bf16 v[56:59], a[140:143], v[188:191], v[56:59]
    ds_read_b64_tr_b16 a[184:185], v218 offset:57344
    s_waitcnt lgkmcnt(8)
    v_mfma_f32_16x16x32_bf16 a[32:35], a[168:171], v[96:99], a[32:35]
    v_exp_f32 v26, v26
    v_mfma_f32_16x16x32_bf16 a[36:39], a[168:171], v[100:103], a[36:39]
    ds_read_b128 a[156:159], v211 offset:61440
    v_add_f32 v227, v227, v22
    v_mfma_f32_16x16x32_bf16 a[40:43], a[168:171], v[104:107], a[40:43]
    v_exp_f32 v27, v27
    v_mfma_f32_16x16x32_bf16 a[44:47], a[168:171], v[108:111], a[44:47]
    ds_read_b64_tr_b16 a[186:187], v218 offset:61440
    v_cvt_pk_bf16_f32 v89, v26, v27
    v_mfma_f32_16x16x32_bf16 v[60:63], a[128:131], v[192:195], v[124:127]
    v_exp_f32 v28, v28
    v_mfma_f32_16x16x32_bf16 v[60:63], a[132:135], v[196:199], v[60:63]
    v_exp_f32 v29, v29
    v_mfma_f32_16x16x32_bf16 v[60:63], a[136:139], v[200:203], v[60:63]
    v_cvt_pk_bf16_f32 v92, v28, v29
    v_add_f32 v227, v227, v23
    v_mfma_f32_16x16x32_bf16 v[60:63], a[140:143], v[204:207], v[60:63]
    ds_read_b64_tr_b16 a[188:189], v219 offset:57344
    v_mfma_f32_16x16x32_bf16 a[48:51], a[172:175], v[96:99], a[48:51]
    v_exp_f32 v30, v30
    v_mfma_f32_16x16x32_bf16 a[52:55], a[172:175], v[100:103], a[52:55]
    v_exp_f32 v31, v31
    v_mfma_f32_16x16x32_bf16 a[56:59], a[172:175], v[104:107], a[56:59]
    v_cvt_pk_bf16_f32 v93, v30, v31
    v_mfma_f32_16x16x32_bf16 a[60:63], a[172:175], v[108:111], a[60:63]
    ds_read_b64_tr_b16 a[190:191], v219 offset:61440
    v_mfma_f32_16x16x32_bf16 v[132:135], v[128:131], v[104:107], v[132:135]
    s_waitcnt vmcnt(8) lgkmcnt(3)
    s_barrier
    v_mfma_f32_16x16x32_bf16 v[64:67], a[144:147], v[144:147], v[112:115]
    v_exp_f32 v32, v32
    v_mfma_f32_16x16x32_bf16 v[64:67], a[148:151], v[148:151], v[64:67]
    ds_read_b128 a[128:131], v208 offset:0
    v_add_f32 v226, v226, v32
    v_mfma_f32_16x16x32_bf16 v[64:67], a[152:155], v[152:155], v[64:67]
    v_exp_f32 v33, v33
    v_mfma_f32_16x16x32_bf16 v[64:67], a[156:159], v[156:159], v[64:67]
    ds_read_b64_tr_b16 a[160:161], v212 offset:0
    v_cvt_pk_bf16_f32 v82, v32, v33
    v_mfma_f32_16x16x32_bf16 a[64:67], a[176:179], v[96:99], a[64:67]
    v_exp_f32 v34, v34
    v_mfma_f32_16x16x32_bf16 a[68:71], a[176:179], v[100:103], a[68:71]
    ds_read_b128 a[132:135], v209 offset:0
    s_add_u32 m0, s25, 32768
    v_mfma_f32_16x16x32_bf16 a[72:75], a[176:179], v[104:107], a[72:75]
    buffer_load_dwordx4 v220, s[8:11], s24 offen lds
    v_add_f32 v226, v226, v33
    v_mfma_f32_16x16x32_bf16 a[76:79], a[176:179], v[108:111], a[76:79]
    ds_read_b64_tr_b16 a[162:163], v212 offset:4096
    v_add_f32 v226, v226, v34
    v_mfma_f32_16x16x32_bf16 v[68:71], a[144:147], v[160:163], v[116:119]
    v_exp_f32 v35, v35
    v_mfma_f32_16x16x32_bf16 v[68:71], a[148:151], v[164:167], v[68:71]
    v_exp_f32 v36, v36
    v_mfma_f32_16x16x32_bf16 v[68:71], a[152:155], v[168:171], v[68:71]
    v_exp_f32 v37, v37
    v_mfma_f32_16x16x32_bf16 v[68:71], a[156:159], v[172:175], v[68:71]
    ds_read_b64_tr_b16 a[164:165], v213 offset:0
    v_cvt_pk_bf16_f32 v83, v34, v35
    v_mfma_f32_16x16x32_bf16 a[80:83], a[180:183], v[96:99], a[80:83]
    v_exp_f32 v38, v38
    v_mfma_f32_16x16x32_bf16 a[84:87], a[180:183], v[100:103], a[84:87]
    ds_read_b128 a[136:139], v210 offset:0
    v_cvt_pk_bf16_f32 v86, v36, v37
    v_mfma_f32_16x16x32_bf16 a[88:91], a[180:183], v[104:107], a[88:91]
    buffer_load_dwordx4 v221, s[8:11], s24 offen offset:1024 lds
    v_add_f32 v226, v226, v35
    v_mfma_f32_16x16x32_bf16 a[92:95], a[180:183], v[108:111], a[92:95]
    ds_read_b64_tr_b16 a[166:167], v213 offset:4096
    v_add_f32 v227, v227, v36
    v_mfma_f32_16x16x32_bf16 v[72:75], a[144:147], v[176:179], v[120:123]
    v_exp_f32 v39, v39
    v_mfma_f32_16x16x32_bf16 v[72:75], a[148:151], v[180:183], v[72:75]
    v_exp_f32 v40, v40
    v_mfma_f32_16x16x32_bf16 v[72:75], a[152:155], v[184:187], v[72:75]
    v_exp_f32 v41, v41
    v_mfma_f32_16x16x32_bf16 v[72:75], a[156:159], v[188:191], v[72:75]
    ds_read_b64_tr_b16 a[168:169], v214 offset:0
    s_waitcnt lgkmcnt(8)
    v_mfma_f32_16x16x32_bf16 a[96:99], a[184:187], v[96:99], a[96:99]
    v_exp_f32 v42, v42
    v_mfma_f32_16x16x32_bf16 a[100:103], a[184:187], v[100:103], a[100:103]
    ds_read_b128 a[140:143], v211 offset:0
    v_cvt_pk_bf16_f32 v87, v38, v39
    v_mfma_f32_16x16x32_bf16 a[104:107], a[184:187], v[104:107], a[104:107]
    buffer_load_dwordx4 v222, s[8:11], s24 offen offset:2048 lds
    v_cvt_pk_bf16_f32 v90, v40, v41
    v_mfma_f32_16x16x32_bf16 a[108:111], a[184:187], v[108:111], a[108:111]
    ds_read_b64_tr_b16 a[170:171], v214 offset:4096
    v_add_f32 v227, v227, v37
    v_mfma_f32_16x16x32_bf16 v[76:79], a[144:147], v[192:195], v[124:127]
    v_exp_f32 v43, v43
    v_mfma_f32_16x16x32_bf16 v[76:79], a[148:151], v[196:199], v[76:79]
    v_exp_f32 v44, v44
    v_mfma_f32_16x16x32_bf16 v[76:79], a[152:155], v[200:203], v[76:79]
    v_exp_f32 v45, v45
    v_mfma_f32_16x16x32_bf16 v[76:79], a[156:159], v[204:207], v[76:79]
    ds_read_b64_tr_b16 a[172:173], v215 offset:0
    v_cvt_pk_bf16_f32 v91, v42, v43
    v_mfma_f32_16x16x32_bf16 a[112:115], a[188:191], v[96:99], a[112:115]
    v_exp_f32 v46, v46
    v_mfma_f32_16x16x32_bf16 a[116:119], a[188:191], v[100:103], a[116:119]
    v_exp_f32 v47, v47
    v_mfma_f32_16x16x32_bf16 a[120:123], a[188:191], v[104:107], a[120:123]
    v_cvt_pk_bf16_f32 v94, v44, v45
    v_cvt_pk_bf16_f32 v95, v46, v47
    v_mfma_f32_16x16x32_bf16 a[124:127], a[188:191], v[108:111], a[124:127]
    ds_read_b64_tr_b16 a[174:175], v215 offset:4096
    v_add_f32 v227, v227, v38
    v_mfma_f32_16x16x32_bf16 v[136:139], v[128:131], v[108:111], v[136:139]
    v_add_f32 v227, v227, v39
    s_sub_u32 s26, s26, 1
    s_cmp_lg_u32 s26, 0
    s_cbranch_scc1 K_aloop
    s_waitcnt lgkmcnt(3)
    v_mfma_f32_16x16x32_bf16 v[16:19], a[128:131], v[144:147], v[112:115]
    v_exp_f32 v48, v48
    v_mfma_f32_16x16x32_bf16 v[16:19], a[132:135], v[148:151], v[16:19]
    ds_read_b128 a[144:147], v208 offset:4096
    v_add_f32 v226, v226, v48
    v_mfma_f32_16x16x32_bf16 v[16:19], a[136:139], v[152:155], v[16:19]
    v_exp_f32 v49, v49
    v_mfma_f32_16x16x32_bf16 v[16:19], a[140:143], v[156:159], v[16:19]
    ds_read_b64_tr_b16 a[176:177], v216 offset:0
    v_add_f32 v226, v226, v49
    v_mfma_f32_16x16x32_bf16 a[0:3], a[160:163], v[80:83], a[0:3]
    v_exp_f32 v50, v50
    v_mfma_f32_16x16x32_bf16 a[4:7], a[160:163], v[84:87], a[4:7]
    ds_read_b128 a[148:151], v209 offset:4096
    v_cvt_pk_bf16_f32 v96, v48, v49
    v_mfma_f32_16x16x32_bf16 a[8:11], a[160:163], v[88:91], a[8:11]
    buffer_load_dwordx4 v223, s[8:11], s24 offen offset:3072 lds
    v_add_f32 v226, v226, v50
    v_mfma_f32_16x16x32_bf16 a[12:15], a[160:163], v[92:95], a[12:15]
    ds_read_b64_tr_b16 a[178:179], v216 offset:4096
    v_mfma_f32_16x16x32_bf16 v[20:23], a[128:131], v[160:163], v[116:119]
    v_exp_f32 v51, v51
    v_mfma_f32_16x16x32_bf16 v[20:23], a[132:135], v[164:167], v[20:23]
    v_exp_f32 v52, v52
    v_mfma_f32_16x16x32_bf16 v[20:23], a[136:139], v[168:171], v[20:23]
    v_exp_f32 v53, v53
    v_mfma_f32_16x16x32_bf16 v[20:23], a[140:143], v[172:175], v[20:23]
    ds_read_b64_tr_b16 a[180:181], v217 offset:0
    v_add_f32 v226, v226, v51
    v_mfma_f32_16x16x32_bf16 a[16:19], a[164:167], v[80:83], a[16:19]
    v_exp_f32 v54, v54
    v_mfma_f32_16x16x32_bf16 a[20:23], a[164:167], v[84:87], a[20:23]
    ds_read_b128 a[152:155], v210 offset:4096
    s_add_u32 m0, s25, 98304
    v_mfma_f32_16x16x32_bf16 a[24:27], a[164:167], v[88:91], a[24:27]
    buffer_load_dwordx4 v224, s[12:15], s24 offen lds
    v_cvt_pk_bf16_f32 v97, v50, v51
    v_mfma_f32_16x16x32_bf16 a[28:31], a[164:167], v[92:95], a[28:31]
    ds_read_b64_tr_b16 a[182:183], v217 offset:4096
    v_cvt_pk_bf16_f32 v100, v52, v53
    v_mfma_f32_16x16x32_bf16 v[24:27], a[128:131], v[176:179], v[120:123]
    v_exp_f32 v55, v55
    v_mfma_f32_16x16x32_bf16 v[24:27], a[132:135], v[180:183], v[24:27]
    v_exp_f32 v56, v56
    v_mfma_f32_16x16x32_bf16 v[24:27], a[136:139], v[184:187], v[24:27]
    v_exp_f32 v57, v57
    v_mfma_f32_16x16x32_bf16 v[24:27], a[140:143], v[188:191], v[24:27]
    ds_read_b64_tr_b16 a[184:185], v218 offset:0
    s_waitcnt lgkmcnt(8)
    v_mfma_f32_16x16x32_bf16 a[32:35], a[168:171], v[80:83], a[32:35]
    v_exp_f32 v58, v58
    v_mfma_f32_16x16x32_bf16 a[36:39], a[168:171], v[84:87], a[36:39]
    ds_read_b128 a[156:159], v211 offset:4096
    v_cvt_pk_bf16_f32 v101, v54, v55
    v_mfma_f32_16x16x32_bf16 a[40:43], a[168:171], v[88:91], a[40:43]
    buffer_load_dwordx4 v225, s[12:15], s24 offen offset:1024 lds
    v_cvt_pk_bf16_f32 v104, v56, v57
    v_mfma_f32_16x16x32_bf16 a[44:47], a[168:171], v[92:95], a[44:47]
    ds_read_b64_tr_b16 a[186:187], v218 offset:4096
    v_add_f32 v227, v227, v52
    v_mfma_f32_16x16x32_bf16 v[28:31], a[128:131], v[192:195], v[124:127]
    v_exp_f32 v59, v59
    v_mfma_f32_16x16x32_bf16 v[28:31], a[132:135], v[196:199], v[28:31]
    v_exp_f32 v60, v60
    v_mfma_f32_16x16x32_bf16 v[28:31], a[136:139], v[200:203], v[28:31]
    v_exp_f32 v61, v61
    v_mfma_f32_16x16x32_bf16 v[28:31], a[140:143], v[204:207], v[28:31]
    ds_read_b64_tr_b16 a[188:189], v219 offset:0
    v_cvt_pk_bf16_f32 v105, v58, v59
    v_mfma_f32_16x16x32_bf16 a[48:51], a[172:175], v[80:83], a[48:51]
    v_exp_f32 v62, v62
    v_mfma_f32_16x16x32_bf16 a[52:55], a[172:175], v[84:87], a[52:55]
    v_exp_f32 v63, v63
    v_mfma_f32_16x16x32_bf16 a[56:59], a[172:175], v[88:91], a[56:59]
    buffer_load_dwordx4 v224, s[12:15], s24 offen offset:2048 lds
    v_cvt_pk_bf16_f32 v108, v60, v61
    v_mfma_f32_16x16x32_bf16 a[60:63], a[172:175], v[92:95], a[60:63]
    ds_read_b64_tr_b16 a[190:191], v219 offset:4096
    v_cvt_pk_bf16_f32 v109, v62, v63
    v_mfma_f32_16x16x32_bf16 v[132:135], v[128:131], v[88:91], v[132:135]
    v_add_f32 v227, v227, v53
    s_waitcnt lgkmcnt(3)
    v_mfma_f32_16x16x32_bf16 v[32:35], a[144:147], v[144:147], v[112:115]
    v_exp_f32 v64, v64
    v_mfma_f32_16x16x32_bf16 v[32:35], a[148:151], v[148:151], v[32:35]
    ds_read_b128 a[128:131], v208 offset:8192
    v_add_f32 v227, v227, v54
    v_mfma_f32_16x16x32_bf16 v[32:35], a[152:155], v[152:155], v[32:35]
    v_exp_f32 v65, v65
    v_mfma_f32_16x16x32_bf16 v[32:35], a[156:159], v[156:159], v[32:35]
    ds_read_b64_tr_b16 a[160:161], v212 offset:8192
    v_cvt_pk_bf16_f32 v98, v64, v65
    v_mfma_f32_16x16x32_bf16 a[64:67], a[176:179], v[80:83], a[64:67]
    v_exp_f32 v66, v66
    v_mfma_f32_16x16x32_bf16 a[68:71], a[176:179], v[84:87], a[68:71]
    ds_read_b128 a[132:135], v209 offset:8192
    v_add_f32 v227, v227, v55
    v_mfma_f32_16x16x32_bf16 a[72:75], a[176:179], v[88:91], a[72:75]
    buffer_load_dwordx4 v225, s[12:15], s24 offen offset:3072 lds
    v_add_f32 v226, v226, v64
    v_mfma_f32_16x16x32_bf16 a[76:79], a[176:179], v[92:95], a[76:79]
    ds_read_b64_tr_b16 a[162:163], v212 offset:12288
    v_add_f32 v226, v226, v65
    v_mfma_f32_16x16x32_bf16 v[36:39], a[144:147], v[160:163], v[116:119]
    v_exp_f32 v67, v67
    v_mfma_f32_16x16x32_bf16 v[36:39], a[148:151], v[164:167], v[36:39]
    v_exp_f32 v68, v68
    v_mfma_f32_16x16x32_bf16 v[36:39], a[152:155], v[168:171], v[36:39]
    v_exp_f32 v69, v69
    v_mfma_f32_16x16x32_bf16 v[36:39], a[156:159], v[172:175], v[36:39]
    ds_read_b64_tr_b16 a[164:165], v213 offset:8192
    v_cvt_pk_bf16_f32 v99, v66, v67
    v_mfma_f32_16x16x32_bf16 a[80:83], a[180:183], v[80:83], a[80:83]
    v_exp_f32 v70, v70
    v_mfma_f32_16x16x32_bf16 a[84:87], a[180:183], v[84:87], a[84:87]
    ds_read_b128 a[136:139], v210 offset:8192
    v_cvt_pk_bf16_f32 v102, v68, v69
    v_mfma_f32_16x16x32_bf16 a[88:91], a[180:183], v[88:91], a[88:91]
    v_exp_f32 v71, v71
    v_mfma_f32_16x16x32_bf16 a[92:95], a[180:183], v[92:95], a[92:95]
    ds_read_b64_tr_b16 a[166:167], v213 offset:12288
    s_add_u32 s24, s24, 16384
    v_mfma_f32_16x16x32_bf16 v[40:43], a[144:147], v[176:179], v[120:123]
    v_exp_f32 v72, v72
    v_mfma_f32_16x16x32_bf16 v[40:43], a[148:151], v[180:183], v[40:43]
    v_exp_f32 v73, v73
    v_mfma_f32_16x16x32_bf16 v[40:43], a[152:155], v[184:187], v[40:43]
    v_cvt_pk_bf16_f32 v103, v70, v71
    v_cvt_pk_bf16_f32 v106, v72, v73
    v_mfma_f32_16x16x32_bf16 v[40:43], a[156:159], v[188:191], v[40:43]
    ds_read_b64_tr_b16 a[168:169], v214 offset:8192
    s_waitcnt lgkmcnt(8)
    v_mfma_f32_16x16x32_bf16 a[96:99], a[184:187], v[80:83], a[96:99]
    v_exp_f32 v74, v74
    v_mfma_f32_16x16x32_bf16 a[100:103], a[184:187], v[84:87], a[100:103]
    ds_read_b128 a[140:143], v211 offset:8192
    v_add_f32 v226, v226, v66
    v_mfma_f32_16x16x32_bf16 a[104:107], a[184:187], v[88:91], a[104:107]
    v_exp_f32 v75, v75
    v_mfma_f32_16x16x32_bf16 a[108:111], a[184:187], v[92:95], a[108:111]
    ds_read_b64_tr_b16 a[170:171], v214 offset:12288
    v_cvt_pk_bf16_f32 v107, v74, v75
    v_mfma_f32_16x16x32_bf16 v[44:47], a[144:147], v[192:195], v[124:127]
    v_exp_f32 v76, v76
    v_mfma_f32_16x16x32_bf16 v[44:47], a[148:151], v[196:199], v[44:47]
    v_exp_f32 v77, v77
    v_mfma_f32_16x16x32_bf16 v[44:47], a[152:155], v[200:203], v[44:47]
    v_cvt_pk_bf16_f32 v110, v76, v77
    v_add_f32 v226, v226, v67
    v_mfma_f32_16x16x32_bf16 v[44:47], a[156:159], v[204:207], v[44:47]
    ds_read_b64_tr_b16 a[172:173], v215 offset:8192
    v_add_f32 v227, v227, v68
    v_mfma_f32_16x16x32_bf16 a[112:115], a[188:191], v[80:83], a[112:115]
    v_exp_f32 v78, v78
    v_mfma_f32_16x16x32_bf16 a[116:119], a[188:191], v[84:87], a[116:119]
    v_exp_f32 v79, v79
    v_mfma_f32_16x16x32_bf16 a[120:123], a[188:191], v[88:91], a[120:123]
    v_cvt_pk_bf16_f32 v111, v78, v79
    v_add_f32 v227, v227, v69
    v_mfma_f32_16x16x32_bf16 a[124:127], a[188:191], v[92:95], a[124:127]
    ds_read_b64_tr_b16 a[174:175], v215 offset:12288
    v_add_f32 v227, v227, v70
    v_mfma_f32_16x16x32_bf16 v[136:139], v[128:131], v[92:95], v[136:139]
    v_add_f32 v227, v227, v71
    s_waitcnt lgkmcnt(3)
    v_mfma_f32_16x16x32_bf16 v[48:51], a[128:131], v[144:147], v[112:115]
    v_exp_f32 v16, v16
    v_mfma_f32_16x16x32_bf16 v[48:51], a[132:135], v[148:151], v[48:51]
    ds_read_b128 a[144:147], v208 offset:12288
    v_add_f32 v226, v226, v16
    v_mfma_f32_16x16x32_bf16 v[48:51], a[136:139], v[152:155], v[48:51]
    v_exp_f32 v17, v17
    v_mfma_f32_16x16x32_bf16 v[48:51], a[140:143], v[156:159], v[48:51]
    ds_read_b64_tr_b16 a[176:177], v216 offset:8192
    s_load_dwordx2 s[40:41], s[0:1], 32
    s_load_dwordx2 s[42:43], s[0:1], 64
    s_and_b32 s51, s2, 3
    s_bfe_u32 s58, s2, 0x30003
    s_lshl_b32 s58, s58, 2
    s_lshr_b32 s59, s2, 6
    s_add_u32 s58, s58, s59
    s_lshl_b32 s58, s58, 2
    s_add_u32 s58, s58, s3
    s_lshl_b32 s58, s58, 4
    s_mul_i32 s59, s51, 1536
    s_add_u32 s59, s59, s58
    v_lshlrev_b32 v242, 7, v1
    v_add_u32 v243, 8192, v242
    v_mfma_f32_16x16x32_bf16 a[0:3], a[160:163], v[96:99], a[0:3]
    v_exp_f32 v18, v18
    v_mfma_f32_16x16x32_bf16 a[4:7], a[160:163], v[100:103], a[4:7]
    ds_read_b128 a[148:151], v209 offset:12288
    v_add_f32 v226, v226, v17
    v_mfma_f32_16x16x32_bf16 a[8:11], a[160:163], v[104:107], a[8:11]
    v_exp_f32 v19, v19
    v_mfma_f32_16x16x32_bf16 a[12:15], a[160:163], v[108:111], a[12:15]
    ds_read_b64_tr_b16 a[178:179], v216 offset:12288
    v_cvt_pk_bf16_f32 v80, v16, v17
    v_mfma_f32_16x16x32_bf16 v[52:55], a[128:131], v[160:163], v[116:119]
    v_exp_f32 v20, v20
    v_mfma_f32_16x16x32_bf16 v[52:55], a[132:135], v[164:167], v[52:55]
    v_exp_f32 v21, v21
    v_mfma_f32_16x16x32_bf16 v[52:55], a[136:139], v[168:171], v[52:55]
    v_add_f32 v226, v226, v18
    v_add_f32 v226, v226, v19
    v_mfma_f32_16x16x32_bf16 v[52:55], a[140:143], v[172:175], v[52:55]
    ds_read_b64_tr_b16 a[180:181], v217 offset:8192
    v_cvt_pk_bf16_f32 v81, v18, v19
    v_mfma_f32_16x16x32_bf16 a[16:19], a[164:167], v[96:99], a[16:19]
    v_exp_f32 v22, v22
    v_mfma_f32_16x16x32_bf16 a[20:23], a[164:167], v[100:103], a[20:23]
    ds_read_b128 a[152:155], v210 offset:12288
    v_cvt_pk_bf16_f32 v84, v20, v21
    v_mfma_f32_16x16x32_bf16 a[24:27], a[164:167], v[104:107], a[24:27]
    v_exp_f32 v23, v23
    v_mfma_f32_16x16x32_bf16 a[28:31], a[164:167], v[108:111], a[28:31]
    ds_read_b64_tr_b16 a[182:183], v217 offset:12288
    v_cvt_pk_bf16_f32 v85, v22, v23
    v_mfma_f32_16x16x32_bf16 v[56:59], a[128:131], v[176:179], v[120:123]
    v_exp_f32 v24, v24
    v_mfma_f32_16x16x32_bf16 v[56:59], a[132:135], v[180:183], v[56:59]
    v_exp_f32 v25, v25
    v_mfma_f32_16x16x32_bf16 v[56:59], a[136:139], v[184:187], v[56:59]
    v_cvt_pk_bf16_f32 v88, v24, v25
    v_add_f32 v227, v227, v20
    v_mfma_f32_16x16x32_bf16 v[56:59], a[140:143], v[188:191], v[56:59]
    ds_read_b64_tr_b16 a[184:185], v218 offset:8192
    s_waitcnt lgkmcnt(0)
    v_mfma_f32_16x16x32_bf16 a[32:35], a[168:171], v[96:99], a[32:35]
    v_exp_f32 v26, v26
    v_mfma_f32_16x16x32_bf16 a[36:39], a[168:171], v[100:103], a[36:39]
    ds_read_b128 a[156:159], v211 offset:12288
    v_add_f32 v227, v227, v21
    v_mfma_f32_16x16x32_bf16 a[40:43], a[168:171], v[104:107], a[40:43]
    v_exp_f32 v27, v27
    v_mfma_f32_16x16x32_bf16 a[44:47], a[168:171], v[108:111], a[44:47]
    ds_read_b64_tr_b16 a[186:187], v218 offset:12288
    v_cvt_pk_bf16_f32 v89, v26, v27
    v_mfma_f32_16x16x32_bf16 v[60:63], a[128:131], v[192:195], v[124:127]
    v_exp_f32 v28, v28
    v_mfma_f32_16x16x32_bf16 v[60:63], a[132:135], v[196:199], v[60:63]
    v_exp_f32 v29, v29
    v_mfma_f32_16x16x32_bf16 v[60:63], a[136:139], v[200:203], v[60:63]
    v_cvt_pk_bf16_f32 v92, v28, v29
    v_add_f32 v227, v227, v22
    v_mfma_f32_16x16x32_bf16 v[60:63], a[140:143], v[204:207], v[60:63]
    ds_read_b64_tr_b16 a[188:189], v219 offset:8192
    v_add_f32 v227, v227, v23
    v_mfma_f32_16x16x32_bf16 a[48:51], a[172:175], v[96:99], a[48:51]
    v_exp_f32 v30, v30
    v_mfma_f32_16x16x32_bf16 a[52:55], a[172:175], v[100:103], a[52:55]
    v_exp_f32 v31, v31
    v_mfma_f32_16x16x32_bf16 a[56:59], a[172:175], v[104:107], a[56:59]
    v_cvt_pk_bf16_f32 v93, v30, v31
    v_mfma_f32_16x16x32_bf16 a[60:63], a[172:175], v[108:111], a[60:63]
    ds_read_b64_tr_b16 a[190:191], v219 offset:12288
    v_mfma_f32_16x16x32_bf16 v[132:135], v[128:131], v[104:107], v[132:135]
    s_waitcnt vmcnt(8) lgkmcnt(3)
    s_barrier
    v_mfma_f32_16x16x32_bf16 v[64:67], a[144:147], v[144:147], v[112:115]
    v_exp_f32 v32, v32
    v_mfma_f32_16x16x32_bf16 v[64:67], a[148:151], v[148:151], v[64:67]
    ds_read_b128 a[128:131], v208 offset:16384
    v_add_f32 v226, v226, v32
    v_mfma_f32_16x16x32_bf16 v[64:67], a[152:155], v[152:155], v[64:67]
    v_exp_f32 v33, v33
    v_mfma_f32_16x16x32_bf16 v[64:67], a[156:159], v[156:159], v[64:67]
    ds_read_b64_tr_b16 a[160:161], v212 offset:16384
    v_cvt_pk_bf16_f32 v82, v32, v33
    v_mfma_f32_16x16x32_bf16 a[64:67], a[176:179], v[96:99], a[64:67]
    v_exp_f32 v34, v34
    v_mfma_f32_16x16x32_bf16 a[68:71], a[176:179], v[100:103], a[68:71]
    ds_read_b128 a[132:135], v209 offset:16384
    v_add_f32 v226, v226, v33
    v_mfma_f32_16x16x32_bf16 a[72:75], a[176:179], v[104:107], a[72:75]
    v_exp_f32 v35, v35
    v_mfma_f32_16x16x32_bf16 a[76:79], a[176:179], v[108:111], a[76:79]
    ds_read_b64_tr_b16 a[162:163], v212 offset:20480
    v_cvt_pk_bf16_f32 v83, v34, v35
    v_mfma_f32_16x16x32_bf16 v[68:71], a[144:147], v[160:163], v[116:119]
    v_exp_f32 v36, v36
    v_mfma_f32_16x16x32_bf16 v[68:71], a[148:151], v[164:167], v[68:71]
    v_exp_f32 v37, v37
    v_mfma_f32_16x16x32_bf16 v[68:71], a[152:155], v[168:171], v[68:71]
    v_cvt_pk_bf16_f32 v86, v36, v37
    v_add_f32 v226, v226, v34
    v_mfma_f32_16x16x32_bf16 v[68:71], a[156:159], v[172:175], v[68:71]
    ds_read_b64_tr_b16 a[164:165], v213 offset:16384
    v_add_f32 v226, v226, v35
    v_mfma_f32_16x16x32_bf16 a[80:83], a[180:183], v[96:99], a[80:83]
    v_exp_f32 v38, v38
    v_mfma_f32_16x16x32_bf16 a[84:87], a[180:183], v[100:103], a[84:87]
    ds_read_b128 a[136:139], v210 offset:16384
    v_add_f32 v227, v227, v36
    v_mfma_f32_16x16x32_bf16 a[88:91], a[180:183], v[104:107], a[88:91]
    v_exp_f32 v39, v39
    v_mfma_f32_16x16x32_bf16 a[92:95], a[180:183], v[108:111], a[92:95]
    ds_read_b64_tr_b16 a[166:167], v213 offset:20480
    v_cvt_pk_bf16_f32 v87, v38, v39
    v_mfma_f32_16x16x32_bf16 v[72:75], a[144:147], v[176:179], v[120:123]
    v_exp_f32 v40, v40
    v_mfma_f32_16x16x32_bf16 v[72:75], a[148:151], v[180:183], v[72:75]
    v_exp_f32 v41, v41
    v_mfma_f32_16x16x32_bf16 v[72:75], a[152:155], v[184:187], v[72:75]
    v_cvt_pk_bf16_f32 v90, v40, v41
    v_add_f32 v227, v227, v37
    v_mfma_f32_16x16x32_bf16 v[72:75], a[156:159], v[188:191], v[72:75]
    ds_read_b64_tr_b16 a[168:169], v214 offset:16384
    s_waitcnt lgkmcnt(8)
    v_mfma_f32_16x16x32_bf16 a[96:99], a[184:187], v[96:99], a[96:99]
    v_exp_f32 v42, v42
    v_mfma_f32_16x16x32_bf16 a[100:103], a[184:187], v[100:103], a[100:103]
    ds_read_b128 a[140:143], v211 offset:16384
    v_add_f32 v227, v227, v38
    v_mfma_f32_16x16x32_bf16 a[104:107], a[184:187], v[104:107], a[104:107]
    v_exp_f32 v43, v43
    v_mfma_f32_16x16x32_bf16 a[108:111], a[184:187], v[108:111], a[108:111]
    ds_read_b64_tr_b16 a[170:171], v214 offset:20480
    v_cvt_pk_bf16_f32 v91, v42, v43
    v_mfma_f32_16x16x32_bf16 v[76:79], a[144:147], v[192:195], v[124:127]
    v_exp_f32 v44, v44
    v_mfma_f32_16x16x32_bf16 v[76:79], a[148:151], v[196:199], v[76:79]
    v_exp_f32 v45, v45
    v_mfma_f32_16x16x32_bf16 v[76:79], a[152:155], v[200:203], v[76:79]
    v_cvt_pk_bf16_f32 v94, v44, v45
    v_add_f32 v227, v227, v39
    v_mfma_f32_16x16x32_bf16 v[76:79], a[156:159], v[204:207], v[76:79]
    ds_read_b64_tr_b16 a[172:173], v215 offset:16384
    v_mfma_f32_16x16x32_bf16 a[112:115], a[188:191], v[96:99], a[112:115]
    v_exp_f32 v46, v46
    v_mfma_f32_16x16x32_bf16 a[116:119], a[188:191], v[100:103], a[116:119]
    v_exp_f32 v47, v47
    v_mfma_f32_16x16x32_bf16 a[120:123], a[188:191], v[104:107], a[120:123]
    v_cvt_pk_bf16_f32 v95, v46, v47
    v_mfma_f32_16x16x32_bf16 a[124:127], a[188:191], v[108:111], a[124:127]
    ds_read_b64_tr_b16 a[174:175], v215 offset:20480
    v_mfma_f32_16x16x32_bf16 v[136:139], v[128:131], v[108:111], v[136:139]
    s_waitcnt lgkmcnt(3)
    v_mfma_f32_16x16x32_bf16 v[16:19], a[128:131], v[144:147], v[112:115]
    v_exp_f32 v48, v48
    v_mfma_f32_16x16x32_bf16 v[16:19], a[132:135], v[148:151], v[16:19]
    ds_read_b128 a[144:147], v208 offset:20480
    v_add_f32 v226, v226, v48
    v_mfma_f32_16x16x32_bf16 v[16:19], a[136:139], v[152:155], v[16:19]
    v_exp_f32 v49, v49
    v_mfma_f32_16x16x32_bf16 v[16:19], a[140:143], v[156:159], v[16:19]
    ds_read_b64_tr_b16 a[176:177], v216 offset:16384
    v_add_f32 v226, v226, v49
    v_mfma_f32_16x16x32_bf16 a[0:3], a[160:163], v[80:83], a[0:3]
    v_exp_f32 v50, v50
    v_mfma_f32_16x16x32_bf16 a[4:7], a[160:163], v[84:87], a[4:7]
    ds_read_b128 a[148:151], v209 offset:20480
    v_cvt_pk_bf16_f32 v96, v48, v49
    v_mfma_f32_16x16x32_bf16 a[8:11], a[160:163], v[88:91], a[8:11]
    v_exp_f32 v51, v51
    v_mfma_f32_16x16x32_bf16 a[12:15], a[160:163], v[92:95], a[12:15]
    ds_read_b64_tr_b16 a[178:179], v216 offset:20480
    v_add_f32 v226, v226, v50
    v_mfma_f32_16x16x32_bf16 v[20:23], a[128:131], v[160:163], v[116:119]
    v_exp_f32 v52, v52
    v_mfma_f32_16x16x32_bf16 v[20:23], a[132:135], v[164:167], v[20:23]
    v_exp_f32 v53, v53
    v_mfma_f32_16x16x32_bf16 v[20:23], a[136:139], v[168:171], v[20:23]
    v_add_f32 v226, v226, v51
    v_cvt_pk_bf16_f32 v97, v50, v51
    v_mfma_f32_16x16x32_bf16 v[20:23], a[140:143], v[172:175], v[20:23]
    ds_read_b64_tr_b16 a[180:181], v217 offset:16384
    v_cvt_pk_bf16_f32 v100, v52, v53
    v_mfma_f32_16x16x32_bf16 a[16:19], a[164:167], v[80:83], a[16:19]
    v_exp_f32 v54, v54
    v_mfma_f32_16x16x32_bf16 a[20:23], a[164:167], v[84:87], a[20:23]
    ds_read_b128 a[152:155], v210 offset:20480
    s_add_u32 m0, s25, 114688
    v_mfma_f32_16x16x32_bf16 a[24:27], a[164:167], v[88:91], a[24:27]
    buffer_load_dwordx4 v224, s[12:15], s24 offen lds
    v_add_f32 v227, v227, v52
    v_mfma_f32_16x16x32_bf16 a[28:31], a[164:167], v[92:95], a[28:31]
    ds_read_b64_tr_b16 a[182:183], v217 offset:20480
    v_add_f32 v227, v227, v53
    v_mfma_f32_16x16x32_bf16 v[24:27], a[128:131], v[176:179], v[120:123]
    v_exp_f32 v55, v55
    v_mfma_f32_16x16x32_bf16 v[24:27], a[132:135], v[180:183], v[24:27]
    v_exp_f32 v56, v56
    v_mfma_f32_16x16x32_bf16 v[24:27], a[136:139], v[184:187], v[24:27]
    v_exp_f32 v57, v57
    v_mfma_f32_16x16x32_bf16 v[24:27], a[140:143], v[188:191], v[24:27]
    ds_read_b64_tr_b16 a[184:185], v218 offset:16384
    s_waitcnt lgkmcnt(8)
    v_mfma_f32_16x16x32_bf16 a[32:35], a[168:171], v[80:83], a[32:35]
    v_exp_f32 v58, v58
    v_mfma_f32_16x16x32_bf16 a[36:39], a[168:171], v[84:87], a[36:39]
    ds_read_b128 a[156:159], v211 offset:20480
    v_cvt_pk_bf16_f32 v101, v54, v55
    v_mfma_f32_16x16x32_bf16 a[40:43], a[168:171], v[88:91], a[40:43]
    buffer_load_dwordx4 v225, s[12:15], s24 offen offset:1024 lds
    v_cvt_pk_bf16_f32 v104, v56, v57
    v_mfma_f32_16x16x32_bf16 a[44:47], a[168:171], v[92:95], a[44:47]
    ds_read_b64_tr_b16 a[186:187], v218 offset:20480
    v_add_f32 v227, v227, v54
    v_mfma_f32_16x16x32_bf16 v[28:31], a[128:131], v[192:195], v[124:127]
    v_exp_f32 v59, v59
    v_mfma_f32_16x16x32_bf16 v[28:31], a[132:135], v[196:199], v[28:31]
    v_exp_f32 v60, v60
    v_mfma_f32_16x16x32_bf16 v[28:31], a[136:139], v[200:203], v[28:31]
    v_exp_f32 v61, v61
    v_mfma_f32_16x16x32_bf16 v[28:31], a[140:143], v[204:207], v[28:31]
    ds_read_b64_tr_b16 a[188:189], v219 offset:16384
    v_cvt_pk_bf16_f32 v105, v58, v59
    v_mfma_f32_16x16x32_bf16 a[48:51], a[172:175], v[80:83], a[48:51]
    v_exp_f32 v62, v62
    v_mfma_f32_16x16x32_bf16 a[52:55], a[172:175], v[84:87], a[52:55]
    v_exp_f32 v63, v63
    v_mfma_f32_16x16x32_bf16 a[56:59], a[172:175], v[88:91], a[56:59]
    buffer_load_dwordx4 v224, s[12:15], s24 offen offset:2048 lds
    v_cvt_pk_bf16_f32 v108, v60, v61
    v_mfma_f32_16x16x32_bf16 a[60:63], a[172:175], v[92:95], a[60:63]
    ds_read_b64_tr_b16 a[190:191], v219 offset:20480
    v_cvt_pk_bf16_f32 v109, v62, v63
    v_mfma_f32_16x16x32_bf16 v[132:135], v[128:131], v[88:91], v[132:135]
    v_add_f32 v227, v227, v55
    s_waitcnt lgkmcnt(3)
    v_mfma_f32_16x16x32_bf16 v[32:35], a[144:147], v[144:147], v[112:115]
    v_exp_f32 v64, v64
    v_mfma_f32_16x16x32_bf16 v[32:35], a[148:151], v[148:151], v[32:35]
    ds_read_b128 a[128:131], v208 offset:24576
    v_add_f32 v226, v226, v64
    v_mfma_f32_16x16x32_bf16 v[32:35], a[152:155], v[152:155], v[32:35]
    v_exp_f32 v65, v65
    v_mfma_f32_16x16x32_bf16 v[32:35], a[156:159], v[156:159], v[32:35]
    ds_read_b64_tr_b16 a[160:161], v212 offset:24576
    v_cvt_pk_bf16_f32 v98, v64, v65
    v_mfma_f32_16x16x32_bf16 a[64:67], a[176:179], v[80:83], a[64:67]
    v_exp_f32 v66, v66
    v_mfma_f32_16x16x32_bf16 a[68:71], a[176:179], v[84:87], a[68:71]
    ds_read_b128 a[132:135], v209 offset:24576
    v_add_f32 v226, v226, v65
    v_mfma_f32_16x16x32_bf16 a[72:75], a[176:179], v[88:91], a[72:75]
    buffer_load_dwordx4 v225, s[12:15], s24 offen offset:3072 lds
    v_add_f32 v226, v226, v66
    v_mfma_f32_16x16x32_bf16 a[76:79], a[176:179], v[92:95], a[76:79]
    ds_read_b64_tr_b16 a[162:163], v212 offset:28672
    v_mfma_f32_16x16x32_bf16 v[36:39], a[144:147], v[160:163], v[116:119]
    v_exp_f32 v67, v67
    v_mfma_f32_16x16x32_bf16 v[36:39], a[148:151], v[164:167], v[36:39]
    s_waitcnt lgkmcnt(0)
    s_and_b32 s41, s41, 0xffff
    s_sub_u32 s42, s42, 4194304
    s_subb_u32 s43, s43, 0
    s_and_b32 s43, s43, 0xffff
    s_cmp_lt_u32 s59, 4096
    s_cselect_b32 s44, s40, s42
    s_cselect_b32 s45, s41, s43
    s_mov_b32 s46, 6029312
    s_cselect_b32 s46, 4194304, s46
    s_mov_b32 s47, 0x20000
    s_lshl_b32 s59, s59, 10
    s_cmp_lt_u32 s58, 1536
    s_cselect_b32 s59, s59, 0xf0000000
    v_mfma_f32_16x16x32_bf16 v[36:39], a[152:155], v[168:171], v[36:39]
    v_exp_f32 v68, v68
    v_mfma_f32_16x16x32_bf16 v[36:39], a[156:159], v[172:175], v[36:39]
    ds_read_b64_tr_b16 a[164:165], v213 offset:24576
    v_cvt_pk_bf16_f32 v99, v66, v67
    v_mfma_f32_16x16x32_bf16 a[80:83], a[180:183], v[80:83], a[80:83]
    v_exp_f32 v69, v69
    v_mfma_f32_16x16x32_bf16 a[84:87], a[180:183], v[84:87], a[84:87]
    ds_read_b128 a[136:139], v210 offset:24576
    v_cvt_pk_bf16_f32 v102, v68, v69
    v_mfma_f32_16x16x32_bf16 a[88:91], a[180:183], v[88:91], a[88:91]
    v_exp_f32 v70, v70
    v_mfma_f32_16x16x32_bf16 a[92:95], a[180:183], v[92:95], a[92:95]
    ds_read_b64_tr_b16 a[166:167], v213 offset:28672
    s_add_u32 s24, s24, 16384
    v_mfma_f32_16x16x32_bf16 v[40:43], a[144:147], v[176:179], v[120:123]
    v_exp_f32 v71, v71
    v_mfma_f32_16x16x32_bf16 v[40:43], a[148:151], v[180:183], v[40:43]
    v_exp_f32 v72, v72
    v_mfma_f32_16x16x32_bf16 v[40:43], a[152:155], v[184:187], v[40:43]
    buffer_load_dword v240, v242, s[44:47], s59 offen
    v_cvt_pk_bf16_f32 v103, v70, v71
    v_mfma_f32_16x16x32_bf16 v[40:43], a[156:159], v[188:191], v[40:43]
    ds_read_b64_tr_b16 a[168:169], v214 offset:24576
    v_mfma_f32_16x16x32_bf16 a[96:99], a[184:187], v[80:83], a[96:99]
    v_exp_f32 v73, v73
    v_mfma_f32_16x16x32_bf16 a[100:103], a[184:187], v[84:87], a[100:103]
    ds_read_b128 a[140:143], v211 offset:24576
    v_cvt_pk_bf16_f32 v106, v72, v73
    v_mfma_f32_16x16x32_bf16 a[104:107], a[184:187], v[88:91], a[104:107]
    buffer_load_dword v241, v243, s[44:47], s59 offen
    v_add_f32 v226, v226, v67
    v_mfma_f32_16x16x32_bf16 a[108:111], a[184:187], v[92:95], a[108:111]
    ds_read_b64_tr_b16 a[170:171], v214 offset:28672
    v_add_f32 v227, v227, v68
    v_mfma_f32_16x16x32_bf16 v[44:47], a[144:147], v[192:195], v[124:127]
    v_exp_f32 v74, v74
    v_mfma_f32_16x16x32_bf16 v[44:47], a[148:151], v[196:199], v[44:47]
    v_exp_f32 v75, v75
    v_mfma_f32_16x16x32_bf16 v[44:47], a[152:155], v[200:203], v[44:47]
    v_exp_f32 v76, v76
    v_mfma_f32_16x16x32_bf16 v[44:47], a[156:159], v[204:207], v[44:47]
    ds_read_b64_tr_b16 a[172:173], v215 offset:24576
    v_cvt_pk_bf16_f32 v107, v74, v75
    v_mfma_f32_16x16x32_bf16 a[112:115], a[188:191], v[80:83], a[112:115]
    v_exp_f32 v77, v77
    v_mfma_f32_16x16x32_bf16 a[116:119], a[188:191], v[84:87], a[116:119]
    v_exp_f32 v78, v78
    v_mfma_f32_16x16x32_bf16 a[120:123], a[188:191], v[88:91], a[120:123]
    v_exp_f32 v79, v79
    v_mfma_f32_16x16x32_bf16 a[124:127], a[188:191], v[92:95], a[124:127]
    ds_read_b64_tr_b16 a[174:175], v215 offset:28672
    v_cvt_pk_bf16_f32 v110, v76, v77
    v_mfma_f32_16x16x32_bf16 v[136:139], v[128:131], v[92:95], v[136:139]
    v_cvt_pk_bf16_f32 v111, v78, v79
    v_add_f32 v227, v227, v69
    s_waitcnt lgkmcnt(3)
    v_mfma_f32_16x16x32_bf16 v[48:51], a[128:131], v[144:147], v[112:115]
    v_exp_f32 v16, v16
    v_mfma_f32_16x16x32_bf16 v[48:51], a[132:135], v[148:151], v[48:51]
    ds_read_b128 a[144:147], v208 offset:28672
    v_add_f32 v227, v227, v70
    v_mfma_f32_16x16x32_bf16 v[48:51], a[136:139], v[152:155], v[48:51]
    v_exp_f32 v17, v17
    v_mfma_f32_16x16x32_bf16 v[48:51], a[140:143], v[156:159], v[48:51]
    ds_read_b64_tr_b16 a[176:177], v216 offset:24576
    v_add_f32 v227, v227, v71
    v_mfma_f32_16x16x32_bf16 a[0:3], a[160:163], v[96:99], a[0:3]
    v_exp_f32 v18, v18
    v_mfma_f32_16x16x32_bf16 a[4:7], a[160:163], v[100:103], a[4:7]
    ds_read_b128 a[148:151], v209 offset:28672
    v_add_f32 v226, v226, v16
    v_mfma_f32_16x16x32_bf16 a[8:11], a[160:163], v[104:107], a[8:11]
    v_exp_f32 v19, v19
    v_mfma_f32_16x16x32_bf16 a[12:15], a[160:163], v[108:111], a[12:15]
    ds_read_b64_tr_b16 a[178:179], v216 offset:28672
    v_add_f32 v226, v226, v17
    v_mfma_f32_16x16x32_bf16 v[52:55], a[128:131], v[160:163], v[116:119]
    v_exp_f32 v20, v20
    v_mfma_f32_16x16x32_bf16 v[52:55], a[132:135], v[164:167], v[52:55]
    v_exp_f32 v21, v21
    v_mfma_f32_16x16x32_bf16 v[52:55], a[136:139], v[168:171], v[52:55]
    v_cvt_pk_bf16_f32 v80, v16, v17
    v_add_f32 v226, v226, v18
    v_mfma_f32_16x16x32_bf16 v[52:55], a[140:143], v[172:175], v[52:55]
    ds_read_b64_tr_b16 a[180:181], v217 offset:24576
    v_add_f32 v226, v226, v19
    v_mfma_f32_16x16x32_bf16 a[16:19], a[164:167], v[96:99], a[16:19]
    v_exp_f32 v22, v22
    v_mfma_f32_16x16x32_bf16 a[20:23], a[164:167], v[100:103], a[20:23]
    ds_read_b128 a[152:155], v210 offset:28672
    v_cvt_pk_bf16_f32 v81, v18, v19
    v_mfma_f32_16x16x32_bf16 a[24:27], a[164:167], v[104:107], a[24:27]
    v_exp_f32 v23, v23
    v_mfma_f32_16x16x32_bf16 a[28:31], a[164:167], v[108:111], a[28:31]
    ds_read_b64_tr_b16 a[182:183], v217 offset:28672
    v_cvt_pk_bf16_f32 v84, v20, v21
    v_mfma_f32_16x16x32_bf16 v[56:59], a[128:131], v[176:179], v[120:123]
    v_exp_f32 v24, v24
    v_mfma_f32_16x16x32_bf16 v[56:59], a[132:135], v[180:183], v[56:59]
    v_exp_f32 v25, v25
    v_mfma_f32_16x16x32_bf16 v[56:59], a[136:139], v[184:187], v[56:59]
    v_cvt_pk_bf16_f32 v85, v22, v23
    v_cvt_pk_bf16_f32 v88, v24, v25
    v_mfma_f32_16x16x32_bf16 v[56:59], a[140:143], v[188:191], v[56:59]
    ds_read_b64_tr_b16 a[184:185], v218 offset:24576
    s_waitcnt lgkmcnt(8)
    v_mfma_f32_16x16x32_bf16 a[32:35], a[168:171], v[96:99], a[32:35]
    v_exp_f32 v26, v26
    v_mfma_f32_16x16x32_bf16 a[36:39], a[168:171], v[100:103], a[36:39]
    ds_read_b128 a[156:159], v211 offset:28672
    v_add_f32 v227, v227, v20
    v_mfma_f32_16x16x32_bf16 a[40:43], a[168:171], v[104:107], a[40:43]
    v_exp_f32 v27, v27
    v_mfma_f32_16x16x32_bf16 a[44:47], a[168:171], v[108:111], a[44:47]
    ds_read_b64_tr_b16 a[186:187], v218 offset:28672
    v_cvt_pk_bf16_f32 v89, v26, v27
    v_mfma_f32_16x16x32_bf16 v[60:63], a[128:131], v[192:195], v[124:127]
    v_exp_f32 v28, v28
    v_mfma_f32_16x16x32_bf16 v[60:63], a[132:135], v[196:199], v[60:63]
    v_exp_f32 v29, v29
    v_mfma_f32_16x16x32_bf16 v[60:63], a[136:139], v[200:203], v[60:63]
    v_cvt_pk_bf16_f32 v92, v28, v29
    v_add_f32 v227, v227, v21
    v_mfma_f32_16x16x32_bf16 v[60:63], a[140:143], v[204:207], v[60:63]
    ds_read_b64_tr_b16 a[188:189], v219 offset:24576
    v_add_f32 v227, v227, v22
    v_mfma_f32_16x16x32_bf16 a[48:51], a[172:175], v[96:99], a[48:51]
    v_exp_f32 v30, v30
    v_mfma_f32_16x16x32_bf16 a[52:55], a[172:175], v[100:103], a[52:55]
    v_exp_f32 v31, v31
    v_mfma_f32_16x16x32_bf16 a[56:59], a[172:175], v[104:107], a[56:59]
    v_cvt_pk_bf16_f32 v93, v30, v31
    v_add_f32 v227, v227, v23
    v_mfma_f32_16x16x32_bf16 a[60:63], a[172:175], v[108:111], a[60:63]
    ds_read_b64_tr_b16 a[190:191], v219 offset:28672
    v_mfma_f32_16x16x32_bf16 v[132:135], v[128:131], v[104:107], v[132:135]
    s_waitcnt vmcnt(6) lgkmcnt(3)
    s_barrier
    v_mfma_f32_16x16x32_bf16 v[64:67], a[144:147], v[144:147], v[112:115]
    v_exp_f32 v32, v32
    v_mfma_f32_16x16x32_bf16 v[64:67], a[148:151], v[148:151], v[64:67]
    ds_read_b128 a[128:131], v208 offset:32768
    v_add_f32 v226, v226, v32
    v_mfma_f32_16x16x32_bf16 v[64:67], a[152:155], v[152:155], v[64:67]
    v_exp_f32 v33, v33
    v_mfma_f32_16x16x32_bf16 v[64:67], a[156:159], v[156:159], v[64:67]
    ds_read_b64_tr_b16 a[160:161], v212 offset:32768
    v_cvt_pk_bf16_f32 v82, v32, v33
    v_mfma_f32_16x16x32_bf16 a[64:67], a[176:179], v[96:99], a[64:67]
    v_exp_f32 v34, v34
    v_mfma_f32_16x16x32_bf16 a[68:71], a[176:179], v[100:103], a[68:71]
    ds_read_b128 a[132:135], v209 offset:32768
    v_add_f32 v226, v226, v33
    v_mfma_f32_16x16x32_bf16 a[72:75], a[176:179], v[104:107], a[72:75]
    v_exp_f32 v35, v35
    v_mfma_f32_16x16x32_bf16 a[76:79], a[176:179], v[108:111], a[76:79]
    ds_read_b64_tr_b16 a[162:163], v212 offset:36864
    v_cvt_pk_bf16_f32 v83, v34, v35
    v_mfma_f32_16x16x32_bf16 v[68:71], a[144:147], v[160:163], v[116:119]
    v_exp_f32 v36, v36
    v_mfma_f32_16x16x32_bf16 v[68:71], a[148:151], v[164:167], v[68:71]
    v_exp_f32 v37, v37
    v_mfma_f32_16x16x32_bf16 v[68:71], a[152:155], v[168:171], v[68:71]
    v_cvt_pk_bf16_f32 v86, v36, v37
    v_add_f32 v226, v226, v34
    v_mfma_f32_16x16x32_bf16 v[68:71], a[156:159], v[172:175], v[68:71]
    ds_read_b64_tr_b16 a[164:165], v213 offset:32768
    v_add_f32 v226, v226, v35
    v_mfma_f32_16x16x32_bf16 a[80:83], a[180:183], v[96:99], a[80:83]
    v_exp_f32 v38, v38
    v_mfma_f32_16x16x32_bf16 a[84:87], a[180:183], v[100:103], a[84:87]
    ds_read_b128 a[136:139], v210 offset:32768
    v_add_f32 v227, v227, v36
    v_mfma_f32_16x16x32_bf16 a[88:91], a[180:183], v[104:107], a[88:91]
    v_exp_f32 v39, v39
    v_mfma_f32_16x16x32_bf16 a[92:95], a[180:183], v[108:111], a[92:95]
    ds_read_b64_tr_b16 a[166:167], v213 offset:36864
    v_cvt_pk_bf16_f32 v87, v38, v39
    v_mfma_f32_16x16x32_bf16 v[72:75], a[144:147], v[176:179], v[120:123]
    v_exp_f32 v40, v40
    v_mfma_f32_16x16x32_bf16 v[72:75], a[148:151], v[180:183], v[72:75]
    v_exp_f32 v41, v41
    v_mfma_f32_16x16x32_bf16 v[72:75], a[152:155], v[184:187], v[72:75]
    v_cvt_pk_bf16_f32 v90, v40, v41
    v_add_f32 v227, v227, v37
    v_mfma_f32_16x16x32_bf16 v[72:75], a[156:159], v[188:191], v[72:75]
    ds_read_b64_tr_b16 a[168:169], v214 offset:32768
    s_waitcnt lgkmcnt(8)
    v_mfma_f32_16x16x32_bf16 a[96:99], a[184:187], v[96:99], a[96:99]
    v_exp_f32 v42, v42
    v_mfma_f32_16x16x32_bf16 a[100:103], a[184:187], v[100:103], a[100:103]
    ds_read_b128 a[140:143], v211 offset:32768
    v_add_f32 v227, v227, v38
    v_mfma_f32_16x16x32_bf16 a[104:107], a[184:187], v[104:107], a[104:107]
    v_exp_f32 v43, v43
    v_mfma_f32_16x16x32_bf16 a[108:111], a[184:187], v[108:111], a[108:111]
    ds_read_b64_tr_b16 a[170:171], v214 offset:36864
    v_cvt_pk_bf16_f32 v91, v42, v43
    v_mfma_f32_16x16x32_bf16 v[76:79], a[144:147], v[192:195], v[124:127]
    v_exp_f32 v44, v44
    v_mfma_f32_16x16x32_bf16 v[76:79], a[148:151], v[196:199], v[76:79]
    v_exp_f32 v45, v45
    v_mfma_f32_16x16x32_bf16 v[76:79], a[152:155], v[200:203], v[76:79]
    v_cvt_pk_bf16_f32 v94, v44, v45
    v_add_f32 v227, v227, v39
    v_mfma_f32_16x16x32_bf16 v[76:79], a[156:159], v[204:207], v[76:79]
    ds_read_b64_tr_b16 a[172:173], v215 offset:32768
    v_mfma_f32_16x16x32_bf16 a[112:115], a[188:191], v[96:99], a[112:115]
    v_exp_f32 v46, v46
    v_mfma_f32_16x16x32_bf16 a[116:119], a[188:191], v[100:103], a[116:119]
    v_exp_f32 v47, v47
    v_mfma_f32_16x16x32_bf16 a[120:123], a[188:191], v[104:107], a[120:123]
    v_cvt_pk_bf16_f32 v95, v46, v47
    v_mfma_f32_16x16x32_bf16 a[124:127], a[188:191], v[108:111], a[124:127]
    ds_read_b64_tr_b16 a[174:175], v215 offset:36864
    v_mfma_f32_16x16x32_bf16 v[136:139], v[128:131], v[108:111], v[136:139]
    s_waitcnt lgkmcnt(3)
    v_mfma_f32_16x16x32_bf16 v[16:19], a[128:131], v[144:147], v[112:115]
    v_exp_f32 v48, v48
    v_mfma_f32_16x16x32_bf16 v[16:19], a[132:135], v[148:151], v[16:19]
    ds_read_b128 a[144:147], v208 offset:36864
    v_add_f32 v226, v226, v48
    v_mfma_f32_16x16x32_bf16 v[16:19], a[136:139], v[152:155], v[16:19]
    v_exp_f32 v49, v49
    v_mfma_f32_16x16x32_bf16 v[16:19], a[140:143], v[156:159], v[16:19]
    ds_read_b64_tr_b16 a[176:177], v216 offset:32768
    v_add_f32 v226, v226, v49
    v_mfma_f32_16x16x32_bf16 a[0:3], a[160:163], v[80:83], a[0:3]
    v_exp_f32 v50, v50
    v_mfma_f32_16x16x32_bf16 a[4:7], a[160:163], v[84:87], a[4:7]
    ds_read_b128 a[148:151], v209 offset:36864
    v_cvt_pk_bf16_f32 v96, v48, v49
    v_mfma_f32_16x16x32_bf16 a[8:11], a[160:163], v[88:91], a[8:11]
    v_exp_f32 v51, v51
    v_mfma_f32_16x16x32_bf16 a[12:15], a[160:163], v[92:95], a[12:15]
    ds_read_b64_tr_b16 a[178:179], v216 offset:36864
    v_add_f32 v226, v226, v50
    v_mfma_f32_16x16x32_bf16 v[20:23], a[128:131], v[160:163], v[116:119]
    v_exp_f32 v52, v52
    v_mfma_f32_16x16x32_bf16 v[20:23], a[132:135], v[164:167], v[20:23]
    v_exp_f32 v53, v53
    v_mfma_f32_16x16x32_bf16 v[20:23], a[136:139], v[168:171], v[20:23]
    v_add_f32 v226, v226, v51
    v_cvt_pk_bf16_f32 v97, v50, v51
    v_mfma_f32_16x16x32_bf16 v[20:23], a[140:143], v[172:175], v[20:23]
    ds_read_b64_tr_b16 a[180:181], v217 offset:32768
    v_cvt_pk_bf16_f32 v100, v52, v53
    v_mfma_f32_16x16x32_bf16 a[16:19], a[164:167], v[80:83], a[16:19]
    v_exp_f32 v54, v54
    v_mfma_f32_16x16x32_bf16 a[20:23], a[164:167], v[84:87], a[20:23]
    ds_read_b128 a[152:155], v210 offset:36864
    v_add_f32 v227, v227, v52
    v_mfma_f32_16x16x32_bf16 a[24:27], a[164:167], v[88:91], a[24:27]
    v_exp_f32 v55, v55
    v_mfma_f32_16x16x32_bf16 a[28:31], a[164:167], v[92:95], a[28:31]
    ds_read_b64_tr_b16 a[182:183], v217 offset:36864
    v_cvt_pk_bf16_f32 v101, v54, v55
    v_mfma_f32_16x16x32_bf16 v[24:27], a[128:131], v[176:179], v[120:123]
    v_exp_f32 v56, v56
    v_mfma_f32_16x16x32_bf16 v[24:27], a[132:135], v[180:183], v[24:27]
    v_exp_f32 v57, v57
    v_mfma_f32_16x16x32_bf16 v[24:27], a[136:139], v[184:187], v[24:27]
    v_cvt_pk_bf16_f32 v104, v56, v57
    v_add_f32 v227, v227, v53
    v_mfma_f32_16x16x32_bf16 v[24:27], a[140:143], v[188:191], v[24:27]
    ds_read_b64_tr_b16 a[184:185], v218 offset:32768
    s_waitcnt lgkmcnt(8)
    v_mfma_f32_16x16x32_bf16 a[32:35], a[168:171], v[80:83], a[32:35]
    v_exp_f32 v58, v58
    v_mfma_f32_16x16x32_bf16 a[36:39], a[168:171], v[84:87], a[36:39]
    ds_read_b128 a[156:159], v211 offset:36864
    v_add_f32 v227, v227, v54
    v_mfma_f32_16x16x32_bf16 a[40:43], a[168:171], v[88:91], a[40:43]
    v_exp_f32 v59, v59
    v_mfma_f32_16x16x32_bf16 a[44:47], a[168:171], v[92:95], a[44:47]
    ds_read_b64_tr_b16 a[186:187], v218 offset:36864
    v_cvt_pk_bf16_f32 v105, v58, v59
    v_mfma_f32_16x16x32_bf16 v[28:31], a[128:131], v[192:195], v[124:127]
    v_exp_f32 v60, v60
    v_mfma_f32_16x16x32_bf16 v[28:31], a[132:135], v[196:199], v[28:31]
    v_exp_f32 v61, v61
    v_mfma_f32_16x16x32_bf16 v[28:31], a[136:139], v[200:203], v[28:31]
    v_cvt_pk_bf16_f32 v108, v60, v61
    v_add_f32 v227, v227, v55
    v_mfma_f32_16x16x32_bf16 v[28:31], a[140:143], v[204:207], v[28:31]
    ds_read_b64_tr_b16 a[188:189], v219 offset:32768
    v_mfma_f32_16x16x32_bf16 a[48:51], a[172:175], v[80:83], a[48:51]
    v_exp_f32 v62, v62
    v_mfma_f32_16x16x32_bf16 a[52:55], a[172:175], v[84:87], a[52:55]
    v_exp_f32 v63, v63
    v_mfma_f32_16x16x32_bf16 a[56:59], a[172:175], v[88:91], a[56:59]
    v_cvt_pk_bf16_f32 v109, v62, v63
    v_mfma_f32_16x16x32_bf16 a[60:63], a[172:175], v[92:95], a[60:63]
    ds_read_b64_tr_b16 a[190:191], v219 offset:36864
    v_mfma_f32_16x16x32_bf16 v[132:135], v[128:131], v[88:91], v[132:135]
    s_waitcnt lgkmcnt(3)
    v_mfma_f32_16x16x32_bf16 v[32:35], a[144:147], v[144:147], v[112:115]
    v_exp_f32 v64, v64
    v_mfma_f32_16x16x32_bf16 v[32:35], a[148:151], v[148:151], v[32:35]
    ds_read_b128 a[128:131], v208 offset:40960
    v_add_f32 v226, v226, v64
    v_mfma_f32_16x16x32_bf16 v[32:35], a[152:155], v[152:155], v[32:35]
    v_exp_f32 v65, v65
    v_mfma_f32_16x16x32_bf16 v[32:35], a[156:159], v[156:159], v[32:35]
    ds_read_b64_tr_b16 a[160:161], v212 offset:40960
    v_cvt_pk_bf16_f32 v98, v64, v65
    v_mfma_f32_16x16x32_bf16 a[64:67], a[176:179], v[80:83], a[64:67]
    v_exp_f32 v66, v66
    v_mfma_f32_16x16x32_bf16 a[68:71], a[176:179], v[84:87], a[68:71]
    ds_read_b128 a[132:135], v209 offset:40960
    v_add_f32 v226, v226, v65
    v_mfma_f32_16x16x32_bf16 a[72:75], a[176:179], v[88:91], a[72:75]
    v_exp_f32 v67, v67
    v_mfma_f32_16x16x32_bf16 a[76:79], a[176:179], v[92:95], a[76:79]
    ds_read_b64_tr_b16 a[162:163], v212 offset:45056
    v_cvt_pk_bf16_f32 v99, v66, v67
    v_mfma_f32_16x16x32_bf16 v[36:39], a[144:147], v[160:163], v[116:119]
    v_exp_f32 v68, v68
    v_mfma_f32_16x16x32_bf16 v[36:39], a[148:151], v[164:167], v[36:39]
    v_exp_f32 v69, v69
    v_mfma_f32_16x16x32_bf16 v[36:39], a[152:155], v[168:171], v[36:39]
    v_cvt_pk_bf16_f32 v102, v68, v69
    v_add_f32 v226, v226, v66
    v_mfma_f32_16x16x32_bf16 v[36:39], a[156:159], v[172:175], v[36:39]
    ds_read_b64_tr_b16 a[164:165], v213 offset:40960
    v_add_f32 v226, v226, v67
    v_mfma_f32_16x16x32_bf16 a[80:83], a[180:183], v[80:83], a[80:83]
    v_exp_f32 v70, v70
    v_mfma_f32_16x16x32_bf16 a[84:87], a[180:183], v[84:87], a[84:87]
    ds_read_b128 a[136:139], v210 offset:40960
    v_add_f32 v227, v227, v68
    v_mfma_f32_16x16x32_bf16 a[88:91], a[180:183], v[88:91], a[88:91]
    v_exp_f32 v71, v71
    v_mfma_f32_16x16x32_bf16 a[92:95], a[180:183], v[92:95], a[92:95]
    ds_read_b64_tr_b16 a[166:167], v213 offset:45056
    v_cvt_pk_bf16_f32 v103, v70, v71
    v_mfma_f32_16x16x32_bf16 v[40:43], a[144:147], v[176:179], v[120:123]
    v_exp_f32 v72, v72
    v_mfma_f32_16x16x32_bf16 v[40:43], a[148:151], v[180:183], v[40:43]
    v_exp_f32 v73, v73
    v_mfma_f32_16x16x32_bf16 v[40:43], a[152:155], v[184:187], v[40:43]
    v_cvt_pk_bf16_f32 v106, v72, v73
    v_add_f32 v227, v227, v69
    v_mfma_f32_16x16x32_bf16 v[40:43], a[156:159], v[188:191], v[40:43]
    ds_read_b64_tr_b16 a[168:169], v214 offset:40960
    s_waitcnt lgkmcnt(8)
    v_mfma_f32_16x16x32_bf16 a[96:99], a[184:187], v[80:83], a[96:99]
    v_exp_f32 v74, v74
    v_mfma_f32_16x16x32_bf16 a[100:103], a[184:187], v[84:87], a[100:103]
    ds_read_b128 a[140:143], v211 offset:40960
    v_add_f32 v227, v227, v70
    v_mfma_f32_16x16x32_bf16 a[104:107], a[184:187], v[88:91], a[104:107]
    v_exp_f32 v75, v75
    v_mfma_f32_16x16x32_bf16 a[108:111], a[184:187], v[92:95], a[108:111]
    ds_read_b64_tr_b16 a[170:171], v214 offset:45056
    v_cvt_pk_bf16_f32 v107, v74, v75
    v_mfma_f32_16x16x32_bf16 v[44:47], a[144:147], v[192:195], v[124:127]
    v_exp_f32 v76, v76
    v_mfma_f32_16x16x32_bf16 v[44:47], a[148:151], v[196:199], v[44:47]
    v_exp_f32 v77, v77
    v_mfma_f32_16x16x32_bf16 v[44:47], a[152:155], v[200:203], v[44:47]
    v_cvt_pk_bf16_f32 v110, v76, v77
    v_add_f32 v227, v227, v71
    v_mfma_f32_16x16x32_bf16 v[44:47], a[156:159], v[204:207], v[44:47]
    ds_read_b64_tr_b16 a[172:173], v215 offset:40960
    v_mfma_f32_16x16x32_bf16 a[112:115], a[188:191], v[80:83], a[112:115]
    v_exp_f32 v78, v78
    v_mfma_f32_16x16x32_bf16 a[116:119], a[188:191], v[84:87], a[116:119]
    v_exp_f32 v79, v79
    v_mfma_f32_16x16x32_bf16 a[120:123], a[188:191], v[88:91], a[120:123]
    v_cvt_pk_bf16_f32 v111, v78, v79
    v_mfma_f32_16x16x32_bf16 a[124:127], a[188:191], v[92:95], a[124:127]
    ds_read_b64_tr_b16 a[174:175], v215 offset:45056
    v_mfma_f32_16x16x32_bf16 v[136:139], v[128:131], v[92:95], v[136:139]
    s_waitcnt lgkmcnt(3)
    v_mfma_f32_16x16x32_bf16 v[48:51], a[128:131], v[144:147], v[112:115]
    v_exp_f32 v16, v16
    v_mfma_f32_16x16x32_bf16 v[48:51], a[132:135], v[148:151], v[48:51]
    ds_read_b128 a[144:147], v208 offset:45056
    v_add_f32 v226, v226, v16
    v_mfma_f32_16x16x32_bf16 v[48:51], a[136:139], v[152:155], v[48:51]
    v_exp_f32 v17, v17
    v_mfma_f32_16x16x32_bf16 v[48:51], a[140:143], v[156:159], v[48:51]
    ds_read_b64_tr_b16 a[176:177], v216 offset:40960
    v_add_f32 v226, v226, v17
    v_mfma_f32_16x16x32_bf16 a[0:3], a[160:163], v[96:99], a[0:3]
    v_exp_f32 v18, v18
    v_mfma_f32_16x16x32_bf16 a[4:7], a[160:163], v[100:103], a[4:7]
    ds_read_b128 a[148:151], v209 offset:45056
    v_cvt_pk_bf16_f32 v80, v16, v17
    v_mfma_f32_16x16x32_bf16 a[8:11], a[160:163], v[104:107], a[8:11]
    v_exp_f32 v19, v19
    v_mfma_f32_16x16x32_bf16 a[12:15], a[160:163], v[108:111], a[12:15]
    ds_read_b64_tr_b16 a[178:179], v216 offset:45056
    v_add_f32 v226, v226, v18
    v_mfma_f32_16x16x32_bf16 v[52:55], a[128:131], v[160:163], v[116:119]
    v_exp_f32 v20, v20
    v_mfma_f32_16x16x32_bf16 v[52:55], a[132:135], v[164:167], v[52:55]
    v_exp_f32 v21, v21
    v_mfma_f32_16x16x32_bf16 v[52:55], a[136:139], v[168:171], v[52:55]
    v_add_f32 v226, v226, v19
    v_cvt_pk_bf16_f32 v81, v18, v19
    v_mfma_f32_16x16x32_bf16 v[52:55], a[140:143], v[172:175], v[52:55]
    ds_read_b64_tr_b16 a[180:181], v217 offset:40960
    v_cvt_pk_bf16_f32 v84, v20, v21
    v_mfma_f32_16x16x32_bf16 a[16:19], a[164:167], v[96:99], a[16:19]
    v_exp_f32 v22, v22
    v_mfma_f32_16x16x32_bf16 a[20:23], a[164:167], v[100:103], a[20:23]
    ds_read_b128 a[152:155], v210 offset:45056
    v_add_f32 v227, v227, v20
    v_mfma_f32_16x16x32_bf16 a[24:27], a[164:167], v[104:107], a[24:27]
    v_exp_f32 v23, v23
    v_mfma_f32_16x16x32_bf16 a[28:31], a[164:167], v[108:111], a[28:31]
    ds_read_b64_tr_b16 a[182:183], v217 offset:45056
    v_cvt_pk_bf16_f32 v85, v22, v23
    v_mfma_f32_16x16x32_bf16 v[56:59], a[128:131], v[176:179], v[120:123]
    v_exp_f32 v24, v24
    v_mfma_f32_16x16x32_bf16 v[56:59], a[132:135], v[180:183], v[56:59]
    v_exp_f32 v25, v25
    v_mfma_f32_16x16x32_bf16 v[56:59], a[136:139], v[184:187], v[56:59]
    v_cvt_pk_bf16_f32 v88, v24, v25
    v_add_f32 v227, v227, v21
    v_mfma_f32_16x16x32_bf16 v[56:59], a[140:143], v[188:191], v[56:59]
    ds_read_b64_tr_b16 a[184:185], v218 offset:40960
    s_waitcnt lgkmcnt(8)
    v_mfma_f32_16x16x32_bf16 a[32:35], a[168:171], v[96:99], a[32:35]
    v_exp_f32 v26, v26
    v_mfma_f32_16x16x32_bf16 a[36:39], a[168:171], v[100:103], a[36:39]
    ds_read_b128 a[156:159], v211 offset:45056
    v_add_f32 v227, v227, v22
    v_mfma_f32_16x16x32_bf16 a[40:43], a[168:171], v[104:107], a[40:43]
    v_exp_f32 v27, v27
    v_mfma_f32_16x16x32_bf16 a[44:47], a[168:171], v[108:111], a[44:47]
    ds_read_b64_tr_b16 a[186:187], v218 offset:45056
    v_cvt_pk_bf16_f32 v89, v26, v27
    v_mfma_f32_16x16x32_bf16 v[60:63], a[128:131], v[192:195], v[124:127]
    v_exp_f32 v28, v28
    v_mfma_f32_16x16x32_bf16 v[60:63], a[132:135], v[196:199], v[60:63]
    v_exp_f32 v29, v29
    v_mfma_f32_16x16x32_bf16 v[60:63], a[136:139], v[200:203], v[60:63]
    v_cvt_pk_bf16_f32 v92, v28, v29
    v_add_f32 v227, v227, v23
    v_mfma_f32_16x16x32_bf16 v[60:63], a[140:143], v[204:207], v[60:63]
    ds_read_b64_tr_b16 a[188:189], v219 offset:40960
    v_mfma_f32_16x16x32_bf16 a[48:51], a[172:175], v[96:99], a[48:51]
    v_exp_f32 v30, v30
    v_mfma_f32_16x16x32_bf16 a[52:55], a[172:175], v[100:103], a[52:55]
    v_exp_f32 v31, v31
    v_mfma_f32_16x16x32_bf16 a[56:59], a[172:175], v[104:107], a[56:59]
    v_cvt_pk_bf16_f32 v93, v30, v31
    v_mfma_f32_16x16x32_bf16 a[60:63], a[172:175], v[108:111], a[60:63]
    ds_read_b64_tr_b16 a[190:191], v219 offset:45056
    v_mfma_f32_16x16x32_bf16 v[132:135], v[128:131], v[104:107], v[132:135]
    s_waitcnt vmcnt(2) lgkmcnt(3)
    s_barrier
    v_mfma_f32_16x16x32_bf16 v[64:67], a[144:147], v[144:147], v[112:115]
    v_exp_f32 v32, v32
    v_mfma_f32_16x16x32_bf16 v[64:67], a[148:151], v[148:151], v[64:67]
    v_exp_f32 v33, v33
    v_mfma_f32_16x16x32_bf16 v[64:67], a[152:155], v[152:155], v[64:67]
    v_exp_f32 v34, v34
    v_mfma_f32_16x16x32_bf16 v[64:67], a[156:159], v[156:159], v[64:67]
    ds_read_b64_tr_b16 a[160:161], v212 offset:49152
    v_cvt_pk_bf16_f32 v82, v32, v33
    v_mfma_f32_16x16x32_bf16 a[64:67], a[176:179], v[96:99], a[64:67]
    v_exp_f32 v35, v35
    v_mfma_f32_16x16x32_bf16 a[68:71], a[176:179], v[100:103], a[68:71]
    v_cvt_pk_bf16_f32 v83, v34, v35
    v_add_f32 v226, v226, v32
    v_mfma_f32_16x16x32_bf16 a[72:75], a[176:179], v[104:107], a[72:75]
    v_exp_f32 v36, v36
    v_mfma_f32_16x16x32_bf16 a[76:79], a[176:179], v[108:111], a[76:79]
    ds_read_b64_tr_b16 a[162:163], v212 offset:53248
    v_add_f32 v226, v226, v33
    v_mfma_f32_16x16x32_bf16 v[68:71], a[144:147], v[160:163], v[116:119]
    v_add_f32 v226, v226, v34
    v_add_f32 v226, v226, v35
    v_mfma_f32_16x16x32_bf16 v[68:71], a[148:151], v[164:167], v[68:71]
    v_exp_f32 v37, v37
    v_mfma_f32_16x16x32_bf16 v[68:71], a[152:155], v[168:171], v[68:71]
    v_cvt_pk_bf16_f32 v86, v36, v37
    v_add_f32 v227, v227, v36
    v_mfma_f32_16x16x32_bf16 v[68:71], a[156:159], v[172:175], v[68:71]
    ds_read_b64_tr_b16 a[164:165], v213 offset:49152
    v_add_f32 v227, v227, v37
    v_mfma_f32_16x16x32_bf16 a[80:83], a[180:183], v[96:99], a[80:83]
    v_exp_f32 v38, v38
    v_mfma_f32_16x16x32_bf16 a[84:87], a[180:183], v[100:103], a[84:87]
    v_exp_f32 v39, v39
    v_mfma_f32_16x16x32_bf16 a[88:91], a[180:183], v[104:107], a[88:91]
    v_cvt_pk_bf16_f32 v87, v38, v39
    v_add_f32 v227, v227, v38
    v_mfma_f32_16x16x32_bf16 a[92:95], a[180:183], v[108:111], a[92:95]
    ds_read_b64_tr_b16 a[166:167], v213 offset:53248
    v_add_f32 v227, v227, v39
    v_mfma_f32_16x16x32_bf16 v[72:75], a[144:147], v[176:179], v[120:123]
    v_exp_f32 v40, v40
    v_mfma_f32_16x16x32_bf16 v[72:75], a[148:151], v[180:183], v[72:75]
    v_exp_f32 v41, v41
    v_mfma_f32_16x16x32_bf16 v[72:75], a[152:155], v[184:187], v[72:75]
    v_cvt_pk_bf16_f32 v90, v40, v41
    v_mfma_f32_16x16x32_bf16 v[72:75], a[156:159], v[188:191], v[72:75]
    ds_read_b64_tr_b16 a[168:169], v214 offset:49152
    s_waitcnt lgkmcnt(5)
    v_mfma_f32_16x16x32_bf16 a[96:99], a[184:187], v[96:99], a[96:99]
    v_exp_f32 v42, v42
    v_mfma_f32_16x16x32_bf16 a[100:103], a[184:187], v[100:103], a[100:103]
    v_exp_f32 v43, v43
    v_mfma_f32_16x16x32_bf16 a[104:107], a[184:187], v[104:107], a[104:107]
    v_cvt_pk_bf16_f32 v91, v42, v43
    v_mfma_f32_16x16x32_bf16 a[108:111], a[184:187], v[108:111], a[108:111]
    ds_read_b64_tr_b16 a[170:171], v214 offset:53248
    v_mfma_f32_16x16x32_bf16 v[76:79], a[144:147], v[192:195], v[124:127]
    v_exp_f32 v44, v44
    v_mfma_f32_16x16x32_bf16 v[76:79], a[148:151], v[196:199], v[76:79]
    v_exp_f32 v45, v45
    v_mfma_f32_16x16x32_bf16 v[76:79], a[152:155], v[200:203], v[76:79]
    v_cvt_pk_bf16_f32 v94, v44, v45
    v_mfma_f32_16x16x32_bf16 v[76:79], a[156:159], v[204:207], v[76:79]
    ds_read_b64_tr_b16 a[172:173], v215 offset:49152
    v_mfma_f32_16x16x32_bf16 a[112:115], a[188:191], v[96:99], a[112:115]
    v_exp_f32 v46, v46
    v_mfma_f32_16x16x32_bf16 a[116:119], a[188:191], v[100:103], a[116:119]
    v_exp_f32 v47, v47
    v_mfma_f32_16x16x32_bf16 a[120:123], a[188:191], v[104:107], a[120:123]
    v_cvt_pk_bf16_f32 v95, v46, v47
    v_mfma_f32_16x16x32_bf16 a[124:127], a[188:191], v[108:111], a[124:127]
    ds_read_b64_tr_b16 a[174:175], v215 offset:53248
    v_mfma_f32_16x16x32_bf16 v[136:139], v[128:131], v[108:111], v[136:139]
    s_waitcnt lgkmcnt(4)
    v_exp_f32 v48, v48
    v_exp_f32 v49, v49
    v_exp_f32 v50, v50
    ds_read_b64_tr_b16 a[176:177], v216 offset:49152
    v_add_f32 v226, v226, v48
    v_add_f32 v226, v226, v49
    v_mfma_f32_16x16x32_bf16 a[0:3], a[160:163], v[80:83], a[0:3]
    v_exp_f32 v51, v51
    v_mfma_f32_16x16x32_bf16 a[4:7], a[160:163], v[84:87], a[4:7]
    v_cvt_pk_bf16_f32 v96, v48, v49
    v_add_f32 v226, v226, v50
    v_mfma_f32_16x16x32_bf16 a[8:11], a[160:163], v[88:91], a[8:11]
    v_exp_f32 v52, v52
    v_mfma_f32_16x16x32_bf16 a[12:15], a[160:163], v[92:95], a[12:15]
    ds_read_b64_tr_b16 a[178:179], v216 offset:53248
    v_add_f32 v226, v226, v51
    v_cvt_pk_bf16_f32 v97, v50, v51
    v_add_f32 v227, v227, v52
    v_exp_f32 v53, v53
    s_nop 0
    v_cvt_pk_bf16_f32 v100, v52, v53
    v_add_f32 v227, v227, v53
    ds_read_b64_tr_b16 a[180:181], v217 offset:49152
    v_exp_f32 v54, v54
    v_mfma_f32_16x16x32_bf16 a[16:19], a[164:167], v[80:83], a[16:19]
    v_add_f32 v227, v227, v54
    v_mfma_f32_16x16x32_bf16 a[20:23], a[164:167], v[84:87], a[20:23]
    v_exp_f32 v55, v55
    v_mfma_f32_16x16x32_bf16 a[24:27], a[164:167], v[88:91], a[24:27]
    v_cvt_pk_bf16_f32 v101, v54, v55
    v_add_f32 v227, v227, v55
    v_mfma_f32_16x16x32_bf16 a[28:31], a[164:167], v[92:95], a[28:31]
    ds_read_b64_tr_b16 a[182:183], v217 offset:53248
    v_exp_f32 v56, v56
    v_exp_f32 v57, v57
    s_nop 0
    v_cvt_pk_bf16_f32 v104, v56, v57
    ds_read_b64_tr_b16 a[184:185], v218 offset:49152
    v_exp_f32 v58, v58
    s_waitcnt lgkmcnt(5)
    v_mfma_f32_16x16x32_bf16 a[32:35], a[168:171], v[80:83], a[32:35]
    v_mfma_f32_16x16x32_bf16 a[36:39], a[168:171], v[84:87], a[36:39]
    v_exp_f32 v59, v59
    v_mfma_f32_16x16x32_bf16 a[40:43], a[168:171], v[88:91], a[40:43]
    v_cvt_pk_bf16_f32 v105, v58, v59
    v_mfma_f32_16x16x32_bf16 a[44:47], a[168:171], v[92:95], a[44:47]
    ds_read_b64_tr_b16 a[186:187], v218 offset:53248
    v_exp_f32 v60, v60
    v_exp_f32 v61, v61
    s_nop 0
    v_cvt_pk_bf16_f32 v108, v60, v61
    ds_read_b64_tr_b16 a[188:189], v219 offset:49152
    v_exp_f32 v62, v62
    v_mfma_f32_16x16x32_bf16 a[48:51], a[172:175], v[80:83], a[48:51]
    v_mfma_f32_16x16x32_bf16 a[52:55], a[172:175], v[84:87], a[52:55]
    v_exp_f32 v63, v63
    v_mfma_f32_16x16x32_bf16 a[56:59], a[172:175], v[88:91], a[56:59]
    v_cvt_pk_bf16_f32 v109, v62, v63
    v_mfma_f32_16x16x32_bf16 a[60:63], a[172:175], v[92:95], a[60:63]
    ds_read_b64_tr_b16 a[190:191], v219 offset:53248
    v_mfma_f32_16x16x32_bf16 v[132:135], v[128:131], v[88:91], v[132:135]
    s_waitcnt lgkmcnt(4)
    v_exp_f32 v64, v64
    v_exp_f32 v65, v65
    v_exp_f32 v66, v66
    ds_read_b64_tr_b16 a[160:161], v212 offset:57344
    v_cvt_pk_bf16_f32 v98, v64, v65
    v_add_f32 v226, v226, v64
    v_mfma_f32_16x16x32_bf16 a[64:67], a[176:179], v[80:83], a[64:67]
    v_exp_f32 v67, v67
    v_mfma_f32_16x16x32_bf16 a[68:71], a[176:179], v[84:87], a[68:71]
    v_cvt_pk_bf16_f32 v99, v66, v67
    v_add_f32 v226, v226, v65
    v_mfma_f32_16x16x32_bf16 a[72:75], a[176:179], v[88:91], a[72:75]
    v_exp_f32 v68, v68
    v_mfma_f32_16x16x32_bf16 a[76:79], a[176:179], v[92:95], a[76:79]
    ds_read_b64_tr_b16 a[162:163], v212 offset:61440
    v_add_f32 v226, v226, v66
    v_add_f32 v226, v226, v67
    v_add_f32 v227, v227, v68
    v_exp_f32 v69, v69
    s_nop 0
    v_cvt_pk_bf16_f32 v102, v68, v69
    v_add_f32 v227, v227, v69
    ds_read_b64_tr_b16 a[164:165], v213 offset:57344
    v_exp_f32 v70, v70
    v_mfma_f32_16x16x32_bf16 a[80:83], a[180:183], v[80:83], a[80:83]
    v_add_f32 v227, v227, v70
    v_mfma_f32_16x16x32_bf16 a[84:87], a[180:183], v[84:87], a[84:87]
    v_exp_f32 v71, v71
    v_mfma_f32_16x16x32_bf16 a[88:91], a[180:183], v[88:91], a[88:91]
    v_cvt_pk_bf16_f32 v103, v70, v71
    v_add_f32 v227, v227, v71
    v_mfma_f32_16x16x32_bf16 a[92:95], a[180:183], v[92:95], a[92:95]
    ds_read_b64_tr_b16 a[166:167], v213 offset:61440
    v_exp_f32 v72, v72
    v_exp_f32 v73, v73
    s_nop 0
    v_cvt_pk_bf16_f32 v106, v72, v73
    ds_read_b64_tr_b16 a[168:169], v214 offset:57344
    v_exp_f32 v74, v74
    s_waitcnt lgkmcnt(5)
    v_mfma_f32_16x16x32_bf16 a[96:99], a[184:187], v[80:83], a[96:99]
    v_mfma_f32_16x16x32_bf16 a[100:103], a[184:187], v[84:87], a[100:103]
    v_exp_f32 v75, v75
    v_mfma_f32_16x16x32_bf16 a[104:107], a[184:187], v[88:91], a[104:107]
    v_cvt_pk_bf16_f32 v107, v74, v75
    v_mfma_f32_16x16x32_bf16 a[108:111], a[184:187], v[92:95], a[108:111]
    ds_read_b64_tr_b16 a[170:171], v214 offset:61440
    v_exp_f32 v76, v76
    v_exp_f32 v77, v77
    s_nop 0
    v_cvt_pk_bf16_f32 v110, v76, v77
    ds_read_b64_tr_b16 a[172:173], v215 offset:57344
    v_exp_f32 v78, v78
    v_mfma_f32_16x16x32_bf16 a[112:115], a[188:191], v[80:83], a[112:115]
    v_mfma_f32_16x16x32_bf16 a[116:119], a[188:191], v[84:87], a[116:119]
    v_exp_f32 v79, v79
    v_mfma_f32_16x16x32_bf16 a[120:123], a[188:191], v[88:91], a[120:123]
    v_cvt_pk_bf16_f32 v111, v78, v79
    v_mfma_f32_16x16x32_bf16 a[124:127], a[188:191], v[92:95], a[124:127]
    ds_read_b64_tr_b16 a[174:175], v215 offset:61440
    v_mfma_f32_16x16x32_bf16 v[136:139], v[128:131], v[92:95], v[136:139]
    s_waitcnt lgkmcnt(4)
    ds_read_b64_tr_b16 a[176:177], v216 offset:57344
    v_mfma_f32_16x16x32_bf16 a[0:3], a[160:163], v[96:99], a[0:3]
    v_mfma_f32_16x16x32_bf16 a[4:7], a[160:163], v[100:103], a[4:7]
    v_mfma_f32_16x16x32_bf16 a[8:11], a[160:163], v[104:107], a[8:11]
    v_mfma_f32_16x16x32_bf16 a[12:15], a[160:163], v[108:111], a[12:15]
    ds_read_b64_tr_b16 a[178:179], v216 offset:61440
    ds_read_b64_tr_b16 a[180:181], v217 offset:57344
    v_mfma_f32_16x16x32_bf16 a[16:19], a[164:167], v[96:99], a[16:19]
    v_mfma_f32_16x16x32_bf16 a[20:23], a[164:167], v[100:103], a[20:23]
    v_mfma_f32_16x16x32_bf16 a[24:27], a[164:167], v[104:107], a[24:27]
    v_mfma_f32_16x16x32_bf16 a[28:31], a[164:167], v[108:111], a[28:31]
    ds_read_b64_tr_b16 a[182:183], v217 offset:61440
    ds_read_b64_tr_b16 a[184:185], v218 offset:57344
    s_waitcnt lgkmcnt(5)
    v_mfma_f32_16x16x32_bf16 a[32:35], a[168:171], v[96:99], a[32:35]
    v_mfma_f32_16x16x32_bf16 a[36:39], a[168:171], v[100:103], a[36:39]
    v_mfma_f32_16x16x32_bf16 a[40:43], a[168:171], v[104:107], a[40:43]
    v_mfma_f32_16x16x32_bf16 a[44:47], a[168:171], v[108:111], a[44:47]
    ds_read_b64_tr_b16 a[186:187], v218 offset:61440
    ds_read_b64_tr_b16 a[188:189], v219 offset:57344
    v_mfma_f32_16x16x32_bf16 a[48:51], a[172:175], v[96:99], a[48:51]
    v_mfma_f32_16x16x32_bf16 a[52:55], a[172:175], v[100:103], a[52:55]
    v_mfma_f32_16x16x32_bf16 a[56:59], a[172:175], v[104:107], a[56:59]
    v_mfma_f32_16x16x32_bf16 a[60:63], a[172:175], v[108:111], a[60:63]
    ds_read_b64_tr_b16 a[190:191], v219 offset:61440
    v_mfma_f32_16x16x32_bf16 v[132:135], v[128:131], v[104:107], v[132:135]
    s_waitcnt lgkmcnt(4)
    v_mfma_f32_16x16x32_bf16 a[64:67], a[176:179], v[96:99], a[64:67]
    v_mfma_f32_16x16x32_bf16 a[68:71], a[176:179], v[100:103], a[68:71]
    v_mfma_f32_16x16x32_bf16 a[72:75], a[176:179], v[104:107], a[72:75]
    v_mfma_f32_16x16x32_bf16 a[76:79], a[176:179], v[108:111], a[76:79]
    v_mfma_f32_16x16x32_bf16 a[80:83], a[180:183], v[96:99], a[80:83]
    v_mfma_f32_16x16x32_bf16 a[84:87], a[180:183], v[100:103], a[84:87]
    v_mfma_f32_16x16x32_bf16 a[88:91], a[180:183], v[104:107], a[88:91]
    v_mfma_f32_16x16x32_bf16 a[92:95], a[180:183], v[108:111], a[92:95]
    s_waitcnt lgkmcnt(0)
    v_mfma_f32_16x16x32_bf16 a[96:99], a[184:187], v[96:99], a[96:99]
    v_mfma_f32_16x16x32_bf16 a[100:103], a[184:187], v[100:103], a[100:103]
    v_mfma_f32_16x16x32_bf16 a[104:107], a[184:187], v[104:107], a[104:107]
    v_mfma_f32_16x16x32_bf16 a[108:111], a[184:187], v[108:111], a[108:111]
    v_mfma_f32_16x16x32_bf16 a[112:115], a[188:191], v[96:99], a[112:115]
    v_mfma_f32_16x16x32_bf16 a[116:119], a[188:191], v[100:103], a[116:119]
    v_mfma_f32_16x16x32_bf16 a[120:123], a[188:191], v[104:107], a[120:123]
    v_mfma_f32_16x16x32_bf16 a[124:127], a[188:191], v[108:111], a[124:127]
    v_mfma_f32_16x16x32_bf16 v[136:139], v[128:131], v[108:111], v[136:139]
    v_mov_b32 v248, v226
    s_nop 1
    v_permlane32_swap_b32 v248, v226
    v_add_f32 v226, v226, v248
    v_mov_b32 v248, v226
    s_nop 1
    v_permlane16_swap_b32 v248, v226
    v_add_f32 v226, v226, v248
    v_mov_b32 v248, v227
    s_nop 1
    v_permlane32_swap_b32 v248, v227
    v_add_f32 v227, v227, v248
    v_mov_b32 v248, v227
    s_nop 1
    v_permlane16_swap_b32 v248, v227
    v_add_f32 v227, v227, v248
    v_mov_b32 v228, v132
    v_mov_b32 v229, v136
    v_max3_f32 v248, v226, v227, v228
    v_max_f32 v248, v248, v229
    v_add_f32 v249, v226, v227
    v_add_f32 v250, v228, v229
    v_add_f32 v249, v249, v250
    s_mov_b32 s6, 0x4b800000
    v_cmp_nlt_f32 vcc, v248, s6
    v_cmp_u_f32 s[6:7], v249, v249
    s_nop 0
    s_or_b64 vcc, vcc, s[6:7]
    s_cmp_lg_u64 vcc, 0
    s_cselect_b32 s6, 1, 0
    v_mov_b32 v248, s6
    v_mov_b32 v249, 131072
    v_lshl_add_u32 v250, s3, 2, v249
    ds_write_b32 v250, v248
    v_rcp_f32 v226, v226
    v_rcp_f32 v227, v227
    v_rcp_f32 v228, v228
    v_rcp_f32 v229, v229
    s_lshl_b32 s6, s5, 1
    s_lshr_b32 s7, s3, 1
    s_add_u32 s6, s6, s7
    s_mul_i32 s6, s6, 1511424
    s_lshl_b32 s7, s4, 15
    s_add_u32 s6, s6, s7
    s_and_b32 s7, s3, 1
    s_lshl_b32 s7, s7, 12
    s_add_u32 s6, s6, s7
    s_add_u32 s52, s6, 4194304
    s_add_u32 s53, s52, 16384
    v_and_b32 v2, 15, v1
    v_lshrrev_b32 v3, 4, v1
    v_bfe_u32 v4, v1, 2, 1
    v_lshlrev_b32 v4, 1, v4
    v_bfe_u32 v5, v1, 3, 1
    v_mul_u32_u24 v5, 3, v5
    v_xor_b32 v4, v4, v5
    v_xor_b32 v4, v4, v3
    v_lshlrev_b32 v4, 4, v4
    v_lshl_add_u32 v2, v2, 6, v4
    v_add_u32 v3, 8192, v2
    v_accvgpr_read_b32 v16, a0
    v_accvgpr_read_b32 v17, a1
    v_accvgpr_read_b32 v18, a2
    v_accvgpr_read_b32 v19, a3
    v_accvgpr_read_b32 v20, a16
    v_accvgpr_read_b32 v21, a17
    v_accvgpr_read_b32 v22, a18
    v_accvgpr_read_b32 v23, a19
    v_pk_mul_f32 v[16:17], v[16:17], v[226:227] op_sel:[0,0] op_sel_hi:[1,0]
    v_pk_mul_f32 v[18:19], v[18:19], v[226:227] op_sel:[0,0] op_sel_hi:[1,0]
    v_pk_mul_f32 v[20:21], v[20:21], v[226:227] op_sel:[0,0] op_sel_hi:[1,0]
    v_pk_mul_f32 v[22:23], v[22:23], v[226:227] op_sel:[0,0] op_sel_hi:[1,0]
    v_cvt_pk_bf16_f32 v24, v16, v17
    v_cvt_pk_bf16_f32 v25, v18, v19
    v_cvt_pk_bf16_f32 v26, v20, v21
    v_cvt_pk_bf16_f32 v27, v22, v23
    buffer_store_dwordx4 v[24:27], v2, s[20:23], s52 offen offset:0
    v_accvgpr_read_b32 v32, a32
    v_accvgpr_read_b32 v33, a33
    v_accvgpr_read_b32 v34, a34
    v_accvgpr_read_b32 v35, a35
    v_accvgpr_read_b32 v36, a48
    v_accvgpr_read_b32 v37, a49
    v_accvgpr_read_b32 v38, a50
    v_accvgpr_read_b32 v39, a51
    v_pk_mul_f32 v[32:33], v[32:33], v[226:227] op_sel:[0,0] op_sel_hi:[1,0]
    v_pk_mul_f32 v[34:35], v[34:35], v[226:227] op_sel:[0,0] op_sel_hi:[1,0]
    v_pk_mul_f32 v[36:37], v[36:37], v[226:227] op_sel:[0,0] op_sel_hi:[1,0]
    v_pk_mul_f32 v[38:39], v[38:39], v[226:227] op_sel:[0,0] op_sel_hi:[1,0]
    v_cvt_pk_bf16_f32 v40, v32, v33
    v_cvt_pk_bf16_f32 v41, v34, v35
    v_cvt_pk_bf16_f32 v42, v36, v37
    v_cvt_pk_bf16_f32 v43, v38, v39
    buffer_store_dwordx4 v[40:43], v3, s[20:23], s52 offen offset:0
    v_accvgpr_read_b32 v16, a64
    v_accvgpr_read_b32 v17, a65
    v_accvgpr_read_b32 v18, a66
    v_accvgpr_read_b32 v19, a67
    v_accvgpr_read_b32 v20, a80
    v_accvgpr_read_b32 v21, a81
    v_accvgpr_read_b32 v22, a82
    v_accvgpr_read_b32 v23, a83
    v_pk_mul_f32 v[16:17], v[16:17], v[226:227] op_sel:[0,0] op_sel_hi:[1,0]
    v_pk_mul_f32 v[18:19], v[18:19], v[226:227] op_sel:[0,0] op_sel_hi:[1,0]
    v_pk_mul_f32 v[20:21], v[20:21], v[226:227] op_sel:[0,0] op_sel_hi:[1,0]
    v_pk_mul_f32 v[22:23], v[22:23], v[226:227] op_sel:[0,0] op_sel_hi:[1,0]
    v_cvt_pk_bf16_f32 v24, v16, v17
    v_cvt_pk_bf16_f32 v25, v18, v19
    v_cvt_pk_bf16_f32 v26, v20, v21
    v_cvt_pk_bf16_f32 v27, v22, v23
    buffer_store_dwordx4 v[24:27], v2, s[20:23], s53 offen offset:0
    v_accvgpr_read_b32 v32, a96
    v_accvgpr_read_b32 v33, a97
    v_accvgpr_read_b32 v34, a98
    v_accvgpr_read_b32 v35, a99
    v_accvgpr_read_b32 v36, a112
    v_accvgpr_read_b32 v37, a113
    v_accvgpr_read_b32 v38, a114
    v_accvgpr_read_b32 v39, a115
    v_pk_mul_f32 v[32:33], v[32:33], v[226:227] op_sel:[0,0] op_sel_hi:[1,0]
    v_pk_mul_f32 v[34:35], v[34:35], v[226:227] op_sel:[0,0] op_sel_hi:[1,0]
    v_pk_mul_f32 v[36:37], v[36:37], v[226:227] op_sel:[0,0] op_sel_hi:[1,0]
    v_pk_mul_f32 v[38:39], v[38:39], v[226:227] op_sel:[0,0] op_sel_hi:[1,0]
    v_cvt_pk_bf16_f32 v40, v32, v33
    v_cvt_pk_bf16_f32 v41, v34, v35
    v_cvt_pk_bf16_f32 v42, v36, v37
    v_cvt_pk_bf16_f32 v43, v38, v39
    buffer_store_dwordx4 v[40:43], v3, s[20:23], s53 offen offset:0
    v_accvgpr_read_b32 v16, a4
    v_accvgpr_read_b32 v17, a5
    v_accvgpr_read_b32 v18, a6
    v_accvgpr_read_b32 v19, a7
    v_accvgpr_read_b32 v20, a20
    v_accvgpr_read_b32 v21, a21
    v_accvgpr_read_b32 v22, a22
    v_accvgpr_read_b32 v23, a23
    v_pk_mul_f32 v[16:17], v[16:17], v[226:227] op_sel:[0,1] op_sel_hi:[1,1]
    v_pk_mul_f32 v[18:19], v[18:19], v[226:227] op_sel:[0,1] op_sel_hi:[1,1]
    v_pk_mul_f32 v[20:21], v[20:21], v[226:227] op_sel:[0,1] op_sel_hi:[1,1]
    v_pk_mul_f32 v[22:23], v[22:23], v[226:227] op_sel:[0,1] op_sel_hi:[1,1]
    v_cvt_pk_bf16_f32 v24, v16, v17
    v_cvt_pk_bf16_f32 v25, v18, v19
    v_cvt_pk_bf16_f32 v26, v20, v21
    v_cvt_pk_bf16_f32 v27, v22, v23
    buffer_store_dwordx4 v[24:27], v2, s[20:23], s52 offen offset:1024
    v_accvgpr_read_b32 v32, a36
    v_accvgpr_read_b32 v33, a37
    v_accvgpr_read_b32 v34, a38
    v_accvgpr_read_b32 v35, a39
    v_accvgpr_read_b32 v36, a52
    v_accvgpr_read_b32 v37, a53
    v_accvgpr_read_b32 v38, a54
    v_accvgpr_read_b32 v39, a55
    v_pk_mul_f32 v[32:33], v[32:33], v[226:227] op_sel:[0,1] op_sel_hi:[1,1]
    v_pk_mul_f32 v[34:35], v[34:35], v[226:227] op_sel:[0,1] op_sel_hi:[1,1]
    v_pk_mul_f32 v[36:37], v[36:37], v[226:227] op_sel:[0,1] op_sel_hi:[1,1]
    v_pk_mul_f32 v[38:39], v[38:39], v[226:227] op_sel:[0,1] op_sel_hi:[1,1]
    v_cvt_pk_bf16_f32 v40, v32, v33
    v_cvt_pk_bf16_f32 v41, v34, v35
    v_cvt_pk_bf16_f32 v42, v36, v37
    v_cvt_pk_bf16_f32 v43, v38, v39
    buffer_store_dwordx4 v[40:43], v3, s[20:23], s52 offen offset:1024
    v_accvgpr_read_b32 v16, a68
    v_accvgpr_read_b32 v17, a69
    v_accvgpr_read_b32 v18, a70
    v_accvgpr_read_b32 v19, a71
    v_accvgpr_read_b32 v20, a84
    v_accvgpr_read_b32 v21, a85
    v_accvgpr_read_b32 v22, a86
    v_accvgpr_read_b32 v23, a87
    v_pk_mul_f32 v[16:17], v[16:17], v[226:227] op_sel:[0,1] op_sel_hi:[1,1]
    v_pk_mul_f32 v[18:19], v[18:19], v[226:227] op_sel:[0,1] op_sel_hi:[1,1]
    v_pk_mul_f32 v[20:21], v[20:21], v[226:227] op_sel:[0,1] op_sel_hi:[1,1]
    v_pk_mul_f32 v[22:23], v[22:23], v[226:227] op_sel:[0,1] op_sel_hi:[1,1]
    v_cvt_pk_bf16_f32 v24, v16, v17
    v_cvt_pk_bf16_f32 v25, v18, v19
    v_cvt_pk_bf16_f32 v26, v20, v21
    v_cvt_pk_bf16_f32 v27, v22, v23
    buffer_store_dwordx4 v[24:27], v2, s[20:23], s53 offen offset:1024
    v_accvgpr_read_b32 v32, a100
    v_accvgpr_read_b32 v33, a101
    v_accvgpr_read_b32 v34, a102
    v_accvgpr_read_b32 v35, a103
    v_accvgpr_read_b32 v36, a116
    v_accvgpr_read_b32 v37, a117
    v_accvgpr_read_b32 v38, a118
    v_accvgpr_read_b32 v39, a119
    v_pk_mul_f32 v[32:33], v[32:33], v[226:227] op_sel:[0,1] op_sel_hi:[1,1]
    v_pk_mul_f32 v[34:35], v[34:35], v[226:227] op_sel:[0,1] op_sel_hi:[1,1]
    v_pk_mul_f32 v[36:37], v[36:37], v[226:227] op_sel:[0,1] op_sel_hi:[1,1]
    v_pk_mul_f32 v[38:39], v[38:39], v[226:227] op_sel:[0,1] op_sel_hi:[1,1]
    v_cvt_pk_bf16_f32 v40, v32, v33
    v_cvt_pk_bf16_f32 v41, v34, v35
    v_cvt_pk_bf16_f32 v42, v36, v37
    v_cvt_pk_bf16_f32 v43, v38, v39
    buffer_store_dwordx4 v[40:43], v3, s[20:23], s53 offen offset:1024
    v_accvgpr_read_b32 v16, a8
    v_accvgpr_read_b32 v17, a9
    v_accvgpr_read_b32 v18, a10
    v_accvgpr_read_b32 v19, a11
    v_accvgpr_read_b32 v20, a24
    v_accvgpr_read_b32 v21, a25
    v_accvgpr_read_b32 v22, a26
    v_accvgpr_read_b32 v23, a27
    v_pk_mul_f32 v[16:17], v[16:17], v[228:229] op_sel:[0,0] op_sel_hi:[1,0]
    v_pk_mul_f32 v[18:19], v[18:19], v[228:229] op_sel:[0,0] op_sel_hi:[1,0]
    v_pk_mul_f32 v[20:21], v[20:21], v[228:229] op_sel:[0,0] op_sel_hi:[1,0]
    v_pk_mul_f32 v[22:23], v[22:23], v[228:229] op_sel:[0,0] op_sel_hi:[1,0]
    v_cvt_pk_bf16_f32 v24, v16, v17
    v_cvt_pk_bf16_f32 v25, v18, v19
    v_cvt_pk_bf16_f32 v26, v20, v21
    v_cvt_pk_bf16_f32 v27, v22, v23
    buffer_store_dwordx4 v[24:27], v2, s[20:23], s52 offen offset:2048
    v_accvgpr_read_b32 v32, a40
    v_accvgpr_read_b32 v33, a41
    v_accvgpr_read_b32 v34, a42
    v_accvgpr_read_b32 v35, a43
    v_accvgpr_read_b32 v36, a56
    v_accvgpr_read_b32 v37, a57
    v_accvgpr_read_b32 v38, a58
    v_accvgpr_read_b32 v39, a59
    v_pk_mul_f32 v[32:33], v[32:33], v[228:229] op_sel:[0,0] op_sel_hi:[1,0]
    v_pk_mul_f32 v[34:35], v[34:35], v[228:229] op_sel:[0,0] op_sel_hi:[1,0]
    v_pk_mul_f32 v[36:37], v[36:37], v[228:229] op_sel:[0,0] op_sel_hi:[1,0]
    v_pk_mul_f32 v[38:39], v[38:39], v[228:229] op_sel:[0,0] op_sel_hi:[1,0]
    v_cvt_pk_bf16_f32 v40, v32, v33
    v_cvt_pk_bf16_f32 v41, v34, v35
    v_cvt_pk_bf16_f32 v42, v36, v37
    v_cvt_pk_bf16_f32 v43, v38, v39
    buffer_store_dwordx4 v[40:43], v3, s[20:23], s52 offen offset:2048
    v_accvgpr_read_b32 v16, a72
    v_accvgpr_read_b32 v17, a73
    v_accvgpr_read_b32 v18, a74
    v_accvgpr_read_b32 v19, a75
    v_accvgpr_read_b32 v20, a88
    v_accvgpr_read_b32 v21, a89
    v_accvgpr_read_b32 v22, a90
    v_accvgpr_read_b32 v23, a91
    v_pk_mul_f32 v[16:17], v[16:17], v[228:229] op_sel:[0,0] op_sel_hi:[1,0]
    v_pk_mul_f32 v[18:19], v[18:19], v[228:229] op_sel:[0,0] op_sel_hi:[1,0]
    v_pk_mul_f32 v[20:21], v[20:21], v[228:229] op_sel:[0,0] op_sel_hi:[1,0]
    v_pk_mul_f32 v[22:23], v[22:23], v[228:229] op_sel:[0,0] op_sel_hi:[1,0]
    v_cvt_pk_bf16_f32 v24, v16, v17
    v_cvt_pk_bf16_f32 v25, v18, v19
    v_cvt_pk_bf16_f32 v26, v20, v21
    v_cvt_pk_bf16_f32 v27, v22, v23
    buffer_store_dwordx4 v[24:27], v2, s[20:23], s53 offen offset:2048
    v_accvgpr_read_b32 v32, a104
    v_accvgpr_read_b32 v33, a105
    v_accvgpr_read_b32 v34, a106
    v_accvgpr_read_b32 v35, a107
    v_accvgpr_read_b32 v36, a120
    v_accvgpr_read_b32 v37, a121
    v_accvgpr_read_b32 v38, a122
    v_accvgpr_read_b32 v39, a123
    v_pk_mul_f32 v[32:33], v[32:33], v[228:229] op_sel:[0,0] op_sel_hi:[1,0]
    v_pk_mul_f32 v[34:35], v[34:35], v[228:229] op_sel:[0,0] op_sel_hi:[1,0]
    v_pk_mul_f32 v[36:37], v[36:37], v[228:229] op_sel:[0,0] op_sel_hi:[1,0]
    v_pk_mul_f32 v[38:39], v[38:39], v[228:229] op_sel:[0,0] op_sel_hi:[1,0]
    v_cvt_pk_bf16_f32 v40, v32, v33
    v_cvt_pk_bf16_f32 v41, v34, v35
    v_cvt_pk_bf16_f32 v42, v36, v37
    v_cvt_pk_bf16_f32 v43, v38, v39
    buffer_store_dwordx4 v[40:43], v3, s[20:23], s53 offen offset:2048
    v_accvgpr_read_b32 v16, a12
    v_accvgpr_read_b32 v17, a13
    v_accvgpr_read_b32 v18, a14
    v_accvgpr_read_b32 v19, a15
    v_accvgpr_read_b32 v20, a28
    v_accvgpr_read_b32 v21, a29
    v_accvgpr_read_b32 v22, a30
    v_accvgpr_read_b32 v23, a31
    v_pk_mul_f32 v[16:17], v[16:17], v[228:229] op_sel:[0,1] op_sel_hi:[1,1]
    v_pk_mul_f32 v[18:19], v[18:19], v[228:229] op_sel:[0,1] op_sel_hi:[1,1]
    v_pk_mul_f32 v[20:21], v[20:21], v[228:229] op_sel:[0,1] op_sel_hi:[1,1]
    v_pk_mul_f32 v[22:23], v[22:23], v[228:229] op_sel:[0,1] op_sel_hi:[1,1]
    v_cvt_pk_bf16_f32 v24, v16, v17
    v_cvt_pk_bf16_f32 v25, v18, v19
    v_cvt_pk_bf16_f32 v26, v20, v21
    v_cvt_pk_bf16_f32 v27, v22, v23
    buffer_store_dwordx4 v[24:27], v2, s[20:23], s52 offen offset:3072
    v_accvgpr_read_b32 v32, a44
    v_accvgpr_read_b32 v33, a45
    v_accvgpr_read_b32 v34, a46
    v_accvgpr_read_b32 v35, a47
    v_accvgpr_read_b32 v36, a60
    v_accvgpr_read_b32 v37, a61
    v_accvgpr_read_b32 v38, a62
    v_accvgpr_read_b32 v39, a63
    v_pk_mul_f32 v[32:33], v[32:33], v[228:229] op_sel:[0,1] op_sel_hi:[1,1]
    v_pk_mul_f32 v[34:35], v[34:35], v[228:229] op_sel:[0,1] op_sel_hi:[1,1]
    v_pk_mul_f32 v[36:37], v[36:37], v[228:229] op_sel:[0,1] op_sel_hi:[1,1]
    v_pk_mul_f32 v[38:39], v[38:39], v[228:229] op_sel:[0,1] op_sel_hi:[1,1]
    v_cvt_pk_bf16_f32 v40, v32, v33
    v_cvt_pk_bf16_f32 v41, v34, v35
    v_cvt_pk_bf16_f32 v42, v36, v37
    v_cvt_pk_bf16_f32 v43, v38, v39
    buffer_store_dwordx4 v[40:43], v3, s[20:23], s52 offen offset:3072
    v_accvgpr_read_b32 v16, a76
    v_accvgpr_read_b32 v17, a77
    v_accvgpr_read_b32 v18, a78
    v_accvgpr_read_b32 v19, a79
    v_accvgpr_read_b32 v20, a92
    v_accvgpr_read_b32 v21, a93
    v_accvgpr_read_b32 v22, a94
    v_accvgpr_read_b32 v23, a95
    v_pk_mul_f32 v[16:17], v[16:17], v[228:229] op_sel:[0,1] op_sel_hi:[1,1]
    v_pk_mul_f32 v[18:19], v[18:19], v[228:229] op_sel:[0,1] op_sel_hi:[1,1]
    v_pk_mul_f32 v[20:21], v[20:21], v[228:229] op_sel:[0,1] op_sel_hi:[1,1]
    v_pk_mul_f32 v[22:23], v[22:23], v[228:229] op_sel:[0,1] op_sel_hi:[1,1]
    v_cvt_pk_bf16_f32 v24, v16, v17
    v_cvt_pk_bf16_f32 v25, v18, v19
    v_cvt_pk_bf16_f32 v26, v20, v21
    v_cvt_pk_bf16_f32 v27, v22, v23
    buffer_store_dwordx4 v[24:27], v2, s[20:23], s53 offen offset:3072
    v_accvgpr_read_b32 v32, a108
    v_accvgpr_read_b32 v33, a109
    v_accvgpr_read_b32 v34, a110
    v_accvgpr_read_b32 v35, a111
    v_accvgpr_read_b32 v36, a124
    v_accvgpr_read_b32 v37, a125
    v_accvgpr_read_b32 v38, a126
    v_accvgpr_read_b32 v39, a127
    v_pk_mul_f32 v[32:33], v[32:33], v[228:229] op_sel:[0,1] op_sel_hi:[1,1]
    v_pk_mul_f32 v[34:35], v[34:35], v[228:229] op_sel:[0,1] op_sel_hi:[1,1]
    v_pk_mul_f32 v[36:37], v[36:37], v[228:229] op_sel:[0,1] op_sel_hi:[1,1]
    v_pk_mul_f32 v[38:39], v[38:39], v[228:229] op_sel:[0,1] op_sel_hi:[1,1]
    v_cvt_pk_bf16_f32 v40, v32, v33
    v_cvt_pk_bf16_f32 v41, v34, v35
    v_cvt_pk_bf16_f32 v42, v36, v37
    v_cvt_pk_bf16_f32 v43, v38, v39
    buffer_store_dwordx4 v[40:43], v3, s[20:23], s53 offen offset:3072
    v_mov_b32 v249, 131072
    s_waitcnt lgkmcnt(0)
    s_barrier
    ds_read_b128 v[248:251], v249
    s_waitcnt lgkmcnt(0)
    v_or3_b32 v248, v248, v249, v250
    v_or_b32 v248, v248, v251
    s_nop 0
    v_readfirstlane_b32 s6, v248
    s_xor_b32 s7, s27, 1
    s_and_b32 s6, s6, s7
    s_cmp_lg_u32 s6, 0
    s_cbranch_scc1 K_fallback
KA_end:
    s_endpgm
K_fallback:
    s_waitcnt vmcnt(0) lgkmcnt(0)
    s_barrier
    s_mov_b32 s27, 1
    v_and_b32 v2, 15, v1
    v_lshrrev_b32 v3, 4, v1
    v_lshlrev_b32 v2, 8, v2
    v_lshl_add_u32 v2, v3, 4, v2
    s_mov_b32 s6, 0
    v_mov_b32 v244, 0xff800000
    v_mov_b32 v245, 0xff800000
    v_mov_b32 v246, 0xff800000
    v_mov_b32 v247, 0xff800000
K_fb_loop:
    buffer_load_dwordx4 v[16:19], v2, s[16:19], s6 offen offset:0
    buffer_load_dwordx4 v[20:23], v2, s[16:19], s6 offen offset:64
    buffer_load_dwordx4 v[24:27], v2, s[16:19], s6 offen offset:128
    buffer_load_dwordx4 v[28:31], v2, s[16:19], s6 offen offset:192
    s_waitcnt vmcnt(0)
    v_mfma_f32_16x16x32_bf16 v[32:35], v[16:19], v[144:147], 0
    v_mfma_f32_16x16x32_bf16 v[32:35], v[20:23], v[148:151], v[32:35]
    v_mfma_f32_16x16x32_bf16 v[32:35], v[24:27], v[152:155], v[32:35]
    v_mfma_f32_16x16x32_bf16 v[32:35], v[28:31], v[156:159], v[32:35]
    v_mfma_f32_16x16x32_bf16 v[36:39], v[16:19], v[160:163], 0
    v_mfma_f32_16x16x32_bf16 v[36:39], v[20:23], v[164:167], v[36:39]
    v_mfma_f32_16x16x32_bf16 v[36:39], v[24:27], v[168:171], v[36:39]
    v_mfma_f32_16x16x32_bf16 v[36:39], v[28:31], v[172:175], v[36:39]
    v_mfma_f32_16x16x32_bf16 v[40:43], v[16:19], v[176:179], 0
    v_mfma_f32_16x16x32_bf16 v[40:43], v[20:23], v[180:183], v[40:43]
    v_mfma_f32_16x16x32_bf16 v[40:43], v[24:27], v[184:187], v[40:43]
    v_mfma_f32_16x16x32_bf16 v[40:43], v[28:31], v[188:191], v[40:43]
    v_mfma_f32_16x16x32_bf16 v[44:47], v[16:19], v[192:195], 0
    v_mfma_f32_16x16x32_bf16 v[44:47], v[20:23], v[196:199], v[44:47]
    v_mfma_f32_16x16x32_bf16 v[44:47], v[24:27], v[200:203], v[44:47]
    v_mfma_f32_16x16x32_bf16 v[44:47], v[28:31], v[204:207], v[44:47]
    s_nop 15
    v_max3_f32 v244, v244, v32, v33
    v_max3_f32 v244, v244, v34, v35
    v_max3_f32 v245, v245, v36, v37
    v_max3_f32 v245, v245, v38, v39
    v_max3_f32 v246, v246, v40, v41
    v_max3_f32 v246, v246, v42, v43
    v_max3_f32 v247, v247, v44, v45
    v_max3_f32 v247, v247, v46, v47
    s_add_u32 s6, s6, 4096
    s_cmp_lt_u32 s6, 524288
    s_cbranch_scc1 K_fb_loop
    v_mov_b32 v248, v244
    s_nop 1
    v_permlane32_swap_b32 v248, v244
    v_max_f32 v244, v244, v248
    v_mov_b32 v248, v244
    s_nop 1
    v_permlane16_swap_b32 v248, v244
    v_max_f32 v244, v244, v248
    v_mov_b32 v248, v245
    s_nop 1
    v_permlane32_swap_b32 v248, v245
    v_max_f32 v245, v245, v248
    v_mov_b32 v248, v245
    s_nop 1
    v_permlane16_swap_b32 v248, v245
    v_max_f32 v245, v245, v248
    v_mov_b32 v248, v246
    s_nop 1
    v_permlane32_swap_b32 v248, v246
    v_max_f32 v246, v246, v248
    v_mov_b32 v248, v246
    s_nop 1
    v_permlane16_swap_b32 v248, v246
    v_max_f32 v246, v246, v248
    v_mov_b32 v248, v247
    s_nop 1
    v_permlane32_swap_b32 v248, v247
    v_max_f32 v247, v247, v248
    v_mov_b32 v248, v247
    s_nop 1
    v_permlane16_swap_b32 v248, v247
    v_max_f32 v247, v247, v248
    s_mov_b32 s6, 0
    s_mov_b32 s7, 16384
    s_add_u32 m0, s25, 49152
    s_nop 0
    buffer_load_dwordx4 v220, s[16:19], 0 offen lds
    buffer_load_dwordx4 v221, s[16:19], 0 offen offset:1024 lds
    buffer_load_dwordx4 v222, s[16:19], 0 offen offset:2048 lds
    buffer_load_dwordx4 v223, s[16:19], 0 offen offset:3072 lds
    s_add_u32 m0, s25, 65536
    s_nop 0
    buffer_load_dwordx4 v224, s[12:15], s6 offen lds
    buffer_load_dwordx4 v225, s[12:15], s6 offen offset:1024 lds
    buffer_load_dwordx4 v224, s[12:15], s6 offen offset:2048 lds
    buffer_load_dwordx4 v225, s[12:15], s6 offen offset:3072 lds
    s_add_u32 m0, s25, 0
    s_nop 0
    buffer_load_dwordx4 v220, s[8:11], s6 offen lds
    buffer_load_dwordx4 v221, s[8:11], s6 offen offset:1024 lds
    buffer_load_dwordx4 v222, s[8:11], s6 offen offset:2048 lds
    buffer_load_dwordx4 v223, s[8:11], s6 offen offset:3072 lds
    s_add_u32 m0, s25, 81920
    s_nop 0
    buffer_load_dwordx4 v224, s[12:15], s7 offen lds
    buffer_load_dwordx4 v225, s[12:15], s7 offen offset:1024 lds
    buffer_load_dwordx4 v224, s[12:15], s7 offen offset:2048 lds
    buffer_load_dwordx4 v225, s[12:15], s7 offen offset:3072 lds
    s_add_u32 m0, s25, 16384
    s_nop 0
    buffer_load_dwordx4 v220, s[8:11], s7 offen lds
    buffer_load_dwordx4 v221, s[8:11], s7 offen offset:1024 lds
    buffer_load_dwordx4 v222, s[8:11], s7 offen offset:2048 lds
    buffer_load_dwordx4 v223, s[8:11], s7 offen offset:3072 lds
    s_branch K_astart

.section .rodata,"a"
.p2align 6
.amdhsa_kernel attn_kernel
  .amdhsa_next_free_vgpr 512
  .amdhsa_next_free_sgpr 102
  .amdhsa_accum_offset 256
  .amdhsa_group_segment_fixed_size 0
  .amdhsa_kernarg_size 96
  .amdhsa_user_sgpr_count 2
  .amdhsa_user_sgpr_kernarg_segment_ptr 1
  .amdhsa_system_sgpr_workgroup_id_x 1
  .amdhsa_float_denorm_mode_32 3
.end_amdhsa_kernel
.text
.globl oproj_kernel
.p2align 8
.type oproj_kernel,@function
oproj_kernel:
    s_cmp_ge_u32 s2, 256
    s_cbranch_scc1 KB_end
    s_load_dwordx2 s[40:41], s[0:1], 32
    s_load_dwordx2 s[42:43], s[0:1], 64
    s_load_dwordx2 s[34:35], s[0:1], 88
    s_load_dwordx2 s[30:31], s[0:1], 0
    s_load_dwordx2 s[32:33], s[0:1], 72
    s_load_dwordx2 s[72:73], s[0:1], 80
    v_and_b32 v1, 63, v0
    v_lshrrev_b32 v2, 6, v0
    s_nop 0
    v_readfirstlane_b32 s3, v2
    s_and_b32 s48, s2, 3
    s_bfe_u32 s49, s2, 0x10002
    s_lshl_b32 s49, s49, 3
    s_bfe_u32 s6, s2, 0x30003
    s_add_u32 s49, s49, s6
    s_lshr_b32 s50, s2, 6
    s_mul_i32 s19, s48, 24
    s_sub_u32 s14, 92, s19
    s_min_u32 s14, s14, 24
    s_lshl_b32 s14, s14, 14
    s_mul_i32 s6, s49, 1511424
    s_lshl_b32 s7, s19, 14
    s_add_u32 s6, s6, s7
    s_add_u32 s36, s6, 4194304
    s_lshl_b32 s24, s3, 11
    s_lshl_b32 s26, s19, 16
    s_lshl_b32 s7, s50, 8
    s_add_u32 s26, s26, s7
    s_lshl_b32 s25, s3, 12
    v_lshrrev_b32 v2, 4, v1
    v_and_b32 v3, 15, v1
    s_lshl_b32 s7, s3, 4
    v_add_u32 v4, 0, v2
    v_lshlrev_b32 v4, 1, v4
    v_xor_b32 v4, v4, v3
    v_lshlrev_b32 v4, 4, v4
    v_add_u32 v5, s7, v2
    v_add_u32 v5, 0, v5
    v_lshl_add_u32 v4, v5, 10, v4
    v_subrev_u32 v224, 0, v4
    v_add_u32 v4, 4, v2
    v_lshlrev_b32 v4, 1, v4
    v_xor_b32 v4, v4, v3
    v_lshlrev_b32 v4, 4, v4
    v_add_u32 v5, s7, v2
    v_add_u32 v5, 4, v5
    v_lshl_add_u32 v4, v5, 10, v4
    v_subrev_u32 v225, 1024, v4
    v_add_u32 v4, 0, v2
    v_lshlrev_b32 v4, 1, v4
    v_xor_b32 v4, v4, v3
    v_lshlrev_b32 v4, 4, v4
    v_add_u32 v5, s7, v2
    v_add_u32 v5, 8, v5
    v_lshl_add_u32 v4, v5, 10, v4
    v_subrev_u32 v226, 2048, v4
    v_add_u32 v4, 4, v2
    v_lshlrev_b32 v4, 1, v4
    v_xor_b32 v4, v4, v3
    v_lshlrev_b32 v4, 4, v4
    v_add_u32 v5, s7, v2
    v_add_u32 v5, 12, v5
    v_lshl_add_u32 v4, v5, 10, v4
    v_subrev_u32 v227, 3072, v4
    v_and_b32 v2, 15, v1
    v_lshrrev_b32 v3, 4, v1
    v_bfe_u32 v4, v1, 2, 1
    v_lshlrev_b32 v4, 1, v4
    v_bfe_u32 v5, v1, 3, 1
    v_mul_u32_u24 v5, 3, v5
    v_xor_b32 v4, v4, v5
    v_xor_b32 v4, v4, v3
    v_lshlrev_b32 v4, 4, v4
    v_lshl_add_u32 v228, v2, 6, v4
    v_add_u32 v229, 8192, v228
    s_waitcnt lgkmcnt(0)
    s_and_b32 s41, s41, 0xffff
    s_sub_u32 s42, s42, 4194304
    s_subb_u32 s43, s43, 0
    s_and_b32 s43, s43, 0xffff
    s_mov_b32 s10, 6029312
    s_mov_b32 s11, 0x20000
    s_mov_b32 s20, s34
    s_and_b32 s21, s35, 0xffff
    s_mov_b32 s22, 0x10000000
    s_mov_b32 s23, 0x20000
    s_add_u32 s12, s34, s36
    s_addc_u32 s13, s35, 0
    s_and_b32 s13, s13, 0xffff
    s_mov_b32 s15, 0x20000
    s_cmp_lt_u32 s19, 64
    s_cselect_b32 s8, s40, s42
    s_cselect_b32 s9, s41, s43
    s_add_u32 s19, s19, 4
    s_add_u32 m0, s25, 0
    s_nop 0
    buffer_load_dwordx4 v224, s[8:11], s26 offen lds
    buffer_load_dwordx4 v225, s[8:11], s26 offen offset:1024 lds
    buffer_load_dwordx4 v226, s[8:11], s26 offen offset:2048 lds
    buffer_load_dwordx4 v227, s[8:11], s26 offen offset:3072 lds
    s_add_u32 s26, s26, 65536
    buffer_load_dwordx4 a[64:67], v228, s[12:15], s24 offen offset:0
    buffer_load_dwordx4 a[68:71], v228, s[12:15], s24 offen offset:1024
    buffer_load_dwordx4 a[72:75], v229, s[12:15], s24 offen offset:0
    buffer_load_dwordx4 a[76:79], v229, s[12:15], s24 offen offset:1024
    s_add_u32 s24, s24, 16384
    s_add_u32 m0, s25, 16384
    s_nop 0
    buffer_load_dwordx4 v224, s[8:11], s26 offen lds
    buffer_load_dwordx4 v225, s[8:11], s26 offen offset:1024 lds
    buffer_load_dwordx4 v226, s[8:11], s26 offen offset:2048 lds
    buffer_load_dwordx4 v227, s[8:11], s26 offen offset:3072 lds
    s_add_u32 s26, s26, 65536
    buffer_load_dwordx4 a[80:83], v228, s[12:15], s24 offen offset:0
    buffer_load_dwordx4 a[84:87], v228, s[12:15], s24 offen offset:1024
    buffer_load_dwordx4 a[88:91], v229, s[12:15], s24 offen offset:0
    buffer_load_dwordx4 a[92:95], v229, s[12:15], s24 offen offset:1024
    s_add_u32 s24, s24, 16384
    s_add_u32 m0, s25, 32768
    s_nop 0
    buffer_load_dwordx4 v224, s[8:11], s26 offen lds
    buffer_load_dwordx4 v225, s[8:11], s26 offen offset:1024 lds
    buffer_load_dwordx4 v226, s[8:11], s26 offen offset:2048 lds
    buffer_load_dwordx4 v227, s[8:11], s26 offen offset:3072 lds
    s_add_u32 s26, s26, 65536
    buffer_load_dwordx4 a[96:99], v228, s[12:15], s24 offen offset:0
    buffer_load_dwordx4 a[100:103], v228, s[12:15], s24 offen offset:1024
    buffer_load_dwordx4 a[104:107], v229, s[12:15], s24 offen offset:0
    buffer_load_dwordx4 a[108:111], v229, s[12:15], s24 offen offset:1024
    s_add_u32 s24, s24, 16384
    v_bfe_u32 v2, v1, 2, 2
    v_and_b32 v3, 3, v1
    v_lshrrev_b32 v4, 4, v1
    v_lshl_add_u32 v6, v4, 2, v2
    v_and_b32 v8, 7, v6
    v_lshlrev_b32 v8, 1, v8
    v_lshlrev_b32 v6, 8, v6
    v_and_b32 v7, 1, v3
    v_lshl_add_u32 v6, v7, 3, v6
    v_lshrrev_b32 v7, 1, v3
    v_add_u32 v9, 0, v7
    v_xor_b32 v9, v9, v8
    v_lshl_add_u32 v208, v9, 4, v6
    v_add_u32 v216, 65536, v208
    v_add_u32 v9, 2, v7
    v_xor_b32 v9, v9, v8
    v_lshl_add_u32 v209, v9, 4, v6
    v_add_u32 v217, 65536, v209
    v_add_u32 v9, 4, v7
    v_xor_b32 v9, v9, v8
    v_lshl_add_u32 v210, v9, 4, v6
    v_add_u32 v218, 65536, v210
    v_add_u32 v9, 6, v7
    v_xor_b32 v9, v9, v8
    v_lshl_add_u32 v211, v9, 4, v6
    v_add_u32 v219, 65536, v211
    v_add_u32 v9, 8, v7
    v_xor_b32 v9, v9, v8
    v_lshl_add_u32 v212, v9, 4, v6
    v_add_u32 v220, 65536, v212
    v_add_u32 v9, 10, v7
    v_xor_b32 v9, v9, v8
    v_lshl_add_u32 v213, v9, 4, v6
    v_add_u32 v221, 65536, v213
    v_add_u32 v9, 12, v7
    v_xor_b32 v9, v9, v8
    v_lshl_add_u32 v214, v9, 4, v6
    v_add_u32 v222, 65536, v214
    v_add_u32 v9, 14, v7
    v_xor_b32 v9, v9, v8
    v_lshl_add_u32 v215, v9, 4, v6
    v_add_u32 v223, 65536, v215
    v_mov_b32 v16, 0
    v_mov_b32 v17, 0
    v_mov_b32 v18, 0
    v_mov_b32 v19, 0
    v_mov_b32 v20, 0
    v_mov_b32 v21, 0
    v_mov_b32 v22, 0
    v_mov_b32 v23, 0
    v_mov_b32 v24, 0
    v_mov_b32 v25, 0
    v_mov_b32 v26, 0
    v_mov_b32 v27, 0
    v_mov_b32 v28, 0
    v_mov_b32 v29, 0
    v_mov_b32 v30, 0
    v_mov_b32 v31, 0
    v_mov_b32 v32, 0
    v_mov_b32 v33, 0
    v_mov_b32 v34, 0
    v_mov_b32 v35, 0
    v_mov_b32 v36, 0
    v_mov_b32 v37, 0
    v_mov_b32 v38, 0
    v_mov_b32 v39, 0
    v_mov_b32 v40, 0
    v_mov_b32 v41, 0
    v_mov_b32 v42, 0
    v_mov_b32 v43, 0
    v_mov_b32 v44, 0
    v_mov_b32 v45, 0
    v_mov_b32 v46, 0
    v_mov_b32 v47, 0
    v_mov_b32 v48, 0
    v_mov_b32 v49, 0
    v_mov_b32 v50, 0
    v_mov_b32 v51, 0
    v_mov_b32 v52, 0
    v_mov_b32 v53, 0
    v_mov_b32 v54, 0
    v_mov_b32 v55, 0
    v_mov_b32 v56, 0
    v_mov_b32 v57, 0
    v_mov_b32 v58, 0
    v_mov_b32 v59, 0
    v_mov_b32 v60, 0
    v_mov_b32 v61, 0
    v_mov_b32 v62, 0
    v_mov_b32 v63, 0
    v_mov_b32 v64, 0
    v_mov_b32 v65, 0
    v_mov_b32 v66, 0
    v_mov_b32 v67, 0
    v_mov_b32 v68, 0
    v_mov_b32 v69, 0
    v_mov_b32 v70, 0
    v_mov_b32 v71, 0
    v_mov_b32 v72, 0
    v_mov_b32 v73, 0
    v_mov_b32 v74, 0
    v_mov_b32 v75, 0
    v_mov_b32 v76, 0
    v_mov_b32 v77, 0
    v_mov_b32 v78, 0
    v_mov_b32 v79, 0
    v_mov_b32 v80, 0
    v_mov_b32 v81, 0
    v_mov_b32 v82, 0
    v_mov_b32 v83, 0
    v_mov_b32 v84, 0
    v_mov_b32 v85, 0
    v_mov_b32 v86, 0
    v_mov_b32 v87, 0
    v_mov_b32 v88, 0
    v_mov_b32 v89, 0
    v_mov_b32 v90, 0
    v_mov_b32 v91, 0
    v_mov_b32 v92, 0
    v_mov_b32 v93, 0
    v_mov_b32 v94, 0
    v_mov_b32 v95, 0
    v_mov_b32 v96, 0
    v_mov_b32 v97, 0
    v_mov_b32 v98, 0
    v_mov_b32 v99, 0
    v_mov_b32 v100, 0
    v_mov_b32 v101, 0
    v_mov_b32 v102, 0
    v_mov_b32 v103, 0
    v_mov_b32 v104, 0
    v_mov_b32 v105, 0
    v_mov_b32 v106, 0
    v_mov_b32 v107, 0
    v_mov_b32 v108, 0
    v_mov_b32 v109, 0
    v_mov_b32 v110, 0
    v_mov_b32 v111, 0
    v_mov_b32 v112, 0
    v_mov_b32 v113, 0
    v_mov_b32 v114, 0
    v_mov_b32 v115, 0
    v_mov_b32 v116, 0
    v_mov_b32 v117, 0
    v_mov_b32 v118, 0
    v_mov_b32 v119, 0
    v_mov_b32 v120, 0
    v_mov_b32 v121, 0
    v_mov_b32 v122, 0
    v_mov_b32 v123, 0
    v_mov_b32 v124, 0
    v_mov_b32 v125, 0
    v_mov_b32 v126, 0
    v_mov_b32 v127, 0
    v_mov_b32 v128, 0
    v_mov_b32 v129, 0
    v_mov_b32 v130, 0
    v_mov_b32 v131, 0
    v_mov_b32 v132, 0
    v_mov_b32 v133, 0
    v_mov_b32 v134, 0
    v_mov_b32 v135, 0
    v_mov_b32 v136, 0
    v_mov_b32 v137, 0
    v_mov_b32 v138, 0
    v_mov_b32 v139, 0
    v_mov_b32 v140, 0
    v_mov_b32 v141, 0
    v_mov_b32 v142, 0
    v_mov_b32 v143, 0
    s_mov_b32 s56, 6
    s_mov_b32 s57, 0
    s_cmp_eq_u32 s48, 2
    s_cselect_b32 s56, 4, s56
    s_cselect_b32 s57, 2, s57
    s_cmp_eq_u32 s48, 3
    s_cselect_b32 s56, 0, s56
    s_cselect_b32 s57, 5, s57
    s_waitcnt vmcnt(20)
    s_barrier
    ds_read_b64_tr_b16 a[0:1], v208 offset:0
    ds_read_b64_tr_b16 a[2:3], v208 offset:4096
    ds_read_b64_tr_b16 a[4:5], v209 offset:0
    ds_read_b64_tr_b16 a[6:7], v209 offset:4096
    ds_read_b64_tr_b16 a[8:9], v210 offset:0
    ds_read_b64_tr_b16 a[10:11], v210 offset:4096
    ds_read_b64_tr_b16 a[12:13], v211 offset:0
    ds_read_b64_tr_b16 a[14:15], v211 offset:4096
    ds_read_b64_tr_b16 a[16:17], v212 offset:0
    ds_read_b64_tr_b16 a[18:19], v212 offset:4096
    ds_read_b64_tr_b16 a[20:21], v213 offset:0
    ds_read_b64_tr_b16 a[22:23], v213 offset:4096
    ds_read_b64_tr_b16 a[24:25], v214 offset:0
    ds_read_b64_tr_b16 a[26:27], v214 offset:4096
    ds_read_b64_tr_b16 a[28:29], v215 offset:0
    ds_read_b64_tr_b16 a[30:31], v215 offset:4096
    ds_read_b64_tr_b16 a[32:33], v208 offset:8192
    ds_read_b64_tr_b16 a[34:35], v208 offset:12288
    ds_read_b64_tr_b16 a[36:37], v209 offset:8192
    ds_read_b64_tr_b16 a[38:39], v209 offset:12288
    ds_read_b64_tr_b16 a[40:41], v210 offset:8192
    ds_read_b64_tr_b16 a[42:43], v210 offset:12288
    ds_read_b64_tr_b16 a[44:45], v211 offset:8192
    ds_read_b64_tr_b16 a[46:47], v211 offset:12288
    ds_read_b64_tr_b16 a[48:49], v212 offset:8192
    ds_read_b64_tr_b16 a[50:51], v212 offset:12288
    ds_read_b64_tr_b16 a[52:53], v213 offset:8192
    ds_read_b64_tr_b16 a[54:55], v213 offset:12288
    ds_read_b64_tr_b16 a[56:57], v214 offset:8192
    ds_read_b64_tr_b16 a[58:59], v214 offset:12288
    ds_read_b64_tr_b16 a[60:61], v215 offset:8192
    ds_read_b64_tr_b16 a[62:63], v215 offset:12288
    s_cmp_eq_u32 s56, 0
    s_cbranch_scc1 K3_l1pre
K3_loop0:
    s_waitcnt vmcnt(8) lgkmcnt(15)
    s_barrier
    v_mfma_f32_16x16x32_bf16 v[16:19], a[0:3], a[64:67], v[16:19]
    buffer_load_dwordx4 a[112:115], v228, s[12:15], s24 offen offset:0
    v_mfma_f32_16x16x32_bf16 v[20:23], a[0:3], a[68:71], v[20:23]
    buffer_load_dwordx4 a[116:119], v228, s[12:15], s24 offen offset:1024
    v_mfma_f32_16x16x32_bf16 v[24:27], a[4:7], a[64:67], v[24:27]
    ds_read_b64_tr_b16 a[0:1], v208 offset:16384
    v_mfma_f32_16x16x32_bf16 v[28:31], a[4:7], a[68:71], v[28:31]
    ds_read_b64_tr_b16 a[2:3], v208 offset:20480
    v_mfma_f32_16x16x32_bf16 v[32:35], a[8:11], a[64:67], v[32:35]
    ds_read_b64_tr_b16 a[4:5], v209 offset:16384
    v_mfma_f32_16x16x32_bf16 v[36:39], a[8:11], a[68:71], v[36:39]
    ds_read_b64_tr_b16 a[6:7], v209 offset:20480
    buffer_load_dwordx4 a[120:123], v229, s[12:15], s24 offen offset:0
    v_mfma_f32_16x16x32_bf16 v[40:43], a[12:15], a[64:67], v[40:43]
    ds_read_b64_tr_b16 a[8:9], v210 offset:16384
    v_mfma_f32_16x16x32_bf16 v[44:47], a[12:15], a[68:71], v[44:47]
    ds_read_b64_tr_b16 a[10:11], v210 offset:20480
    v_mfma_f32_16x16x32_bf16 v[48:51], a[16:19], a[64:67], v[48:51]
    ds_read_b64_tr_b16 a[12:13], v211 offset:16384
    buffer_load_dwordx4 a[124:127], v229, s[12:15], s24 offen offset:1024
    v_mfma_f32_16x16x32_bf16 v[52:55], a[16:19], a[68:71], v[52:55]
    ds_read_b64_tr_b16 a[14:15], v211 offset:20480
    s_add_u32 s24, s24, 16384
    v_mfma_f32_16x16x32_bf16 v[56:59], a[20:23], a[64:67], v[56:59]
    ds_read_b64_tr_b16 a[16:17], v212 offset:16384
    v_mfma_f32_16x16x32_bf16 v[60:63], a[20:23], a[68:71], v[60:63]
    ds_read_b64_tr_b16 a[18:19], v212 offset:20480
    s_add_u32 m0, s25, 49152
    v_mfma_f32_16x16x32_bf16 v[64:67], a[24:27], a[64:67], v[64:67]
    ds_read_b64_tr_b16 a[20:21], v213 offset:16384
    buffer_load_dwordx4 v224, s[8:11], s26 offen lds
    v_mfma_f32_16x16x32_bf16 v[68:71], a[24:27], a[68:71], v[68:71]
    ds_read_b64_tr_b16 a[22:23], v213 offset:20480
    v_mfma_f32_16x16x32_bf16 v[72:75], a[28:31], a[64:67], v[72:75]
    ds_read_b64_tr_b16 a[24:25], v214 offset:16384
    v_mfma_f32_16x16x32_bf16 v[76:79], a[28:31], a[68:71], v[76:79]
    ds_read_b64_tr_b16 a[26:27], v214 offset:20480
    s_waitcnt lgkmcnt(14)
    v_mfma_f32_16x16x32_bf16 v[16:19], a[32:35], a[72:75], v[16:19]
    ds_read_b64_tr_b16 a[28:29], v215 offset:16384
    buffer_load_dwordx4 v225, s[8:11], s26 offen offset:1024 lds
    v_mfma_f32_16x16x32_bf16 v[20:23], a[32:35], a[76:79], v[20:23]
    ds_read_b64_tr_b16 a[30:31], v215 offset:20480
    v_mfma_f32_16x16x32_bf16 v[24:27], a[36:39], a[72:75], v[24:27]
    ds_read_b64_tr_b16 a[32:33], v208 offset:24576
    v_mfma_f32_16x16x32_bf16 v[28:31], a[36:39], a[76:79], v[28:31]
    ds_read_b64_tr_b16 a[34:35], v208 offset:28672
    v_mfma_f32_16x16x32_bf16 v[32:35], a[40:43], a[72:75], v[32:35]
    ds_read_b64_tr_b16 a[36:37], v209 offset:24576
    buffer_load_dwordx4 v226, s[8:11], s26 offen offset:2048 lds
    v_mfma_f32_16x16x32_bf16 v[36:39], a[40:43], a[76:79], v[36:39]
    ds_read_b64_tr_b16 a[38:39], v209 offset:28672
    v_mfma_f32_16x16x32_bf16 v[40:43], a[44:47], a[72:75], v[40:43]
    ds_read_b64_tr_b16 a[40:41], v210 offset:24576
    v_mfma_f32_16x16x32_bf16 v[44:47], a[44:47], a[76:79], v[44:47]
    ds_read_b64_tr_b16 a[42:43], v210 offset:28672
    v_mfma_f32_16x16x32_bf16 v[48:51], a[48:51], a[72:75], v[48:51]
    ds_read_b64_tr_b16 a[44:45], v211 offset:24576
    buffer_load_dwordx4 v227, s[8:11], s26 offen offset:3072 lds
    v_mfma_f32_16x16x32_bf16 v[52:55], a[48:51], a[76:79], v[52:55]
    ds_read_b64_tr_b16 a[46:47], v211 offset:28672
    v_mfma_f32_16x16x32_bf16 v[56:59], a[52:55], a[72:75], v[56:59]
    ds_read_b64_tr_b16 a[48:49], v212 offset:24576
    s_add_u32 s26, s26, 65536
    v_mfma_f32_16x16x32_bf16 v[60:63], a[52:55], a[76:79], v[60:63]
    ds_read_b64_tr_b16 a[50:51], v212 offset:28672
    v_mfma_f32_16x16x32_bf16 v[64:67], a[56:59], a[72:75], v[64:67]
    ds_read_b64_tr_b16 a[52:53], v213 offset:24576
    v_mfma_f32_16x16x32_bf16 v[68:71], a[56:59], a[76:79], v[68:71]
    ds_read_b64_tr_b16 a[54:55], v213 offset:28672
    v_mfma_f32_16x16x32_bf16 v[72:75], a[60:63], a[72:75], v[72:75]
    ds_read_b64_tr_b16 a[56:57], v214 offset:24576
    v_mfma_f32_16x16x32_bf16 v[76:79], a[60:63], a[76:79], v[76:79]
    ds_read_b64_tr_b16 a[58:59], v214 offset:28672
    ds_read_b64_tr_b16 a[60:61], v215 offset:24576
    ds_read_b64_tr_b16 a[62:63], v215 offset:28672
    s_waitcnt vmcnt(8) lgkmcnt(15)
    s_barrier
    v_mfma_f32_16x16x32_bf16 v[16:19], a[0:3], a[80:83], v[16:19]
    buffer_load_dwordx4 a[64:67], v228, s[12:15], s24 offen offset:0
    s_cmp_lt_u32 s19, 64
    v_mfma_f32_16x16x32_bf16 v[20:23], a[0:3], a[84:87], v[20:23]
    buffer_load_dwordx4 a[68:71], v228, s[12:15], s24 offen offset:1024
    s_cselect_b32 s8, s40, s42
    v_mfma_f32_16x16x32_bf16 v[24:27], a[4:7], a[80:83], v[24:27]
    ds_read_b64_tr_b16 a[0:1], v208 offset:32768
    s_cselect_b32 s9, s41, s43
    v_mfma_f32_16x16x32_bf16 v[28:31], a[4:7], a[84:87], v[28:31]
    ds_read_b64_tr_b16 a[2:3], v208 offset:36864
    s_add_u32 s19, s19, 4
    v_mfma_f32_16x16x32_bf16 v[32:35], a[8:11], a[80:83], v[32:35]
    ds_read_b64_tr_b16 a[4:5], v209 offset:32768
    v_mfma_f32_16x16x32_bf16 v[36:39], a[8:11], a[84:87], v[36:39]
    ds_read_b64_tr_b16 a[6:7], v209 offset:36864
    buffer_load_dwordx4 a[72:75], v229, s[12:15], s24 offen offset:0
    v_mfma_f32_16x16x32_bf16 v[40:43], a[12:15], a[80:83], v[40:43]
    ds_read_b64_tr_b16 a[8:9], v210 offset:32768
    v_mfma_f32_16x16x32_bf16 v[44:47], a[12:15], a[84:87], v[44:47]
    ds_read_b64_tr_b16 a[10:11], v210 offset:36864
    v_mfma_f32_16x16x32_bf16 v[48:51], a[16:19], a[80:83], v[48:51]
    ds_read_b64_tr_b16 a[12:13], v211 offset:32768
    buffer_load_dwordx4 a[76:79], v229, s[12:15], s24 offen offset:1024
    v_mfma_f32_16x16x32_bf16 v[52:55], a[16:19], a[84:87], v[52:55]
    ds_read_b64_tr_b16 a[14:15], v211 offset:36864
    s_add_u32 s24, s24, 16384
    v_mfma_f32_16x16x32_bf16 v[56:59], a[20:23], a[80:83], v[56:59]
    ds_read_b64_tr_b16 a[16:17], v212 offset:32768
    v_mfma_f32_16x16x32_bf16 v[60:63], a[20:23], a[84:87], v[60:63]
    ds_read_b64_tr_b16 a[18:19], v212 offset:36864
    s_add_u32 m0, s25, 0
    v_mfma_f32_16x16x32_bf16 v[64:67], a[24:27], a[80:83], v[64:67]
    ds_read_b64_tr_b16 a[20:21], v213 offset:32768
    buffer_load_dwordx4 v224, s[8:11], s26 offen lds
    v_mfma_f32_16x16x32_bf16 v[68:71], a[24:27], a[84:87], v[68:71]
    ds_read_b64_tr_b16 a[22:23], v213 offset:36864
    v_mfma_f32_16x16x32_bf16 v[72:75], a[28:31], a[80:83], v[72:75]
    ds_read_b64_tr_b16 a[24:25], v214 offset:32768
    v_mfma_f32_16x16x32_bf16 v[76:79], a[28:31], a[84:87], v[76:79]
    ds_read_b64_tr_b16 a[26:27], v214 offset:36864
    s_waitcnt lgkmcnt(14)
    v_mfma_f32_16x16x32_bf16 v[16:19], a[32:35], a[88:91], v[16:19]
    ds_read_b64_tr_b16 a[28:29], v215 offset:32768
    buffer_load_dwordx4 v225, s[8:11], s26 offen offset:1024 lds
    v_mfma_f32_16x16x32_bf16 v[20:23], a[32:35], a[92:95], v[20:23]
    ds_read_b64_tr_b16 a[30:31], v215 offset:36864
    v_mfma_f32_16x16x32_bf16 v[24:27], a[36:39], a[88:91], v[24:27]
    ds_read_b64_tr_b16 a[32:33], v208 offset:40960
    v_mfma_f32_16x16x32_bf16 v[28:31], a[36:39], a[92:95], v[28:31]
    ds_read_b64_tr_b16 a[34:35], v208 offset:45056
    v_mfma_f32_16x16x32_bf16 v[32:35], a[40:43], a[88:91], v[32:35]
    ds_read_b64_tr_b16 a[36:37], v209 offset:40960
    buffer_load_dwordx4 v226, s[8:11], s26 offen offset:2048 lds
    v_mfma_f32_16x16x32_bf16 v[36:39], a[40:43], a[92:95], v[36:39]
    ds_read_b64_tr_b16 a[38:39], v209 offset:45056
    v_mfma_f32_16x16x32_bf16 v[40:43], a[44:47], a[88:91], v[40:43]
    ds_read_b64_tr_b16 a[40:41], v210 offset:40960
    v_mfma_f32_16x16x32_bf16 v[44:47], a[44:47], a[92:95], v[44:47]
    ds_read_b64_tr_b16 a[42:43], v210 offset:45056
    v_mfma_f32_16x16x32_bf16 v[48:51], a[48:51], a[88:91], v[48:51]
    ds_read_b64_tr_b16 a[44:45], v211 offset:40960
    buffer_load_dwordx4 v227, s[8:11], s26 offen offset:3072 lds
    v_mfma_f32_16x16x32_bf16 v[52:55], a[48:51], a[92:95], v[52:55]
    ds_read_b64_tr_b16 a[46:47], v211 offset:45056
    v_mfma_f32_16x16x32_bf16 v[56:59], a[52:55], a[88:91], v[56:59]
    ds_read_b64_tr_b16 a[48:49], v212 offset:40960
    s_add_u32 s26, s26, 65536
    v_mfma_f32_16x16x32_bf16 v[60:63], a[52:55], a[92:95], v[60:63]
    ds_read_b64_tr_b16 a[50:51], v212 offset:45056
    v_mfma_f32_16x16x32_bf16 v[64:67], a[56:59], a[88:91], v[64:67]
    ds_read_b64_tr_b16 a[52:53], v213 offset:40960
    v_mfma_f32_16x16x32_bf16 v[68:71], a[56:59], a[92:95], v[68:71]
    ds_read_b64_tr_b16 a[54:55], v213 offset:45056
    v_mfma_f32_16x16x32_bf16 v[72:75], a[60:63], a[88:91], v[72:75]
    ds_read_b64_tr_b16 a[56:57], v214 offset:40960
    v_mfma_f32_16x16x32_bf16 v[76:79], a[60:63], a[92:95], v[76:79]
    ds_read_b64_tr_b16 a[58:59], v214 offset:45056
    ds_read_b64_tr_b16 a[60:61], v215 offset:40960
    ds_read_b64_tr_b16 a[62:63], v215 offset:45056
    s_waitcnt vmcnt(8) lgkmcnt(15)
    s_barrier
    v_mfma_f32_16x16x32_bf16 v[16:19], a[0:3], a[96:99], v[16:19]
    buffer_load_dwordx4 a[80:83], v228, s[12:15], s24 offen offset:0
    v_mfma_f32_16x16x32_bf16 v[20:23], a[0:3], a[100:103], v[20:23]
    buffer_load_dwordx4 a[84:87], v228, s[12:15], s24 offen offset:1024
    v_mfma_f32_16x16x32_bf16 v[24:27], a[4:7], a[96:99], v[24:27]
    ds_read_b64_tr_b16 a[0:1], v208 offset:49152
    v_mfma_f32_16x16x32_bf16 v[28:31], a[4:7], a[100:103], v[28:31]
    ds_read_b64_tr_b16 a[2:3], v208 offset:53248
    v_mfma_f32_16x16x32_bf16 v[32:35], a[8:11], a[96:99], v[32:35]
    ds_read_b64_tr_b16 a[4:5], v209 offset:49152
    v_mfma_f32_16x16x32_bf16 v[36:39], a[8:11], a[100:103], v[36:39]
    ds_read_b64_tr_b16 a[6:7], v209 offset:53248
    buffer_load_dwordx4 a[88:91], v229, s[12:15], s24 offen offset:0
    v_mfma_f32_16x16x32_bf16 v[40:43], a[12:15], a[96:99], v[40:43]
    ds_read_b64_tr_b16 a[8:9], v210 offset:49152
    v_mfma_f32_16x16x32_bf16 v[44:47], a[12:15], a[100:103], v[44:47]
    ds_read_b64_tr_b16 a[10:11], v210 offset:53248
    v_mfma_f32_16x16x32_bf16 v[48:51], a[16:19], a[96:99], v[48:51]
    ds_read_b64_tr_b16 a[12:13], v211 offset:49152
    buffer_load_dwordx4 a[92:95], v229, s[12:15], s24 offen offset:1024
    v_mfma_f32_16x16x32_bf16 v[52:55], a[16:19], a[100:103], v[52:55]
    ds_read_b64_tr_b16 a[14:15], v211 offset:53248
    s_add_u32 s24, s24, 16384
    v_mfma_f32_16x16x32_bf16 v[56:59], a[20:23], a[96:99], v[56:59]
    ds_read_b64_tr_b16 a[16:17], v212 offset:49152
    v_mfma_f32_16x16x32_bf16 v[60:63], a[20:23], a[100:103], v[60:63]
    ds_read_b64_tr_b16 a[18:19], v212 offset:53248
    s_add_u32 m0, s25, 16384
    v_mfma_f32_16x16x32_bf16 v[64:67], a[24:27], a[96:99], v[64:67]
    ds_read_b64_tr_b16 a[20:21], v213 offset:49152
    buffer_load_dwordx4 v224, s[8:11], s26 offen lds
    v_mfma_f32_16x16x32_bf16 v[68:71], a[24:27], a[100:103], v[68:71]
    ds_read_b64_tr_b16 a[22:23], v213 offset:53248
    v_mfma_f32_16x16x32_bf16 v[72:75], a[28:31], a[96:99], v[72:75]
    ds_read_b64_tr_b16 a[24:25], v214 offset:49152
    v_mfma_f32_16x16x32_bf16 v[76:79], a[28:31], a[100:103], v[76:79]
    ds_read_b64_tr_b16 a[26:27], v214 offset:53248
    s_waitcnt lgkmcnt(14)
    v_mfma_f32_16x16x32_bf16 v[16:19], a[32:35], a[104:107], v[16:19]
    ds_read_b64_tr_b16 a[28:29], v215 offset:49152
    buffer_load_dwordx4 v225, s[8:11], s26 offen offset:1024 lds
    v_mfma_f32_16x16x32_bf16 v[20:23], a[32:35], a[108:111], v[20:23]
    ds_read_b64_tr_b16 a[30:31], v215 offset:53248
    v_mfma_f32_16x16x32_bf16 v[24:27], a[36:39], a[104:107], v[24:27]
    ds_read_b64_tr_b16 a[32:33], v208 offset:57344
    v_mfma_f32_16x16x32_bf16 v[28:31], a[36:39], a[108:111], v[28:31]
    ds_read_b64_tr_b16 a[34:35], v208 offset:61440
    v_mfma_f32_16x16x32_bf16 v[32:35], a[40:43], a[104:107], v[32:35]
    ds_read_b64_tr_b16 a[36:37], v209 offset:57344
    buffer_load_dwordx4 v226, s[8:11], s26 offen offset:2048 lds
    v_mfma_f32_16x16x32_bf16 v[36:39], a[40:43], a[108:111], v[36:39]
    ds_read_b64_tr_b16 a[38:39], v209 offset:61440
    v_mfma_f32_16x16x32_bf16 v[40:43], a[44:47], a[104:107], v[40:43]
    ds_read_b64_tr_b16 a[40:41], v210 offset:57344
    v_mfma_f32_16x16x32_bf16 v[44:47], a[44:47], a[108:111], v[44:47]
    ds_read_b64_tr_b16 a[42:43], v210 offset:61440
    v_mfma_f32_16x16x32_bf16 v[48:51], a[48:51], a[104:107], v[48:51]
    ds_read_b64_tr_b16 a[44:45], v211 offset:57344
    buffer_load_dwordx4 v227, s[8:11], s26 offen offset:3072 lds
    v_mfma_f32_16x16x32_bf16 v[52:55], a[48:51], a[108:111], v[52:55]
    ds_read_b64_tr_b16 a[46:47], v211 offset:61440
    v_mfma_f32_16x16x32_bf16 v[56:59], a[52:55], a[104:107], v[56:59]
    ds_read_b64_tr_b16 a[48:49], v212 offset:57344
    s_add_u32 s26, s26, 65536
    v_mfma_f32_16x16x32_bf16 v[60:63], a[52:55], a[108:111], v[60:63]
    ds_read_b64_tr_b16 a[50:51], v212 offset:61440
    v_mfma_f32_16x16x32_bf16 v[64:67], a[56:59], a[104:107], v[64:67]
    ds_read_b64_tr_b16 a[52:53], v213 offset:57344
    v_mfma_f32_16x16x32_bf16 v[68:71], a[56:59], a[108:111], v[68:71]
    ds_read_b64_tr_b16 a[54:55], v213 offset:61440
    v_mfma_f32_16x16x32_bf16 v[72:75], a[60:63], a[104:107], v[72:75]
    ds_read_b64_tr_b16 a[56:57], v214 offset:57344
    v_mfma_f32_16x16x32_bf16 v[76:79], a[60:63], a[108:111], v[76:79]
    ds_read_b64_tr_b16 a[58:59], v214 offset:61440
    ds_read_b64_tr_b16 a[60:61], v215 offset:57344
    ds_read_b64_tr_b16 a[62:63], v215 offset:61440
    s_waitcnt vmcnt(8) lgkmcnt(15)
    s_barrier
    v_mfma_f32_16x16x32_bf16 v[16:19], a[0:3], a[112:115], v[16:19]
    buffer_load_dwordx4 a[96:99], v228, s[12:15], s24 offen offset:0
    v_mfma_f32_16x16x32_bf16 v[20:23], a[0:3], a[116:119], v[20:23]
    buffer_load_dwordx4 a[100:103], v228, s[12:15], s24 offen offset:1024
    v_mfma_f32_16x16x32_bf16 v[24:27], a[4:7], a[112:115], v[24:27]
    ds_read_b64_tr_b16 a[0:1], v208 offset:0
    v_mfma_f32_16x16x32_bf16 v[28:31], a[4:7], a[116:119], v[28:31]
    ds_read_b64_tr_b16 a[2:3], v208 offset:4096
    v_mfma_f32_16x16x32_bf16 v[32:35], a[8:11], a[112:115], v[32:35]
    ds_read_b64_tr_b16 a[4:5], v209 offset:0
    v_mfma_f32_16x16x32_bf16 v[36:39], a[8:11], a[116:119], v[36:39]
    ds_read_b64_tr_b16 a[6:7], v209 offset:4096
    buffer_load_dwordx4 a[104:107], v229, s[12:15], s24 offen offset:0
    v_mfma_f32_16x16x32_bf16 v[40:43], a[12:15], a[112:115], v[40:43]
    ds_read_b64_tr_b16 a[8:9], v210 offset:0
    v_mfma_f32_16x16x32_bf16 v[44:47], a[12:15], a[116:119], v[44:47]
    ds_read_b64_tr_b16 a[10:11], v210 offset:4096
    v_mfma_f32_16x16x32_bf16 v[48:51], a[16:19], a[112:115], v[48:51]
    ds_read_b64_tr_b16 a[12:13], v211 offset:0
    buffer_load_dwordx4 a[108:111], v229, s[12:15], s24 offen offset:1024
    v_mfma_f32_16x16x32_bf16 v[52:55], a[16:19], a[116:119], v[52:55]
    ds_read_b64_tr_b16 a[14:15], v211 offset:4096
    s_add_u32 s24, s24, 16384
    v_mfma_f32_16x16x32_bf16 v[56:59], a[20:23], a[112:115], v[56:59]
    ds_read_b64_tr_b16 a[16:17], v212 offset:0
    v_mfma_f32_16x16x32_bf16 v[60:63], a[20:23], a[116:119], v[60:63]
    ds_read_b64_tr_b16 a[18:19], v212 offset:4096
    s_add_u32 m0, s25, 32768
    v_mfma_f32_16x16x32_bf16 v[64:67], a[24:27], a[112:115], v[64:67]
    ds_read_b64_tr_b16 a[20:21], v213 offset:0
    buffer_load_dwordx4 v224, s[8:11], s26 offen lds
    v_mfma_f32_16x16x32_bf16 v[68:71], a[24:27], a[116:119], v[68:71]
    ds_read_b64_tr_b16 a[22:23], v213 offset:4096
    v_mfma_f32_16x16x32_bf16 v[72:75], a[28:31], a[112:115], v[72:75]
    ds_read_b64_tr_b16 a[24:25], v214 offset:0
    v_mfma_f32_16x16x32_bf16 v[76:79], a[28:31], a[116:119], v[76:79]
    ds_read_b64_tr_b16 a[26:27], v214 offset:4096
    s_waitcnt lgkmcnt(14)
    v_mfma_f32_16x16x32_bf16 v[16:19], a[32:35], a[120:123], v[16:19]
    ds_read_b64_tr_b16 a[28:29], v215 offset:0
    buffer_load_dwordx4 v225, s[8:11], s26 offen offset:1024 lds
    v_mfma_f32_16x16x32_bf16 v[20:23], a[32:35], a[124:127], v[20:23]
    ds_read_b64_tr_b16 a[30:31], v215 offset:4096
    v_mfma_f32_16x16x32_bf16 v[24:27], a[36:39], a[120:123], v[24:27]
    ds_read_b64_tr_b16 a[32:33], v208 offset:8192
    v_mfma_f32_16x16x32_bf16 v[28:31], a[36:39], a[124:127], v[28:31]
    ds_read_b64_tr_b16 a[34:35], v208 offset:12288
    v_mfma_f32_16x16x32_bf16 v[32:35], a[40:43], a[120:123], v[32:35]
    ds_read_b64_tr_b16 a[36:37], v209 offset:8192
    buffer_load_dwordx4 v226, s[8:11], s26 offen offset:2048 lds
    v_mfma_f32_16x16x32_bf16 v[36:39], a[40:43], a[124:127], v[36:39]
    ds_read_b64_tr_b16 a[38:39], v209 offset:12288
    v_mfma_f32_16x16x32_bf16 v[40:43], a[44:47], a[120:123], v[40:43]
    ds_read_b64_tr_b16 a[40:41], v210 offset:8192
    v_mfma_f32_16x16x32_bf16 v[44:47], a[44:47], a[124:127], v[44:47]
    ds_read_b64_tr_b16 a[42:43], v210 offset:12288
    v_mfma_f32_16x16x32_bf16 v[48:51], a[48:51], a[120:123], v[48:51]
    ds_read_b64_tr_b16 a[44:45], v211 offset:8192
    buffer_load_dwordx4 v227, s[8:11], s26 offen offset:3072 lds
    v_mfma_f32_16x16x32_bf16 v[52:55], a[48:51], a[124:127], v[52:55]
    ds_read_b64_tr_b16 a[46:47], v211 offset:12288
    v_mfma_f32_16x16x32_bf16 v[56:59], a[52:55], a[120:123], v[56:59]
    ds_read_b64_tr_b16 a[48:49], v212 offset:8192
    s_add_u32 s26, s26, 65536
    v_mfma_f32_16x16x32_bf16 v[60:63], a[52:55], a[124:127], v[60:63]
    ds_read_b64_tr_b16 a[50:51], v212 offset:12288
    v_mfma_f32_16x16x32_bf16 v[64:67], a[56:59], a[120:123], v[64:67]
    ds_read_b64_tr_b16 a[52:53], v213 offset:8192
    v_mfma_f32_16x16x32_bf16 v[68:71], a[56:59], a[124:127], v[68:71]
    ds_read_b64_tr_b16 a[54:55], v213 offset:12288
    v_mfma_f32_16x16x32_bf16 v[72:75], a[60:63], a[120:123], v[72:75]
    ds_read_b64_tr_b16 a[56:57], v214 offset:8192
    v_mfma_f32_16x16x32_bf16 v[76:79], a[60:63], a[124:127], v[76:79]
    ds_read_b64_tr_b16 a[58:59], v214 offset:12288
    ds_read_b64_tr_b16 a[60:61], v215 offset:8192
    ds_read_b64_tr_b16 a[62:63], v215 offset:12288
    s_sub_u32 s56, s56, 1
    s_cmp_lg_u32 s56, 0
    s_cbranch_scc1 K3_loop0
K3_l1pre:
    s_cmp_eq_u32 s57, 0
    s_cbranch_scc1 K3_post
K3_loop1:
    s_waitcnt vmcnt(8) lgkmcnt(15)
    s_barrier
    v_mfma_f32_16x16x32_bf16 v[80:83], a[0:3], a[64:67], v[80:83]
    buffer_load_dwordx4 a[112:115], v228, s[12:15], s24 offen offset:0
    v_mfma_f32_16x16x32_bf16 v[84:87], a[0:3], a[68:71], v[84:87]
    buffer_load_dwordx4 a[116:119], v228, s[12:15], s24 offen offset:1024
    v_mfma_f32_16x16x32_bf16 v[88:91], a[4:7], a[64:67], v[88:91]
    ds_read_b64_tr_b16 a[0:1], v208 offset:16384
    v_mfma_f32_16x16x32_bf16 v[92:95], a[4:7], a[68:71], v[92:95]
    ds_read_b64_tr_b16 a[2:3], v208 offset:20480
    v_mfma_f32_16x16x32_bf16 v[96:99], a[8:11], a[64:67], v[96:99]
    ds_read_b64_tr_b16 a[4:5], v209 offset:16384
    v_mfma_f32_16x16x32_bf16 v[100:103], a[8:11], a[68:71], v[100:103]
    ds_read_b64_tr_b16 a[6:7], v209 offset:20480
    buffer_load_dwordx4 a[120:123], v229, s[12:15], s24 offen offset:0
    v_mfma_f32_16x16x32_bf16 v[104:107], a[12:15], a[64:67], v[104:107]
    ds_read_b64_tr_b16 a[8:9], v210 offset:16384
    v_mfma_f32_16x16x32_bf16 v[108:111], a[12:15], a[68:71], v[108:111]
    ds_read_b64_tr_b16 a[10:11], v210 offset:20480
    v_mfma_f32_16x16x32_bf16 v[112:115], a[16:19], a[64:67], v[112:115]
    ds_read_b64_tr_b16 a[12:13], v211 offset:16384
    buffer_load_dwordx4 a[124:127], v229, s[12:15], s24 offen offset:1024
    v_mfma_f32_16x16x32_bf16 v[116:119], a[16:19], a[68:71], v[116:119]
    ds_read_b64_tr_b16 a[14:15], v211 offset:20480
    s_add_u32 s24, s24, 16384
    v_mfma_f32_16x16x32_bf16 v[120:123], a[20:23], a[64:67], v[120:123]
    ds_read_b64_tr_b16 a[16:17], v212 offset:16384
    v_mfma_f32_16x16x32_bf16 v[124:127], a[20:23], a[68:71], v[124:127]
    ds_read_b64_tr_b16 a[18:19], v212 offset:20480
    s_add_u32 m0, s25, 49152
    v_mfma_f32_16x16x32_bf16 v[128:131], a[24:27], a[64:67], v[128:131]
    ds_read_b64_tr_b16 a[20:21], v213 offset:16384
    buffer_load_dwordx4 v224, s[8:11], s26 offen lds
    v_mfma_f32_16x16x32_bf16 v[132:135], a[24:27], a[68:71], v[132:135]
    ds_read_b64_tr_b16 a[22:23], v213 offset:20480
    v_mfma_f32_16x16x32_bf16 v[136:139], a[28:31], a[64:67], v[136:139]
    ds_read_b64_tr_b16 a[24:25], v214 offset:16384
    v_mfma_f32_16x16x32_bf16 v[140:143], a[28:31], a[68:71], v[140:143]
    ds_read_b64_tr_b16 a[26:27], v214 offset:20480
    s_waitcnt lgkmcnt(14)
    v_mfma_f32_16x16x32_bf16 v[80:83], a[32:35], a[72:75], v[80:83]
    ds_read_b64_tr_b16 a[28:29], v215 offset:16384
    buffer_load_dwordx4 v225, s[8:11], s26 offen offset:1024 lds
    v_mfma_f32_16x16x32_bf16 v[84:87], a[32:35], a[76:79], v[84:87]
    ds_read_b64_tr_b16 a[30:31], v215 offset:20480
    v_mfma_f32_16x16x32_bf16 v[88:91], a[36:39], a[72:75], v[88:91]
    ds_read_b64_tr_b16 a[32:33], v208 offset:24576
    v_mfma_f32_16x16x32_bf16 v[92:95], a[36:39], a[76:79], v[92:95]
    ds_read_b64_tr_b16 a[34:35], v208 offset:28672
    v_mfma_f32_16x16x32_bf16 v[96:99], a[40:43], a[72:75], v[96:99]
    ds_read_b64_tr_b16 a[36:37], v209 offset:24576
    buffer_load_dwordx4 v226, s[8:11], s26 offen offset:2048 lds
    v_mfma_f32_16x16x32_bf16 v[100:103], a[40:43], a[76:79], v[100:103]
    ds_read_b64_tr_b16 a[38:39], v209 offset:28672
    v_mfma_f32_16x16x32_bf16 v[104:107], a[44:47], a[72:75], v[104:107]
    ds_read_b64_tr_b16 a[40:41], v210 offset:24576
    v_mfma_f32_16x16x32_bf16 v[108:111], a[44:47], a[76:79], v[108:111]
    ds_read_b64_tr_b16 a[42:43], v210 offset:28672
    v_mfma_f32_16x16x32_bf16 v[112:115], a[48:51], a[72:75], v[112:115]
    ds_read_b64_tr_b16 a[44:45], v211 offset:24576
    buffer_load_dwordx4 v227, s[8:11], s26 offen offset:3072 lds
    v_mfma_f32_16x16x32_bf16 v[116:119], a[48:51], a[76:79], v[116:119]
    ds_read_b64_tr_b16 a[46:47], v211 offset:28672
    v_mfma_f32_16x16x32_bf16 v[120:123], a[52:55], a[72:75], v[120:123]
    ds_read_b64_tr_b16 a[48:49], v212 offset:24576
    s_add_u32 s26, s26, 65536
    v_mfma_f32_16x16x32_bf16 v[124:127], a[52:55], a[76:79], v[124:127]
    ds_read_b64_tr_b16 a[50:51], v212 offset:28672
    v_mfma_f32_16x16x32_bf16 v[128:131], a[56:59], a[72:75], v[128:131]
    ds_read_b64_tr_b16 a[52:53], v213 offset:24576
    v_mfma_f32_16x16x32_bf16 v[132:135], a[56:59], a[76:79], v[132:135]
    ds_read_b64_tr_b16 a[54:55], v213 offset:28672
    v_mfma_f32_16x16x32_bf16 v[136:139], a[60:63], a[72:75], v[136:139]
    ds_read_b64_tr_b16 a[56:57], v214 offset:24576
    v_mfma_f32_16x16x32_bf16 v[140:143], a[60:63], a[76:79], v[140:143]
    ds_read_b64_tr_b16 a[58:59], v214 offset:28672
    ds_read_b64_tr_b16 a[60:61], v215 offset:24576
    ds_read_b64_tr_b16 a[62:63], v215 offset:28672
    s_waitcnt vmcnt(8) lgkmcnt(15)
    s_barrier
    v_mfma_f32_16x16x32_bf16 v[80:83], a[0:3], a[80:83], v[80:83]
    buffer_load_dwordx4 a[64:67], v228, s[12:15], s24 offen offset:0
    s_cmp_lt_u32 s19, 64
    v_mfma_f32_16x16x32_bf16 v[84:87], a[0:3], a[84:87], v[84:87]
    buffer_load_dwordx4 a[68:71], v228, s[12:15], s24 offen offset:1024
    s_cselect_b32 s8, s40, s42
    v_mfma_f32_16x16x32_bf16 v[88:91], a[4:7], a[80:83], v[88:91]
    ds_read_b64_tr_b16 a[0:1], v208 offset:32768
    s_cselect_b32 s9, s41, s43
    v_mfma_f32_16x16x32_bf16 v[92:95], a[4:7], a[84:87], v[92:95]
    ds_read_b64_tr_b16 a[2:3], v208 offset:36864
    s_add_u32 s19, s19, 4
    v_mfma_f32_16x16x32_bf16 v[96:99], a[8:11], a[80:83], v[96:99]
    ds_read_b64_tr_b16 a[4:5], v209 offset:32768
    v_mfma_f32_16x16x32_bf16 v[100:103], a[8:11], a[84:87], v[100:103]
    ds_read_b64_tr_b16 a[6:7], v209 offset:36864
    buffer_load_dwordx4 a[72:75], v229, s[12:15], s24 offen offset:0
    v_mfma_f32_16x16x32_bf16 v[104:107], a[12:15], a[80:83], v[104:107]
    ds_read_b64_tr_b16 a[8:9], v210 offset:32768
    v_mfma_f32_16x16x32_bf16 v[108:111], a[12:15], a[84:87], v[108:111]
    ds_read_b64_tr_b16 a[10:11], v210 offset:36864
    v_mfma_f32_16x16x32_bf16 v[112:115], a[16:19], a[80:83], v[112:115]
    ds_read_b64_tr_b16 a[12:13], v211 offset:32768
    buffer_load_dwordx4 a[76:79], v229, s[12:15], s24 offen offset:1024
    v_mfma_f32_16x16x32_bf16 v[116:119], a[16:19], a[84:87], v[116:119]
    ds_read_b64_tr_b16 a[14:15], v211 offset:36864
    s_add_u32 s24, s24, 16384
    v_mfma_f32_16x16x32_bf16 v[120:123], a[20:23], a[80:83], v[120:123]
    ds_read_b64_tr_b16 a[16:17], v212 offset:32768
    v_mfma_f32_16x16x32_bf16 v[124:127], a[20:23], a[84:87], v[124:127]
    ds_read_b64_tr_b16 a[18:19], v212 offset:36864
    s_add_u32 m0, s25, 0
    v_mfma_f32_16x16x32_bf16 v[128:131], a[24:27], a[80:83], v[128:131]
    ds_read_b64_tr_b16 a[20:21], v213 offset:32768
    buffer_load_dwordx4 v224, s[8:11], s26 offen lds
    v_mfma_f32_16x16x32_bf16 v[132:135], a[24:27], a[84:87], v[132:135]
    ds_read_b64_tr_b16 a[22:23], v213 offset:36864
    v_mfma_f32_16x16x32_bf16 v[136:139], a[28:31], a[80:83], v[136:139]
    ds_read_b64_tr_b16 a[24:25], v214 offset:32768
    v_mfma_f32_16x16x32_bf16 v[140:143], a[28:31], a[84:87], v[140:143]
    ds_read_b64_tr_b16 a[26:27], v214 offset:36864
    s_waitcnt lgkmcnt(14)
    v_mfma_f32_16x16x32_bf16 v[80:83], a[32:35], a[88:91], v[80:83]
    ds_read_b64_tr_b16 a[28:29], v215 offset:32768
    buffer_load_dwordx4 v225, s[8:11], s26 offen offset:1024 lds
    v_mfma_f32_16x16x32_bf16 v[84:87], a[32:35], a[92:95], v[84:87]
    ds_read_b64_tr_b16 a[30:31], v215 offset:36864
    v_mfma_f32_16x16x32_bf16 v[88:91], a[36:39], a[88:91], v[88:91]
    ds_read_b64_tr_b16 a[32:33], v208 offset:40960
    v_mfma_f32_16x16x32_bf16 v[92:95], a[36:39], a[92:95], v[92:95]
    ds_read_b64_tr_b16 a[34:35], v208 offset:45056
    v_mfma_f32_16x16x32_bf16 v[96:99], a[40:43], a[88:91], v[96:99]
    ds_read_b64_tr_b16 a[36:37], v209 offset:40960
    buffer_load_dwordx4 v226, s[8:11], s26 offen offset:2048 lds
    v_mfma_f32_16x16x32_bf16 v[100:103], a[40:43], a[92:95], v[100:103]
    ds_read_b64_tr_b16 a[38:39], v209 offset:45056
    v_mfma_f32_16x16x32_bf16 v[104:107], a[44:47], a[88:91], v[104:107]
    ds_read_b64_tr_b16 a[40:41], v210 offset:40960
    v_mfma_f32_16x16x32_bf16 v[108:111], a[44:47], a[92:95], v[108:111]
    ds_read_b64_tr_b16 a[42:43], v210 offset:45056
    v_mfma_f32_16x16x32_bf16 v[112:115], a[48:51], a[88:91], v[112:115]
    ds_read_b64_tr_b16 a[44:45], v211 offset:40960
    buffer_load_dwordx4 v227, s[8:11], s26 offen offset:3072 lds
    v_mfma_f32_16x16x32_bf16 v[116:119], a[48:51], a[92:95], v[116:119]
    ds_read_b64_tr_b16 a[46:47], v211 offset:45056
    v_mfma_f32_16x16x32_bf16 v[120:123], a[52:55], a[88:91], v[120:123]
    ds_read_b64_tr_b16 a[48:49], v212 offset:40960
    s_add_u32 s26, s26, 65536
    v_mfma_f32_16x16x32_bf16 v[124:127], a[52:55], a[92:95], v[124:127]
    ds_read_b64_tr_b16 a[50:51], v212 offset:45056
    v_mfma_f32_16x16x32_bf16 v[128:131], a[56:59], a[88:91], v[128:131]
    ds_read_b64_tr_b16 a[52:53], v213 offset:40960
    v_mfma_f32_16x16x32_bf16 v[132:135], a[56:59], a[92:95], v[132:135]
    ds_read_b64_tr_b16 a[54:55], v213 offset:45056
    v_mfma_f32_16x16x32_bf16 v[136:139], a[60:63], a[88:91], v[136:139]
    ds_read_b64_tr_b16 a[56:57], v214 offset:40960
    v_mfma_f32_16x16x32_bf16 v[140:143], a[60:63], a[92:95], v[140:143]
    ds_read_b64_tr_b16 a[58:59], v214 offset:45056
    ds_read_b64_tr_b16 a[60:61], v215 offset:40960
    ds_read_b64_tr_b16 a[62:63], v215 offset:45056
    s_waitcnt vmcnt(8) lgkmcnt(15)
    s_barrier
    v_mfma_f32_16x16x32_bf16 v[80:83], a[0:3], a[96:99], v[80:83]
    buffer_load_dwordx4 a[80:83], v228, s[12:15], s24 offen offset:0
    v_mfma_f32_16x16x32_bf16 v[84:87], a[0:3], a[100:103], v[84:87]
    buffer_load_dwordx4 a[84:87], v228, s[12:15], s24 offen offset:1024
    v_mfma_f32_16x16x32_bf16 v[88:91], a[4:7], a[96:99], v[88:91]
    ds_read_b64_tr_b16 a[0:1], v208 offset:49152
    v_mfma_f32_16x16x32_bf16 v[92:95], a[4:7], a[100:103], v[92:95]
    ds_read_b64_tr_b16 a[2:3], v208 offset:53248
    v_mfma_f32_16x16x32_bf16 v[96:99], a[8:11], a[96:99], v[96:99]
    ds_read_b64_tr_b16 a[4:5], v209 offset:49152
    v_mfma_f32_16x16x32_bf16 v[100:103], a[8:11], a[100:103], v[100:103]
    ds_read_b64_tr_b16 a[6:7], v209 offset:53248
    buffer_load_dwordx4 a[88:91], v229, s[12:15], s24 offen offset:0
    v_mfma_f32_16x16x32_bf16 v[104:107], a[12:15], a[96:99], v[104:107]
    ds_read_b64_tr_b16 a[8:9], v210 offset:49152
    v_mfma_f32_16x16x32_bf16 v[108:111], a[12:15], a[100:103], v[108:111]
    ds_read_b64_tr_b16 a[10:11], v210 offset:53248
    v_mfma_f32_16x16x32_bf16 v[112:115], a[16:19], a[96:99], v[112:115]
    ds_read_b64_tr_b16 a[12:13], v211 offset:49152
    buffer_load_dwordx4 a[92:95], v229, s[12:15], s24 offen offset:1024
    v_mfma_f32_16x16x32_bf16 v[116:119], a[16:19], a[100:103], v[116:119]
    ds_read_b64_tr_b16 a[14:15], v211 offset:53248
    s_add_u32 s24, s24, 16384
    v_mfma_f32_16x16x32_bf16 v[120:123], a[20:23], a[96:99], v[120:123]
    ds_read_b64_tr_b16 a[16:17], v212 offset:49152
    v_mfma_f32_16x16x32_bf16 v[124:127], a[20:23], a[100:103], v[124:127]
    ds_read_b64_tr_b16 a[18:19], v212 offset:53248
    s_add_u32 m0, s25, 16384
    v_mfma_f32_16x16x32_bf16 v[128:131], a[24:27], a[96:99], v[128:131]
    ds_read_b64_tr_b16 a[20:21], v213 offset:49152
    buffer_load_dwordx4 v224, s[8:11], s26 offen lds
    v_mfma_f32_16x16x32_bf16 v[132:135], a[24:27], a[100:103], v[132:135]
    ds_read_b64_tr_b16 a[22:23], v213 offset:53248
    v_mfma_f32_16x16x32_bf16 v[136:139], a[28:31], a[96:99], v[136:139]
    ds_read_b64_tr_b16 a[24:25], v214 offset:49152
    v_mfma_f32_16x16x32_bf16 v[140:143], a[28:31], a[100:103], v[140:143]
    ds_read_b64_tr_b16 a[26:27], v214 offset:53248
    s_waitcnt lgkmcnt(14)
    v_mfma_f32_16x16x32_bf16 v[80:83], a[32:35], a[104:107], v[80:83]
    ds_read_b64_tr_b16 a[28:29], v215 offset:49152
    buffer_load_dwordx4 v225, s[8:11], s26 offen offset:1024 lds
    v_mfma_f32_16x16x32_bf16 v[84:87], a[32:35], a[108:111], v[84:87]
    ds_read_b64_tr_b16 a[30:31], v215 offset:53248
    v_mfma_f32_16x16x32_bf16 v[88:91], a[36:39], a[104:107], v[88:91]
    ds_read_b64_tr_b16 a[32:33], v208 offset:57344
    v_mfma_f32_16x16x32_bf16 v[92:95], a[36:39], a[108:111], v[92:95]
    ds_read_b64_tr_b16 a[34:35], v208 offset:61440
    v_mfma_f32_16x16x32_bf16 v[96:99], a[40:43], a[104:107], v[96:99]
    ds_read_b64_tr_b16 a[36:37], v209 offset:57344
    buffer_load_dwordx4 v226, s[8:11], s26 offen offset:2048 lds
    v_mfma_f32_16x16x32_bf16 v[100:103], a[40:43], a[108:111], v[100:103]
    ds_read_b64_tr_b16 a[38:39], v209 offset:61440
    v_mfma_f32_16x16x32_bf16 v[104:107], a[44:47], a[104:107], v[104:107]
    ds_read_b64_tr_b16 a[40:41], v210 offset:57344
    v_mfma_f32_16x16x32_bf16 v[108:111], a[44:47], a[108:111], v[108:111]
    ds_read_b64_tr_b16 a[42:43], v210 offset:61440
    v_mfma_f32_16x16x32_bf16 v[112:115], a[48:51], a[104:107], v[112:115]
    ds_read_b64_tr_b16 a[44:45], v211 offset:57344
    buffer_load_dwordx4 v227, s[8:11], s26 offen offset:3072 lds
    v_mfma_f32_16x16x32_bf16 v[116:119], a[48:51], a[108:111], v[116:119]
    ds_read_b64_tr_b16 a[46:47], v211 offset:61440
    v_mfma_f32_16x16x32_bf16 v[120:123], a[52:55], a[104:107], v[120:123]
    ds_read_b64_tr_b16 a[48:49], v212 offset:57344
    s_add_u32 s26, s26, 65536
    v_mfma_f32_16x16x32_bf16 v[124:127], a[52:55], a[108:111], v[124:127]
    ds_read_b64_tr_b16 a[50:51], v212 offset:61440
    v_mfma_f32_16x16x32_bf16 v[128:131], a[56:59], a[104:107], v[128:131]
    ds_read_b64_tr_b16 a[52:53], v213 offset:57344
    v_mfma_f32_16x16x32_bf16 v[132:135], a[56:59], a[108:111], v[132:135]
    ds_read_b64_tr_b16 a[54:55], v213 offset:61440
    v_mfma_f32_16x16x32_bf16 v[136:139], a[60:63], a[104:107], v[136:139]
    ds_read_b64_tr_b16 a[56:57], v214 offset:57344
    v_mfma_f32_16x16x32_bf16 v[140:143], a[60:63], a[108:111], v[140:143]
    ds_read_b64_tr_b16 a[58:59], v214 offset:61440
    ds_read_b64_tr_b16 a[60:61], v215 offset:57344
    ds_read_b64_tr_b16 a[62:63], v215 offset:61440
    s_waitcnt vmcnt(8) lgkmcnt(15)
    s_barrier
    v_mfma_f32_16x16x32_bf16 v[80:83], a[0:3], a[112:115], v[80:83]
    buffer_load_dwordx4 a[96:99], v228, s[12:15], s24 offen offset:0
    v_mfma_f32_16x16x32_bf16 v[84:87], a[0:3], a[116:119], v[84:87]
    buffer_load_dwordx4 a[100:103], v228, s[12:15], s24 offen offset:1024
    v_mfma_f32_16x16x32_bf16 v[88:91], a[4:7], a[112:115], v[88:91]
    ds_read_b64_tr_b16 a[0:1], v208 offset:0
    v_mfma_f32_16x16x32_bf16 v[92:95], a[4:7], a[116:119], v[92:95]
    ds_read_b64_tr_b16 a[2:3], v208 offset:4096
    v_mfma_f32_16x16x32_bf16 v[96:99], a[8:11], a[112:115], v[96:99]
    ds_read_b64_tr_b16 a[4:5], v209 offset:0
    v_mfma_f32_16x16x32_bf16 v[100:103], a[8:11], a[116:119], v[100:103]
    ds_read_b64_tr_b16 a[6:7], v209 offset:4096
    buffer_load_dwordx4 a[104:107], v229, s[12:15], s24 offen offset:0
    v_mfma_f32_16x16x32_bf16 v[104:107], a[12:15], a[112:115], v[104:107]
    ds_read_b64_tr_b16 a[8:9], v210 offset:0
    v_mfma_f32_16x16x32_bf16 v[108:111], a[12:15], a[116:119], v[108:111]
    ds_read_b64_tr_b16 a[10:11], v210 offset:4096
    v_mfma_f32_16x16x32_bf16 v[112:115], a[16:19], a[112:115], v[112:115]
    ds_read_b64_tr_b16 a[12:13], v211 offset:0
    buffer_load_dwordx4 a[108:111], v229, s[12:15], s24 offen offset:1024
    v_mfma_f32_16x16x32_bf16 v[116:119], a[16:19], a[116:119], v[116:119]
    ds_read_b64_tr_b16 a[14:15], v211 offset:4096
    s_add_u32 s24, s24, 16384
    v_mfma_f32_16x16x32_bf16 v[120:123], a[20:23], a[112:115], v[120:123]
    ds_read_b64_tr_b16 a[16:17], v212 offset:0
    v_mfma_f32_16x16x32_bf16 v[124:127], a[20:23], a[116:119], v[124:127]
    ds_read_b64_tr_b16 a[18:19], v212 offset:4096
    s_add_u32 m0, s25, 32768
    v_mfma_f32_16x16x32_bf16 v[128:131], a[24:27], a[112:115], v[128:131]
    ds_read_b64_tr_b16 a[20:21], v213 offset:0
    buffer_load_dwordx4 v224, s[8:11], s26 offen lds
    v_mfma_f32_16x16x32_bf16 v[132:135], a[24:27], a[116:119], v[132:135]
    ds_read_b64_tr_b16 a[22:23], v213 offset:4096
    v_mfma_f32_16x16x32_bf16 v[136:139], a[28:31], a[112:115], v[136:139]
    ds_read_b64_tr_b16 a[24:25], v214 offset:0
    v_mfma_f32_16x16x32_bf16 v[140:143], a[28:31], a[116:119], v[140:143]
    ds_read_b64_tr_b16 a[26:27], v214 offset:4096
    s_waitcnt lgkmcnt(14)
    v_mfma_f32_16x16x32_bf16 v[80:83], a[32:35], a[120:123], v[80:83]
    ds_read_b64_tr_b16 a[28:29], v215 offset:0
    buffer_load_dwordx4 v225, s[8:11], s26 offen offset:1024 lds
    v_mfma_f32_16x16x32_bf16 v[84:87], a[32:35], a[124:127], v[84:87]
    ds_read_b64_tr_b16 a[30:31], v215 offset:4096
    v_mfma_f32_16x16x32_bf16 v[88:91], a[36:39], a[120:123], v[88:91]
    ds_read_b64_tr_b16 a[32:33], v208 offset:8192
    v_mfma_f32_16x16x32_bf16 v[92:95], a[36:39], a[124:127], v[92:95]
    ds_read_b64_tr_b16 a[34:35], v208 offset:12288
    v_mfma_f32_16x16x32_bf16 v[96:99], a[40:43], a[120:123], v[96:99]
    ds_read_b64_tr_b16 a[36:37], v209 offset:8192
    buffer_load_dwordx4 v226, s[8:11], s26 offen offset:2048 lds
    v_mfma_f32_16x16x32_bf16 v[100:103], a[40:43], a[124:127], v[100:103]
    ds_read_b64_tr_b16 a[38:39], v209 offset:12288
    v_mfma_f32_16x16x32_bf16 v[104:107], a[44:47], a[120:123], v[104:107]
    ds_read_b64_tr_b16 a[40:41], v210 offset:8192
    v_mfma_f32_16x16x32_bf16 v[108:111], a[44:47], a[124:127], v[108:111]
    ds_read_b64_tr_b16 a[42:43], v210 offset:12288
    v_mfma_f32_16x16x32_bf16 v[112:115], a[48:51], a[120:123], v[112:115]
    ds_read_b64_tr_b16 a[44:45], v211 offset:8192
    buffer_load_dwordx4 v227, s[8:11], s26 offen offset:3072 lds
    v_mfma_f32_16x16x32_bf16 v[116:119], a[48:51], a[124:127], v[116:119]
    ds_read_b64_tr_b16 a[46:47], v211 offset:12288
    v_mfma_f32_16x16x32_bf16 v[120:123], a[52:55], a[120:123], v[120:123]
    ds_read_b64_tr_b16 a[48:49], v212 offset:8192
    s_add_u32 s26, s26, 65536
    v_mfma_f32_16x16x32_bf16 v[124:127], a[52:55], a[124:127], v[124:127]
    ds_read_b64_tr_b16 a[50:51], v212 offset:12288
    v_mfma_f32_16x16x32_bf16 v[128:131], a[56:59], a[120:123], v[128:131]
    ds_read_b64_tr_b16 a[52:53], v213 offset:8192
    v_mfma_f32_16x16x32_bf16 v[132:135], a[56:59], a[124:127], v[132:135]
    ds_read_b64_tr_b16 a[54:55], v213 offset:12288
    v_mfma_f32_16x16x32_bf16 v[136:139], a[60:63], a[120:123], v[136:139]
    ds_read_b64_tr_b16 a[56:57], v214 offset:8192
    v_mfma_f32_16x16x32_bf16 v[140:143], a[60:63], a[124:127], v[140:143]
    ds_read_b64_tr_b16 a[58:59], v214 offset:12288
    ds_read_b64_tr_b16 a[60:61], v215 offset:8192
    ds_read_b64_tr_b16 a[62:63], v215 offset:12288
    s_sub_u32 s57, s57, 1
    s_cmp_lg_u32 s57, 0
    s_cbranch_scc1 K3_loop1
K3_post:
    s_waitcnt lgkmcnt(0)
    s_nop 15
    s_lshl_b32 s7, s49, 2
    s_add_u32 s7, s7, s50
    s_mul_i32 s58, s7, 164096
    s_add_u32 s58, s58, 33554432
    s_lshl_b32 s59, s3, 13
    s_add_u32 s59, s59, s58
    s_lshl_b32 s6, s48, 15
    s_add_u32 s6, s6, s59
    v_lshlrev_b32 v2, 4, v1
    s_mov_b32 s36, 0xfffffffe
    s_cmp_eq_u32 s48, 3
    s_cbranch_scc1 K3_st1
    v_cvt_pk_bf16_f32 v144, v16, v17
    v_cvt_pk_bf16_f32 v145, v18, v19
    v_cvt_pk_bf16_f32 v146, v20, v21
    v_cvt_pk_bf16_f32 v147, v22, v23
    v_min_u32 v144, s36, v144
    v_min_u32 v145, s36, v145
    v_min_u32 v146, s36, v146
    v_min_u32 v147, s36, v147
    buffer_store_dwordx4 v[144:147], v2, s[20:23], s6 offen offset:0 sc1
    v_cvt_pk_bf16_f32 v148, v24, v25
    v_cvt_pk_bf16_f32 v149, v26, v27
    v_cvt_pk_bf16_f32 v150, v28, v29
    v_cvt_pk_bf16_f32 v151, v30, v31
    v_min_u32 v148, s36, v148
    v_min_u32 v149, s36, v149
    v_min_u32 v150, s36, v150
    v_min_u32 v151, s36, v151
    buffer_store_dwordx4 v[148:151], v2, s[20:23], s6 offen offset:1024 sc1
    v_cvt_pk_bf16_f32 v152, v32, v33
    v_cvt_pk_bf16_f32 v153, v34, v35
    v_cvt_pk_bf16_f32 v154, v36, v37
    v_cvt_pk_bf16_f32 v155, v38, v39
    v_min_u32 v152, s36, v152
    v_min_u32 v153, s36, v153
    v_min_u32 v154, s36, v154
    v_min_u32 v155, s36, v155
    buffer_store_dwordx4 v[152:155], v2, s[20:23], s6 offen offset:2048 sc1
    v_cvt_pk_bf16_f32 v156, v40, v41
    v_cvt_pk_bf16_f32 v157, v42, v43
    v_cvt_pk_bf16_f32 v158, v44, v45
    v_cvt_pk_bf16_f32 v159, v46, v47
    v_min_u32 v156, s36, v156
    v_min_u32 v157, s36, v157
    v_min_u32 v158, s36, v158
    v_min_u32 v159, s36, v159
    buffer_store_dwordx4 v[156:159], v2, s[20:23], s6 offen offset:3072 sc1
    v_cvt_pk_bf16_f32 v144, v48, v49
    v_cvt_pk_bf16_f32 v145, v50, v51
    v_cvt_pk_bf16_f32 v146, v52, v53
    v_cvt_pk_bf16_f32 v147, v54, v55
    v_min_u32 v144, s36, v144
    v_min_u32 v145, s36, v145
    v_min_u32 v146, s36, v146
    v_min_u32 v147, s36, v147
    s_add_u32 s6, s6, 4096
    buffer_store_dwordx4 v[144:147], v2, s[20:23], s6 offen offset:0 sc1
    v_cvt_pk_bf16_f32 v148, v56, v57
    v_cvt_pk_bf16_f32 v149, v58, v59
    v_cvt_pk_bf16_f32 v150, v60, v61
    v_cvt_pk_bf16_f32 v151, v62, v63
    v_min_u32 v148, s36, v148
    v_min_u32 v149, s36, v149
    v_min_u32 v150, s36, v150
    v_min_u32 v151, s36, v151
    buffer_store_dwordx4 v[148:151], v2, s[20:23], s6 offen offset:1024 sc1
    v_cvt_pk_bf16_f32 v152, v64, v65
    v_cvt_pk_bf16_f32 v153, v66, v67
    v_cvt_pk_bf16_f32 v154, v68, v69
    v_cvt_pk_bf16_f32 v155, v70, v71
    v_min_u32 v152, s36, v152
    v_min_u32 v153, s36, v153
    v_min_u32 v154, s36, v154
    v_min_u32 v155, s36, v155
    buffer_store_dwordx4 v[152:155], v2, s[20:23], s6 offen offset:2048 sc1
    v_cvt_pk_bf16_f32 v156, v72, v73
    v_cvt_pk_bf16_f32 v157, v74, v75
    v_cvt_pk_bf16_f32 v158, v76, v77
    v_cvt_pk_bf16_f32 v159, v78, v79
    v_min_u32 v156, s36, v156
    v_min_u32 v157, s36, v157
    v_min_u32 v158, s36, v158
    v_min_u32 v159, s36, v159
    buffer_store_dwordx4 v[156:159], v2, s[20:23], s6 offen offset:3072 sc1
K3_st1:
    s_cmp_lt_u32 s48, 2
    s_cbranch_scc1 K3_sync
    s_add_u32 s6, s48, 1
    s_lshl_b32 s6, s6, 15
    s_add_u32 s6, s6, s59
    v_cvt_pk_bf16_f32 v144, v80, v81
    v_cvt_pk_bf16_f32 v145, v82, v83
    v_cvt_pk_bf16_f32 v146, v84, v85
    v_cvt_pk_bf16_f32 v147, v86, v87
    v_min_u32 v144, s36, v144
    v_min_u32 v145, s36, v145
    v_min_u32 v146, s36, v146
    v_min_u32 v147, s36, v147
    buffer_store_dwordx4 v[144:147], v2, s[20:23], s6 offen offset:0 sc1
    v_cvt_pk_bf16_f32 v148, v88, v89
    v_cvt_pk_bf16_f32 v149, v90, v91
    v_cvt_pk_bf16_f32 v150, v92, v93
    v_cvt_pk_bf16_f32 v151, v94, v95
    v_min_u32 v148, s36, v148
    v_min_u32 v149, s36, v149
    v_min_u32 v150, s36, v150
    v_min_u32 v151, s36, v151
    buffer_store_dwordx4 v[148:151], v2, s[20:23], s6 offen offset:1024 sc1
    v_cvt_pk_bf16_f32 v152, v96, v97
    v_cvt_pk_bf16_f32 v153, v98, v99
    v_cvt_pk_bf16_f32 v154, v100, v101
    v_cvt_pk_bf16_f32 v155, v102, v103
    v_min_u32 v152, s36, v152
    v_min_u32 v153, s36, v153
    v_min_u32 v154, s36, v154
    v_min_u32 v155, s36, v155
    buffer_store_dwordx4 v[152:155], v2, s[20:23], s6 offen offset:2048 sc1
    v_cvt_pk_bf16_f32 v156, v104, v105
    v_cvt_pk_bf16_f32 v157, v106, v107
    v_cvt_pk_bf16_f32 v158, v108, v109
    v_cvt_pk_bf16_f32 v159, v110, v111
    v_min_u32 v156, s36, v156
    v_min_u32 v157, s36, v157
    v_min_u32 v158, s36, v158
    v_min_u32 v159, s36, v159
    buffer_store_dwordx4 v[156:159], v2, s[20:23], s6 offen offset:3072 sc1
    v_cvt_pk_bf16_f32 v144, v112, v113
    v_cvt_pk_bf16_f32 v145, v114, v115
    v_cvt_pk_bf16_f32 v146, v116, v117
    v_cvt_pk_bf16_f32 v147, v118, v119
    v_min_u32 v144, s36, v144
    v_min_u32 v145, s36, v145
    v_min_u32 v146, s36, v146
    v_min_u32 v147, s36, v147
    s_add_u32 s6, s6, 4096
    buffer_store_dwordx4 v[144:147], v2, s[20:23], s6 offen offset:0 sc1
    v_cvt_pk_bf16_f32 v148, v120, v121
    v_cvt_pk_bf16_f32 v149, v122, v123
    v_cvt_pk_bf16_f32 v150, v124, v125
    v_cvt_pk_bf16_f32 v151, v126, v127
    v_min_u32 v148, s36, v148
    v_min_u32 v149, s36, v149
    v_min_u32 v150, s36, v150
    v_min_u32 v151, s36, v151
    buffer_store_dwordx4 v[148:151], v2, s[20:23], s6 offen offset:1024 sc1
    v_cvt_pk_bf16_f32 v152, v128, v129
    v_cvt_pk_bf16_f32 v153, v130, v131
    v_cvt_pk_bf16_f32 v154, v132, v133
    v_cvt_pk_bf16_f32 v155, v134, v135
    v_min_u32 v152, s36, v152
    v_min_u32 v153, s36, v153
    v_min_u32 v154, s36, v154
    v_min_u32 v155, s36, v155
    buffer_store_dwordx4 v[152:155], v2, s[20:23], s6 offen offset:2048 sc1
    v_cvt_pk_bf16_f32 v156, v136, v137
    v_cvt_pk_bf16_f32 v157, v138, v139
    v_cvt_pk_bf16_f32 v158, v140, v141
    v_cvt_pk_bf16_f32 v159, v142, v143
    v_min_u32 v156, s36, v156
    v_min_u32 v157, s36, v157
    v_min_u32 v158, s36, v158
    v_min_u32 v159, s36, v159
    buffer_store_dwordx4 v[156:159], v2, s[20:23], s6 offen offset:3072 sc1
K3_sync:
    s_mov_b32 s8, s30
    s_and_b32 s9, s31, 0xffff
    s_mov_b32 s10, 2097152
    s_mov_b32 s11, 0x20000
    s_mov_b32 s12, s32
    s_and_b32 s13, s33, 0xffff
    s_mov_b32 s14, 2097152
    s_mov_b32 s15, 0x20000
    s_lshl_b32 s6, s49, 7
    s_lshl_b32 s74, s48, 5
    s_add_u32 s6, s6, s74
    s_lshl_b32 s6, s6, 10
    s_lshl_b32 s74, s50, 8
    s_add_u32 s6, s6, s74
    s_lshl_b32 s74, s3, 6
    s_add_u32 s37, s6, s74
    v_and_b32 v3, 15, v1
    v_lshrrev_b32 v4, 4, v1
    v_lshlrev_b32 v3, 10, v3
    v_lshl_add_u32 v3, v4, 3, v3
    v_add_u32 v4, 16384, v3
    buffer_load_dwordx2 v[200:201], v3, s[8:11], s37 offen offset:0
    buffer_load_dwordx2 v[202:203], v4, s[8:11], s37 offen offset:0
    buffer_load_dwordx2 v[204:205], v3, s[8:11], s37 offen offset:32
    buffer_load_dwordx2 v[206:207], v4, s[8:11], s37 offen offset:32
    s_lshl_b32 s59, s48, 13
    s_add_u32 s59, s59, s58
    s_lshl_b32 s6, s3, 11
    s_add_u32 s59, s59, s6
    s_mov_b32 s79, 0x40000
K3_retry:
    s_add_u32 s6, s59, 0
    buffer_load_dwordx4 v[16:19], v2, s[20:23], s6 offen offset:0 sc1
    buffer_load_dwordx4 v[20:23], v2, s[20:23], s6 offen offset:1024 sc1
    s_add_u32 s6, s59, 32768
    buffer_load_dwordx4 v[24:27], v2, s[20:23], s6 offen offset:0 sc1
    buffer_load_dwordx4 v[28:31], v2, s[20:23], s6 offen offset:1024 sc1
    s_add_u32 s6, s59, 65536
    buffer_load_dwordx4 v[32:35], v2, s[20:23], s6 offen offset:0 sc1
    buffer_load_dwordx4 v[36:39], v2, s[20:23], s6 offen offset:1024 sc1
    s_add_u32 s6, s59, 98304
    buffer_load_dwordx4 v[40:43], v2, s[20:23], s6 offen offset:0 sc1
    buffer_load_dwordx4 v[44:47], v2, s[20:23], s6 offen offset:1024 sc1
    s_add_u32 s6, s59, 131072
    buffer_load_dwordx4 v[48:51], v2, s[20:23], s6 offen offset:0 sc1
    buffer_load_dwordx4 v[52:55], v2, s[20:23], s6 offen offset:1024 sc1
    s_waitcnt vmcnt(0)
    v_max3_u32 v60, v16, v17, v18
    v_max3_u32 v60, v60, v19, v20
    v_max3_u32 v60, v60, v21, v22
    v_max3_u32 v60, v60, v23, v24
    v_max3_u32 v60, v60, v25, v26
    v_max3_u32 v60, v60, v27, v28
    v_max3_u32 v60, v60, v29, v30
    v_max3_u32 v60, v60, v31, v32
    v_max3_u32 v60, v60, v33, v34
    v_max3_u32 v60, v60, v35, v36
    v_max3_u32 v60, v60, v37, v38
    v_max3_u32 v60, v60, v39, v40
    v_max3_u32 v60, v60, v41, v42
    v_max3_u32 v60, v60, v43, v44
    v_max3_u32 v60, v60, v45, v46
    v_max3_u32 v60, v60, v47, v48
    v_max3_u32 v60, v60, v49, v50
    v_max3_u32 v60, v60, v51, v52
    v_max3_u32 v60, v60, v53, v54
    v_max_u32 v60, v60, v55
    v_cmp_eq_u32 vcc, -1, v60
    s_nop 4
    s_cbranch_vccz K3_ready
    s_sleep 1
    s_sub_u32 s79, s79, 1
    s_cbranch_scc0 K3_retry
K3_ready:
    s_mov_b32 s7, 0xbfb8aa3b
    v_lshlrev_b32 v60, 16, v16
    v_and_b32 v61, 0xffff0000, v16
    v_lshlrev_b32 v62, 16, v17
    v_and_b32 v63, 0xffff0000, v17
    v_lshlrev_b32 v68, 16, v24
    v_and_b32 v69, 0xffff0000, v24
    v_lshlrev_b32 v70, 16, v25
    v_and_b32 v71, 0xffff0000, v25
    v_add_f32 v60, v60, v68
    v_add_f32 v61, v61, v69
    v_add_f32 v62, v62, v70
    v_add_f32 v63, v63, v71
    v_lshlrev_b32 v68, 16, v32
    v_and_b32 v69, 0xffff0000, v32
    v_lshlrev_b32 v70, 16, v33
    v_and_b32 v71, 0xffff0000, v33
    v_add_f32 v60, v60, v68
    v_add_f32 v61, v61, v69
    v_add_f32 v62, v62, v70
    v_add_f32 v63, v63, v71
    v_lshlrev_b32 v64, 16, v40
    v_and_b32 v65, 0xffff0000, v40
    v_lshlrev_b32 v66, 16, v41
    v_and_b32 v67, 0xffff0000, v41
    v_lshlrev_b32 v68, 16, v48
    v_and_b32 v69, 0xffff0000, v48
    v_lshlrev_b32 v70, 16, v49
    v_and_b32 v71, 0xffff0000, v49
    v_add_f32 v64, v64, v68
    v_add_f32 v65, v65, v69
    v_add_f32 v66, v66, v70
    v_add_f32 v67, v67, v71
    v_mul_f32 v68, s7, v64
    v_mul_f32 v69, s7, v65
    v_mul_f32 v70, s7, v66
    v_mul_f32 v71, s7, v67
    v_exp_f32 v68, v68
    v_exp_f32 v69, v69
    v_exp_f32 v70, v70
    v_exp_f32 v71, v71
    v_add_f32 v68, 1.0, v68
    v_add_f32 v69, 1.0, v69
    v_add_f32 v70, 1.0, v70
    v_add_f32 v71, 1.0, v71
    v_rcp_f32 v68, v68
    v_rcp_f32 v69, v69
    v_rcp_f32 v70, v70
    v_rcp_f32 v71, v71
    v_mul_f32 v64, v64, v68
    v_mul_f32 v65, v65, v69
    v_mul_f32 v66, v66, v70
    v_mul_f32 v67, v67, v71
    v_lshlrev_b32 v68, 16, v200
    v_and_b32 v69, 0xffff0000, v200
    v_lshlrev_b32 v70, 16, v201
    v_and_b32 v71, 0xffff0000, v201
    v_fma_f32 v60, v60, v64, v68
    v_fma_f32 v61, v61, v65, v69
    v_fma_f32 v62, v62, v66, v70
    v_fma_f32 v63, v63, v67, v71
    v_cvt_pk_bf16_f32 v72, v60, v61
    v_cvt_pk_bf16_f32 v73, v62, v63
    buffer_store_dwordx2 v[72:73], v3, s[12:15], s37 offen offset:0
    v_lshlrev_b32 v60, 16, v18
    v_and_b32 v61, 0xffff0000, v18
    v_lshlrev_b32 v62, 16, v19
    v_and_b32 v63, 0xffff0000, v19
    v_lshlrev_b32 v68, 16, v26
    v_and_b32 v69, 0xffff0000, v26
    v_lshlrev_b32 v70, 16, v27
    v_and_b32 v71, 0xffff0000, v27
    v_add_f32 v60, v60, v68
    v_add_f32 v61, v61, v69
    v_add_f32 v62, v62, v70
    v_add_f32 v63, v63, v71
    v_lshlrev_b32 v68, 16, v34
    v_and_b32 v69, 0xffff0000, v34
    v_lshlrev_b32 v70, 16, v35
    v_and_b32 v71, 0xffff0000, v35
    v_add_f32 v60, v60, v68
    v_add_f32 v61, v61, v69
    v_add_f32 v62, v62, v70
    v_add_f32 v63, v63, v71
    v_lshlrev_b32 v64, 16, v42
    v_and_b32 v65, 0xffff0000, v42
    v_lshlrev_b32 v66, 16, v43
    v_and_b32 v67, 0xffff0000, v43
    v_lshlrev_b32 v68, 16, v50
    v_and_b32 v69, 0xffff0000, v50
    v_lshlrev_b32 v70, 16, v51
    v_and_b32 v71, 0xffff0000, v51
    v_add_f32 v64, v64, v68
    v_add_f32 v65, v65, v69
    v_add_f32 v66, v66, v70
    v_add_f32 v67, v67, v71
    v_mul_f32 v68, s7, v64
    v_mul_f32 v69, s7, v65
    v_mul_f32 v70, s7, v66
    v_mul_f32 v71, s7, v67
    v_exp_f32 v68, v68
    v_exp_f32 v69, v69
    v_exp_f32 v70, v70
    v_exp_f32 v71, v71
    v_add_f32 v68, 1.0, v68
    v_add_f32 v69, 1.0, v69
    v_add_f32 v70, 1.0, v70
    v_add_f32 v71, 1.0, v71
    v_rcp_f32 v68, v68
    v_rcp_f32 v69, v69
    v_rcp_f32 v70, v70
    v_rcp_f32 v71, v71
    v_mul_f32 v64, v64, v68
    v_mul_f32 v65, v65, v69
    v_mul_f32 v66, v66, v70
    v_mul_f32 v67, v67, v71
    v_lshlrev_b32 v68, 16, v202
    v_and_b32 v69, 0xffff0000, v202
    v_lshlrev_b32 v70, 16, v203
    v_and_b32 v71, 0xffff0000, v203
    v_fma_f32 v60, v60, v64, v68
    v_fma_f32 v61, v61, v65, v69
    v_fma_f32 v62, v62, v66, v70
    v_fma_f32 v63, v63, v67, v71
    v_cvt_pk_bf16_f32 v74, v60, v61
    v_cvt_pk_bf16_f32 v75, v62, v63
    buffer_store_dwordx2 v[74:75], v4, s[12:15], s37 offen offset:0
    v_lshlrev_b32 v60, 16, v20
    v_and_b32 v61, 0xffff0000, v20
    v_lshlrev_b32 v62, 16, v21
    v_and_b32 v63, 0xffff0000, v21
    v_lshlrev_b32 v68, 16, v28
    v_and_b32 v69, 0xffff0000, v28
    v_lshlrev_b32 v70, 16, v29
    v_and_b32 v71, 0xffff0000, v29
    v_add_f32 v60, v60, v68
    v_add_f32 v61, v61, v69
    v_add_f32 v62, v62, v70
    v_add_f32 v63, v63, v71
    v_lshlrev_b32 v68, 16, v36
    v_and_b32 v69, 0xffff0000, v36
    v_lshlrev_b32 v70, 16, v37
    v_and_b32 v71, 0xffff0000, v37
    v_add_f32 v60, v60, v68
    v_add_f32 v61, v61, v69
    v_add_f32 v62, v62, v70
    v_add_f32 v63, v63, v71
    v_lshlrev_b32 v64, 16, v44
    v_and_b32 v65, 0xffff0000, v44
    v_lshlrev_b32 v66, 16, v45
    v_and_b32 v67, 0xffff0000, v45
    v_lshlrev_b32 v68, 16, v52
    v_and_b32 v69, 0xffff0000, v52
    v_lshlrev_b32 v70, 16, v53
    v_and_b32 v71, 0xffff0000, v53
    v_add_f32 v64, v64, v68
    v_add_f32 v65, v65, v69
    v_add_f32 v66, v66, v70
    v_add_f32 v67, v67, v71
    v_mul_f32 v68, s7, v64
    v_mul_f32 v69, s7, v65
    v_mul_f32 v70, s7, v66
    v_mul_f32 v71, s7, v67
    v_exp_f32 v68, v68
    v_exp_f32 v69, v69
    v_exp_f32 v70, v70
    v_exp_f32 v71, v71
    v_add_f32 v68, 1.0, v68
    v_add_f32 v69, 1.0, v69
    v_add_f32 v70, 1.0, v70
    v_add_f32 v71, 1.0, v71
    v_rcp_f32 v68, v68
    v_rcp_f32 v69, v69
    v_rcp_f32 v70, v70
    v_rcp_f32 v71, v71
    v_mul_f32 v64, v64, v68
    v_mul_f32 v65, v65, v69
    v_mul_f32 v66, v66, v70
    v_mul_f32 v67, v67, v71
    v_lshlrev_b32 v68, 16, v204
    v_and_b32 v69, 0xffff0000, v204
    v_lshlrev_b32 v70, 16, v205
    v_and_b32 v71, 0xffff0000, v205
    v_fma_f32 v60, v60, v64, v68
    v_fma_f32 v61, v61, v65, v69
    v_fma_f32 v62, v62, v66, v70
    v_fma_f32 v63, v63, v67, v71
    v_cvt_pk_bf16_f32 v72, v60, v61
    v_cvt_pk_bf16_f32 v73, v62, v63
    buffer_store_dwordx2 v[72:73], v3, s[12:15], s37 offen offset:32
    v_lshlrev_b32 v60, 16, v22
    v_and_b32 v61, 0xffff0000, v22
    v_lshlrev_b32 v62, 16, v23
    v_and_b32 v63, 0xffff0000, v23
    v_lshlrev_b32 v68, 16, v30
    v_and_b32 v69, 0xffff0000, v30
    v_lshlrev_b32 v70, 16, v31
    v_and_b32 v71, 0xffff0000, v31
    v_add_f32 v60, v60, v68
    v_add_f32 v61, v61, v69
    v_add_f32 v62, v62, v70
    v_add_f32 v63, v63, v71
    v_lshlrev_b32 v68, 16, v38
    v_and_b32 v69, 0xffff0000, v38
    v_lshlrev_b32 v70, 16, v39
    v_and_b32 v71, 0xffff0000, v39
    v_add_f32 v60, v60, v68
    v_add_f32 v61, v61, v69
    v_add_f32 v62, v62, v70
    v_add_f32 v63, v63, v71
    v_lshlrev_b32 v64, 16, v46
    v_and_b32 v65, 0xffff0000, v46
    v_lshlrev_b32 v66, 16, v47
    v_and_b32 v67, 0xffff0000, v47
    v_lshlrev_b32 v68, 16, v54
    v_and_b32 v69, 0xffff0000, v54
    v_lshlrev_b32 v70, 16, v55
    v_and_b32 v71, 0xffff0000, v55
    v_add_f32 v64, v64, v68
    v_add_f32 v65, v65, v69
    v_add_f32 v66, v66, v70
    v_add_f32 v67, v67, v71
    v_mul_f32 v68, s7, v64
    v_mul_f32 v69, s7, v65
    v_mul_f32 v70, s7, v66
    v_mul_f32 v71, s7, v67
    v_exp_f32 v68, v68
    v_exp_f32 v69, v69
    v_exp_f32 v70, v70
    v_exp_f32 v71, v71
    v_add_f32 v68, 1.0, v68
    v_add_f32 v69, 1.0, v69
    v_add_f32 v70, 1.0, v70
    v_add_f32 v71, 1.0, v71
    v_rcp_f32 v68, v68
    v_rcp_f32 v69, v69
    v_rcp_f32 v70, v70
    v_rcp_f32 v71, v71
    v_mul_f32 v64, v64, v68
    v_mul_f32 v65, v65, v69
    v_mul_f32 v66, v66, v70
    v_mul_f32 v67, v67, v71
    v_lshlrev_b32 v68, 16, v206
    v_and_b32 v69, 0xffff0000, v206
    v_lshlrev_b32 v70, 16, v207
    v_and_b32 v71, 0xffff0000, v207
    v_fma_f32 v60, v60, v64, v68
    v_fma_f32 v61, v61, v65, v69
    v_fma_f32 v62, v62, v66, v70
    v_fma_f32 v63, v63, v67, v71
    v_cvt_pk_bf16_f32 v74, v60, v61
    v_cvt_pk_bf16_f32 v75, v62, v63
    buffer_store_dwordx2 v[74:75], v4, s[12:15], s37 offen offset:32
KB_end:
    s_endpgm
TEXT_END:

.section .rodata,"a"
.p2align 6
.amdhsa_kernel oproj_kernel
  .amdhsa_next_free_vgpr 384
  .amdhsa_next_free_sgpr 102
  .amdhsa_accum_offset 256
  .amdhsa_group_segment_fixed_size 0
  .amdhsa_kernarg_size 96
  .amdhsa_user_sgpr_count 2
  .amdhsa_user_sgpr_kernarg_segment_ptr 1
  .amdhsa_system_sgpr_workgroup_id_x 1
  .amdhsa_float_denorm_mode_32 3
.end_amdhsa_kernel
.text
```
